```python
import torch

def _softmax(x, axis=-1):
    return torch.softmax(x, dim=axis)

def _gelu(x):
    return torch.nn.functional.gelu(x, approximate='tanh')

def _silu(x):
    return torch.nn.functional.silu(x)

def _sigmoid(x):
    return torch.sigmoid(x)

def _layernorm(x, axis=-1, eps=1e-05):
    m = x.mean(dim=axis, keepdim=True)
    v = x.var(dim=axis, keepdim=True, unbiased=False)
    return (x - m) / torch.sqrt(v + eps)

def _scatter_add(tgt, idx, src, axis=0):
    return tgt.clone().index_add_(axis, idx, src)

def _segment_sum(src, seg, n):
    out = torch.zeros((n,) + src.shape[1:], dtype=src.dtype)
    return out.index_add_(0, seg, src)

def _pad(x, pw):
    flat = tuple((v for pair in reversed(pw) for v in pair))
    return torch.nn.functional.pad(x, flat)
kernel_name = 'sequential_preLN__memory_aug_recurrent_mem_tr__glu_gated_bilinear__prompt'

def setup_inputs():

    _w = lambda a: (lambda t: t.to(torch.bfloat16) if t.is_floating_point() else t)(torch.as_tensor(a))

    def _A_setup():
        B, S, Dm = (1, 2048, 640)
        H, Dh = (32, 192)
        M, seg = (8, 32)
        seg = min(seg, S)
        S = S // seg * seg
        return {'x': _w((lambda *s: torch.randn(*s, dtype=torch.bfloat16) * 0.05)(B, S, Dm)), 'mem0': _w((lambda *s: torch.randn(*s, dtype=torch.bfloat16) * 0.2)(B, M, Dm)), 'Wq': _w((lambda *s: torch.randn(*s, dtype=torch.bfloat16) * 1.6)(Dm, H, Dh) * Dm ** (-0.5)), 'Wk': _w((lambda *s: torch.randn(*s, dtype=torch.bfloat16) * 1.6)(Dm, H, Dh) * Dm ** (-0.5)), 'Wv': _w((lambda *s: torch.randn(*s, dtype=torch.bfloat16) * 0.2)(Dm, H, Dh) * Dm ** (-0.5)), 'Wo': _w((lambda *s: torch.randn(*s, dtype=torch.bfloat16) * 0.2)(H, Dh, Dm) * (H * Dh) ** (-0.5)), 'seg_len': seg}
    _A_in = _A_setup()

    def _B_setup():
        B, S, D, F = (1, 2048, 640, 1536)
        return {'x': _w((lambda *s: torch.randn(*s, dtype=torch.bfloat16) * 0.05)(B, S, D)), 'w_gate': _w((lambda *s: torch.randn(*s, dtype=torch.bfloat16) * 0.2)(D, F) * D ** (-0.5)), 'w_up': _w((lambda *s: torch.randn(*s, dtype=torch.bfloat16) * 0.2)(D, F) * D ** (-0.5)), 'w_down': _w((lambda *s: torch.randn(*s, dtype=torch.bfloat16) * 0.2)(F, D) * F ** (-0.5))}
    _B_in = _B_setup()
    return {'A_x': _A_in['x'], 'A_mem0': _A_in['mem0'], 'A_Wq': _A_in['Wq'], 'A_Wk': _A_in['Wk'], 'A_Wv': _A_in['Wv'], 'A_Wo': _A_in['Wo'], 'A_seg_len': _A_in['seg_len'], 'B_x': _B_in['x'], 'B_w_gate': _B_in['w_gate'], 'B_w_up': _B_in['w_up'], 'B_w_down': _B_in['w_down']}

def reference(A_x, A_mem0, A_Wq, A_Wk, A_Wv, A_Wo, A_seg_len, B_x, B_w_gate, B_w_up, B_w_down):

    def _A_ref(x, mem0, Wq, Wk, Wv, Wo, seg_len):
        B, S, Dm = x.shape
        H, Dh = (Wq.shape[1], Wq.shape[2])
        M = mem0.shape[1]
        scale = Dh ** (-0.5)
        n_seg = S // seg_len
        L = M + seg_len
        idx = torch.arange(L)
        mask = (idx[:, None] < M) | (idx[:, None] >= idx[None, :])
        mem = mem0
        outs = []
        for s in range(n_seg):
            xs = x[:, s * seg_len:(s + 1) * seg_len, :].clone()
            h = torch.concatenate([mem, xs], axis=1)
            q = torch.einsum('btd,dhe->bhte', h, Wq)
            k = torch.einsum('btd,dhe->bhte', h, Wk)
            v = torch.einsum('btd,dhe->bhte', h, Wv)
            scores = torch.einsum('bhqe,bhke->bhqk', q, k) * scale
            scores = torch.where(mask[None, None], scores, -1000000000.0)
            p = _softmax(scores, axis=-1)
            o = torch.einsum('bhqk,bhke->bhqe', p, v)
            o = torch.einsum('bhte,hed->btd', o, Wo)
            mem = o[:, :M, :].clone()
            outs.append(o[:, M:, :])
        return torch.concatenate(outs, axis=1)

    def _B_ref(x, w_gate, w_up, w_down):
        g = torch.einsum('bsd,df->bsf', x, w_gate)
        u = torch.einsum('bsd,df->bsf', x, w_up)
        h = g * u
        return torch.einsum('bsf,fd->bsd', h, w_down)
    x = A_x
    h = x + _A_ref(_layernorm(x, axis=-1), A_mem0, A_Wq, A_Wk, A_Wv, A_Wo, A_seg_len)
    h2 = h + _B_ref(_layernorm(h, axis=-1), B_w_gate, B_w_up, B_w_down)
    return h2
```

```asm
; @launch kernel=prep_kernel grid=(1536,1,1) block=(256,1,1) lds=0
; @launch kernel=chain_kernel grid=(256,1,1) block=(384,1,1) lds=145408
; @launch kernel=wo_kernel grid=(256,1,1) block=(256,1,1) lds=131072
.amdgcn_target "amdgcn-amd-amdhsa--gfx950"
.text
.globl prep_kernel
.p2align 8
.type prep_kernel,@function
prep_kernel:
    s_load_dwordx2 s[4:5], s[0:1], 104
    s_mov_b32 s3, s2
    s_cmp_lt_u32 s3, 512
    s_cbranch_scc1 L_prep_ln
    s_sub_u32 s3, s3, 512
    s_cmp_lt_u32 s3, 64
    s_cbranch_scc1 L_prep_zero
    s_sub_u32 s3, s3, 64
    s_cmp_lt_u32 s3, 960
    s_cbranch_scc1 L_prep_touch
    s_sub_u32 s3, s3, 960
    s_endpgm
L_prep_touch:
    s_and_b32 s20, s3, 3
    s_cmp_eq_u32 s20, 3
    s_cbranch_scc1 L_prep_tend
    s_lshr_b32 s3, s3, 2
    s_lshl_b32 s20, s20, 3
    s_add_u32 s20, s20, 16
    s_load_dwordx2 s[6:7], s[0:1], s20
    s_mul_i32 s3, s3, 32768
    v_mul_u32_u24 v1, 16, v0
    s_waitcnt lgkmcnt(0)
    s_mov_b32 s8, s6
    s_mov_b32 s9, s7
    s_and_b32 s9, s9, 0xffff
    s_mov_b32 s10, 0x780000
    s_mov_b32 s11, 0x20000
    buffer_load_dwordx4 v[4:7], v1, s[8:11], s3 offen
    s_add_u32 s3, s3, 4096
    buffer_load_dwordx4 v[8:11], v1, s[8:11], s3 offen
    s_add_u32 s3, s3, 4096
    buffer_load_dwordx4 v[12:15], v1, s[8:11], s3 offen
    s_add_u32 s3, s3, 4096
    buffer_load_dwordx4 v[16:19], v1, s[8:11], s3 offen
    s_add_u32 s3, s3, 4096
    buffer_load_dwordx4 v[20:23], v1, s[8:11], s3 offen
    s_add_u32 s3, s3, 4096
    buffer_load_dwordx4 v[24:27], v1, s[8:11], s3 offen
    s_add_u32 s3, s3, 4096
    buffer_load_dwordx4 v[28:31], v1, s[8:11], s3 offen
    s_add_u32 s3, s3, 4096
    buffer_load_dwordx4 v[32:35], v1, s[8:11], s3 offen
    s_add_u32 s3, s3, 4096
    s_waitcnt vmcnt(0)
L_prep_tend:
    s_endpgm
L_prep_zero:
    s_waitcnt lgkmcnt(0)
    s_add_u32 s8, s4, 0xa000000
    s_addc_u32 s9, s5, 0
    s_and_b32 s9, s9, 0xffff
    s_mov_b32 s10, 0x100000
    s_mov_b32 s11, 0x20000
    s_lshl_b32 s3, s3, 14
    v_lshlrev_b32 v1, 4, v0
    v_mov_b32 v4, 0
    v_mov_b32 v5, 0
    v_mov_b32 v6, 0
    v_mov_b32 v7, 0
    s_add_u32 s20, s3, 0
    buffer_store_dwordx4 v[4:7], v1, s[8:11], s20 offen
    s_add_u32 s20, s3, 4096
    buffer_store_dwordx4 v[4:7], v1, s[8:11], s20 offen
    s_add_u32 s20, s3, 8192
    buffer_store_dwordx4 v[4:7], v1, s[8:11], s20 offen
    s_add_u32 s20, s3, 12288
    buffer_store_dwordx4 v[4:7], v1, s[8:11], s20 offen
    s_cmp_lg_u32 s3, 0
    s_cbranch_scc1 L_prep_zend
    s_add_u32 s12, s4, 0xc000000
    s_addc_u32 s13, s5, 0
    s_and_b32 s13, s13, 0xffff
    s_mov_b32 s14, 0x1000
    s_mov_b32 s15, 0x20000
    buffer_store_dwordx4 v[4:7], v1, s[12:15], 0 offen
L_prep_zend:
    s_endpgm
L_prep_ln:
    s_load_dwordx2 s[6:7], s[0:1], 0
    s_waitcnt lgkmcnt(0)
    s_mov_b32 s8, s6
    s_mov_b32 s9, s7
    s_and_b32 s9, s9, 0xffff
    s_mov_b32 s10, 0x280000
    s_mov_b32 s11, 0x20000
    s_mov_b32 s12, s4
    s_mov_b32 s13, s5
    s_and_b32 s13, s13, 0xffff
    s_mov_b32 s14, 0x280000
    s_mov_b32 s15, 0x20000
    v_lshrrev_b32 v1, 6, v0
    s_nop 0
    v_readfirstlane_b32 s41, v1
    s_lshl_b32 s3, s3, 2
    s_add_u32 s41, s41, s3
    v_and_b32 v1, 63, v0
    v_lshlrev_b32 v2, 2, v1
    v_xor_b32 v3, 32, v1
    v_lshlrev_b32 v3, 2, v3
    s_mul_i32 s40, s41, 1280
    buffer_load_dword v10, v2, s[8:11], s40 offen offset:0
    buffer_load_dword v11, v2, s[8:11], s40 offen offset:256
    buffer_load_dword v12, v2, s[8:11], s40 offen offset:512
    buffer_load_dword v13, v2, s[8:11], s40 offen offset:768
    buffer_load_dword v14, v2, s[8:11], s40 offen offset:1024
    s_waitcnt vmcnt(0)
    v_lshlrev_b32 v20, 16, v10
    v_and_b32 v21, 0xffff0000, v10
    v_lshlrev_b32 v22, 16, v11
    v_and_b32 v23, 0xffff0000, v11
    v_lshlrev_b32 v24, 16, v12
    v_and_b32 v25, 0xffff0000, v12
    v_lshlrev_b32 v26, 16, v13
    v_and_b32 v27, 0xffff0000, v13
    v_lshlrev_b32 v28, 16, v14
    v_and_b32 v29, 0xffff0000, v14
    v_add_f32 v4, v20, v21
    v_add_f32 v4, v4, v22
    v_add_f32 v4, v4, v23
    v_add_f32 v4, v4, v24
    v_add_f32 v4, v4, v25
    v_add_f32 v4, v4, v26
    v_add_f32 v4, v4, v27
    v_add_f32 v4, v4, v28
    v_add_f32 v4, v4, v29
    ds_swizzle_b32 v5, v4 offset:0x41f
    s_waitcnt lgkmcnt(0)
    v_add_f32 v4, v4, v5
    ds_swizzle_b32 v5, v4 offset:0x81f
    s_waitcnt lgkmcnt(0)
    v_add_f32 v4, v4, v5
    ds_swizzle_b32 v5, v4 offset:0x101f
    s_waitcnt lgkmcnt(0)
    v_add_f32 v4, v4, v5
    ds_swizzle_b32 v5, v4 offset:0x201f
    s_waitcnt lgkmcnt(0)
    v_add_f32 v4, v4, v5
    ds_swizzle_b32 v5, v4 offset:0x401f
    s_waitcnt lgkmcnt(0)
    v_add_f32 v4, v4, v5
    ds_bpermute_b32 v5, v3, v4
    s_waitcnt lgkmcnt(0)
    v_add_f32 v4, v4, v5
    v_mul_f32 v4, 0x3acccccd, v4
    v_sub_f32 v20, v20, v4
    v_sub_f32 v21, v21, v4
    v_sub_f32 v22, v22, v4
    v_sub_f32 v23, v23, v4
    v_sub_f32 v24, v24, v4
    v_sub_f32 v25, v25, v4
    v_sub_f32 v26, v26, v4
    v_sub_f32 v27, v27, v4
    v_sub_f32 v28, v28, v4
    v_sub_f32 v29, v29, v4
    v_mul_f32 v6, v20, v20
    v_fmac_f32 v6, v21, v21
    v_fmac_f32 v6, v22, v22
    v_fmac_f32 v6, v23, v23
    v_fmac_f32 v6, v24, v24
    v_fmac_f32 v6, v25, v25
    v_fmac_f32 v6, v26, v26
    v_fmac_f32 v6, v27, v27
    v_fmac_f32 v6, v28, v28
    v_fmac_f32 v6, v29, v29
    ds_swizzle_b32 v5, v6 offset:0x41f
    s_waitcnt lgkmcnt(0)
    v_add_f32 v6, v6, v5
    ds_swizzle_b32 v5, v6 offset:0x81f
    s_waitcnt lgkmcnt(0)
    v_add_f32 v6, v6, v5
    ds_swizzle_b32 v5, v6 offset:0x101f
    s_waitcnt lgkmcnt(0)
    v_add_f32 v6, v6, v5
    ds_swizzle_b32 v5, v6 offset:0x201f
    s_waitcnt lgkmcnt(0)
    v_add_f32 v6, v6, v5
    ds_swizzle_b32 v5, v6 offset:0x401f
    s_waitcnt lgkmcnt(0)
    v_add_f32 v6, v6, v5
    ds_bpermute_b32 v5, v3, v6
    s_waitcnt lgkmcnt(0)
    v_add_f32 v6, v6, v5
    v_mul_f32 v6, 0x3acccccd, v6
    v_add_f32 v6, 0x3727c5ac, v6
    v_rsq_f32 v6, v6
    s_nop 1
    v_mul_f32 v20, v20, v6
    v_mul_f32 v21, v21, v6
    v_mul_f32 v22, v22, v6
    v_mul_f32 v23, v23, v6
    v_mul_f32 v24, v24, v6
    v_mul_f32 v25, v25, v6
    v_mul_f32 v26, v26, v6
    v_mul_f32 v27, v27, v6
    v_mul_f32 v28, v28, v6
    v_mul_f32 v29, v29, v6
    v_cvt_pk_bf16_f32 v10, v20, v21
    v_cvt_pk_bf16_f32 v11, v22, v23
    v_cvt_pk_bf16_f32 v12, v24, v25
    v_cvt_pk_bf16_f32 v13, v26, v27
    v_cvt_pk_bf16_f32 v14, v28, v29
    buffer_store_dword v10, v2, s[12:15], s40 offen offset:0
    buffer_store_dword v11, v2, s[12:15], s40 offen offset:256
    buffer_store_dword v12, v2, s[12:15], s40 offen offset:512
    buffer_store_dword v13, v2, s[12:15], s40 offen offset:768
    buffer_store_dword v14, v2, s[12:15], s40 offen offset:1024
    s_endpgm
.globl chain_kernel
.p2align 8
.type chain_kernel,@function
chain_kernel:
    s_cmp_ge_u32 s2, 256
    s_cbranch_scc1 L_chain_end
    s_load_dwordx2 s[4:5], s[0:1], 104
    s_load_dwordx2 s[6:7], s[0:1], 8
    s_load_dwordx2 s[76:77], s[0:1], 16
    s_load_dwordx2 s[78:79], s[0:1], 24
    s_load_dwordx2 s[80:81], s[0:1], 32
    s_load_dwordx2 s[82:83], s[0:1], 40
    s_and_b32 s20, s2, 7
    s_lshl_b32 s20, s20, 2
    s_bfe_u32 s21, s2, 0x20003
    s_add_u32 s20, s20, s21
    s_lshr_b32 s21, s2, 5
    s_mul_i32 s57, s20, 192
    s_mul_i32 s23, s21, 24
    s_add_u32 s22, s57, s23
    v_lshrrev_b32 v4, 6, v0
    s_nop 0
    v_readfirstlane_b32 s24, v4
    s_cmp_eq_u32 s24, 5
    s_cbranch_scc1 L_wt6
    s_lshl_b32 s25, s24, 2
    s_lshr_b32 s24, 0x40213, s25
    s_and_b32 s24, s24, 7
    v_and_b32 v0, 63, v0
    v_lshl_add_u32 v0, s24, 6, v0
    s_waitcnt lgkmcnt(0)
    s_add_u32 s12, s4, 0x1a00000
    s_addc_u32 s13, s5, 0
    s_and_b32 s13, s13, 0xffff
    s_mov_b32 s14, 0x780000
    s_mov_b32 s15, 0x20000
    s_mov_b32 s16, s6
    s_mov_b32 s17, s7
    s_and_b32 s17, s17, 0xffff
    s_mov_b32 s18, 0x2800
    s_mov_b32 s19, 0x20000
    s_add_u32 s28, s4, 0x2800000
    s_addc_u32 s29, s5, 0
    s_and_b32 s29, s29, 0xffff
    s_mov_b32 s30, 0x4800000
    s_mov_b32 s31, 0x20000
    s_mov_b32 s32, s4
    s_mov_b32 s33, s5
    s_and_b32 s33, s33, 0xffff
    s_mov_b32 s34, 0x280000
    s_mov_b32 s35, 0x20000
    s_add_u32 s40, s4, 0x7c00000
    s_addc_u32 s41, s5, 0
    s_and_b32 s41, s41, 0xffff
    s_mov_b32 s42, 0x1800000
    s_mov_b32 s43, 0x20000
    s_add_u32 s44, s4, 0xa000000
    s_addc_u32 s45, s5, 0
    s_and_b32 s45, s45, 0xffff
    s_mov_b32 s46, 0x100000
    s_mov_b32 s47, 0x20000
    v_and_b32 v1, 15, v0
    v_bfe_u32 v2, v0, 4, 2
    v_and_b32 v3, 63, v0
    v_and_b32 v10, 7, v1
    v_and_b32 v11, 1, v2
    v_cmp_gt_u32 s[62:63], 8, v1
    v_cmp_gt_u32 s[64:65], 2, v2
    v_mul_u32_u24 v6, 52429, v0
    v_lshrrev_b32 v6, 22, v6
    v_mul_u32_u24 v7, 80, v6
    v_sub_u32 v7, v0, v7
    v_and_b32 v8, 7, v6
    v_xor_b32 v7, v7, v8
    v_mul_u32_u24 v140, 1280, v6
    v_lshl_add_u32 v140, v7, 4, v140
    v_xor_b32 v141, 64, v140
    s_lshl_b32 s72, s24, 10
    s_lshl_b32 s27, s22, 1
    s_mov_b32 s26, 12288
    v_add_u32 v6, 0, v0
    v_mul_u32_u24 v7, 43691, v6
    v_lshrrev_b32 v7, 17, v7
    v_mul_u32_u24 v8, 3, v7
    v_sub_u32 v8, v6, v8
    v_mul_lo_u32 v7, v7, s26
    v_lshl_add_u32 v7, v8, 4, v7
    v_add_u32 v142, s27, v7
    v_add_u32 v6, 320, v0
    v_mul_u32_u24 v7, 43691, v6
    v_lshrrev_b32 v7, 17, v7
    v_mul_u32_u24 v8, 3, v7
    v_sub_u32 v8, v6, v8
    v_mul_lo_u32 v7, v7, s26
    v_lshl_add_u32 v7, v8, 4, v7
    v_add_u32 v143, s27, v7
    v_add_u32 v6, 640, v0
    v_mul_u32_u24 v7, 43691, v6
    v_lshrrev_b32 v7, 17, v7
    v_mul_u32_u24 v8, 3, v7
    v_sub_u32 v8, v6, v8
    v_mul_lo_u32 v7, v7, s26
    v_lshl_add_u32 v7, v8, 4, v7
    v_add_u32 v144, s27, v7
    v_add_u32 v6, 960, v0
    v_mul_u32_u24 v7, 43691, v6
    v_lshrrev_b32 v7, 17, v7
    v_mul_u32_u24 v8, 3, v7
    v_sub_u32 v8, v6, v8
    v_mul_lo_u32 v7, v7, s26
    v_lshl_add_u32 v7, v8, 4, v7
    v_add_u32 v145, s27, v7
    v_add_u32 v6, 1280, v0
    v_mul_u32_u24 v7, 43691, v6
    v_lshrrev_b32 v7, 17, v7
    v_mul_u32_u24 v8, 3, v7
    v_sub_u32 v8, v6, v8
    v_mul_lo_u32 v7, v7, s26
    v_lshl_add_u32 v7, v8, 4, v7
    v_add_u32 v146, s27, v7
    v_add_u32 v6, 1600, v0
    v_mul_u32_u24 v7, 43691, v6
    v_lshrrev_b32 v7, 17, v7
    v_mul_u32_u24 v8, 3, v7
    v_sub_u32 v8, v6, v8
    v_mul_lo_u32 v7, v7, s26
    v_lshl_add_u32 v7, v8, 4, v7
    v_add_u32 v147, s27, v7
    s_mov_b32 s8, s76
    s_mov_b32 s9, s77
    s_and_b32 s9, s9, 0xffff
    s_mov_b32 s10, 0x780000
    s_mov_b32 s11, 0x20000
    s_add_u32 m0, s72, 0
    s_nop 0
    buffer_load_dwordx4 v142, s[8:11], 0 offen lds
    s_add_u32 m0, s72, 5120
    s_nop 0
    buffer_load_dwordx4 v143, s[8:11], 0 offen lds
    s_add_u32 m0, s72, 10240
    s_nop 0
    buffer_load_dwordx4 v144, s[8:11], 0 offen lds
    s_add_u32 m0, s72, 15360
    s_nop 0
    buffer_load_dwordx4 v145, s[8:11], 0 offen lds
    s_add_u32 m0, s72, 20480
    s_nop 0
    buffer_load_dwordx4 v146, s[8:11], 0 offen lds
    s_add_u32 m0, s72, 25600
    s_nop 0
    buffer_load_dwordx4 v147, s[8:11], 0 offen lds
    s_mov_b32 s8, s78
    s_mov_b32 s9, s79
    s_and_b32 s9, s9, 0xffff
    s_mov_b32 s10, 0x780000
    s_mov_b32 s11, 0x20000
    s_add_u32 m0, s72, 30720
    s_nop 0
    buffer_load_dwordx4 v142, s[8:11], 0 offen lds
    s_add_u32 m0, s72, 35840
    s_nop 0
    buffer_load_dwordx4 v143, s[8:11], 0 offen lds
    s_add_u32 m0, s72, 40960
    s_nop 0
    buffer_load_dwordx4 v144, s[8:11], 0 offen lds
    s_add_u32 m0, s72, 46080
    s_nop 0
    buffer_load_dwordx4 v145, s[8:11], 0 offen lds
    s_add_u32 m0, s72, 51200
    s_nop 0
    buffer_load_dwordx4 v146, s[8:11], 0 offen lds
    s_add_u32 m0, s72, 56320
    s_nop 0
    buffer_load_dwordx4 v147, s[8:11], 0 offen lds
    s_mov_b32 s8, s80
    s_mov_b32 s9, s81
    s_and_b32 s9, s9, 0xffff
    s_mov_b32 s10, 0x780000
    s_mov_b32 s11, 0x20000
    s_add_u32 m0, s72, 104448
    s_nop 0
    buffer_load_dwordx4 v142, s[8:11], 0 offen lds
    s_add_u32 m0, s72, 109568
    s_nop 0
    buffer_load_dwordx4 v143, s[8:11], 0 offen lds
    s_add_u32 m0, s72, 114688
    s_nop 0
    buffer_load_dwordx4 v144, s[8:11], 0 offen lds
    s_add_u32 m0, s72, 119808
    s_nop 0
    buffer_load_dwordx4 v145, s[8:11], 0 offen lds
    s_add_u32 m0, s72, 124928
    s_nop 0
    buffer_load_dwordx4 v146, s[8:11], 0 offen lds
    s_add_u32 m0, s72, 130048
    s_nop 0
    buffer_load_dwordx4 v147, s[8:11], 0 offen lds
    s_add_u32 m0, s72, 63488
    s_mov_b32 s75, 0
    buffer_load_dwordx4 v140, s[32:35], s75 offen lds
    s_add_u32 m0, s72, 68608
    s_mov_b32 s75, 5120
    buffer_load_dwordx4 v141, s[32:35], s75 offen lds
    s_add_u32 m0, s72, 73728
    s_mov_b32 s75, 10240
    buffer_load_dwordx4 v140, s[32:35], s75 offen lds
    s_add_u32 m0, s72, 78848
    s_mov_b32 s75, 15360
    buffer_load_dwordx4 v141, s[32:35], s75 offen lds
    s_add_u32 m0, s72, 83968
    s_mov_b32 s75, 20480
    buffer_load_dwordx4 v140, s[32:35], s75 offen lds
    s_add_u32 m0, s72, 89088
    s_mov_b32 s75, 25600
    buffer_load_dwordx4 v141, s[32:35], s75 offen lds
    s_add_u32 m0, s72, 94208
    s_mov_b32 s75, 30720
    buffer_load_dwordx4 v140, s[32:35], s75 offen lds
    s_add_u32 m0, s72, 99328
    s_mov_b32 s75, 35840
    buffer_load_dwordx4 v141, s[32:35], s75 offen lds
    s_lshl_b32 s25, s24, 4
    v_add_u32 v5, s25, v1
    v_cmp_lt_u32 vcc, 71, v5
    v_subrev_u32 v6, 8, v5
    s_nop 0
    v_cndmask_b32 v5, v5, v6, vcc
    v_cndmask_b32 v47, 0, 32, vcc
    v_mul_u32_u24 v6, 43, v5
    v_lshrrev_b32 v6, 10, v6
    v_mul_u32_u24 v7, 24, v6
    v_sub_u32 v7, v5, v7
    v_and_b32 v9, 1, v1
    v_and_b32 v148, -2, v7
    v_lshlrev_b32 v148, 1, v148
    v_lshl_add_u32 v8, v2, 3, v9
    v_add_u32 v8, v8, v47
    v_mul_u32_u24 v8, 48, v8
    v_add_u32 v148, v148, v8
    v_mul_u32_u24 v8, 30720, v6
    v_cmp_eq_u32 vcc, 2, v6
    v_mov_b32 v149, 104448
    s_nop 0
    v_cndmask_b32 v8, v8, v149, vcc
    v_add_u32 v148, v148, v8
    v_add_u32 v7, s22, v7
    v_and_b32 v7, -2, v7
    v_lshlrev_b32 v7, 1, v7
    v_lshl_add_u32 v8, v2, 3, v9
    s_mov_b32 s26, 12288
    v_mul_lo_u32 v8, v8, s26
    v_add_u32 v48, v7, v8
    v_mul_lo_u32 v47, v47, s26
    v_add_u32 v7, v48, v47
    v_mov_b32 v46, 0x01000504
    v_mov_b32 v47, 0x07060302
    v_cmp_eq_u32 vcc, 1, v9
    s_nop 1
    v_cndmask_b32 v46, v46, v47, vcc
    s_mul_i32 s27, s21, 80
    s_add_u32 s27, s27, s25
    v_add_u32 v5, s27, v1
    v_and_b32 v8, -2, v5
    v_lshlrev_b32 v8, 1, v8
    v_lshl_add_u32 v47, v2, 2, s57
    v_add_u32 v47, v47, v9
    s_movk_i32 s27, 1280
    v_mul_lo_u32 v47, v47, s27
    v_add_u32 v8, v8, v47
    v_mul_lo_u32 v5, v5, s26
    s_lshl_b32 s27, s57, 1
    v_add_u32 v5, s27, v5
    v_lshl_add_u32 v5, v2, 3, v5
    s_mov_b32 s68, s12
    s_mov_b32 s69, s13
    s_mov_b32 s70, s14
    s_mov_b32 s71, s15
    s_mov_b32 s4, s82
    s_mov_b32 s5, s83
    s_and_b32 s5, s5, 0xffff
    s_mov_b32 s6, 0x780000
    s_mov_b32 s7, 0x20000
    v_mov_b32 v130, v5
    v_mov_b32 v131, v46
    v_mov_b32 v133, v8
    s_mov_b32 s11, 0x20000
    s_waitcnt vmcnt(8)
    s_barrier
    ds_read2_b32 v[50:51], v148 offset0:0 offset1:24
    ds_read2_b32 v[52:53], v148 offset0:48 offset1:72
    v_add_u32 v148, 1536, v148
    ds_read2_b32 v[54:55], v148 offset0:0 offset1:24
    ds_read2_b32 v[56:57], v148 offset0:48 offset1:72
    v_add_u32 v148, 1536, v148
    ds_read2_b32 v[58:59], v148 offset0:0 offset1:24
    ds_read2_b32 v[60:61], v148 offset0:48 offset1:72
    v_add_u32 v148, 1536, v148
    ds_read2_b32 v[62:63], v148 offset0:0 offset1:24
    ds_read2_b32 v[64:65], v148 offset0:48 offset1:72
    v_add_u32 v148, 1536, v148
    ds_read2_b32 v[66:67], v148 offset0:0 offset1:24
    ds_read2_b32 v[68:69], v148 offset0:48 offset1:72
    v_add_u32 v148, 1536, v148
    ds_read2_b32 v[70:71], v148 offset0:0 offset1:24
    ds_read2_b32 v[72:73], v148 offset0:48 offset1:72
    v_add_u32 v148, 1536, v148
    s_waitcnt lgkmcnt(10)
    ds_read2_b32 v[74:75], v148 offset0:0 offset1:24
    ds_read2_b32 v[76:77], v148 offset0:48 offset1:72
    v_add_u32 v148, 1536, v148
    v_mov_b32_dpp v47, v50 quad_perm:[1,0,3,2] row_mask:0xf bank_mask:0xf
    v_perm_b32 v50, v50, v47, v46
    v_accvgpr_write_b32 a0, v50
    v_mov_b32_dpp v47, v51 quad_perm:[1,0,3,2] row_mask:0xf bank_mask:0xf
    v_perm_b32 v51, v51, v47, v46
    v_accvgpr_write_b32 a1, v51
    v_mov_b32_dpp v47, v52 quad_perm:[1,0,3,2] row_mask:0xf bank_mask:0xf
    v_perm_b32 v52, v52, v47, v46
    v_accvgpr_write_b32 a2, v52
    v_mov_b32_dpp v47, v53 quad_perm:[1,0,3,2] row_mask:0xf bank_mask:0xf
    v_perm_b32 v53, v53, v47, v46
    v_accvgpr_write_b32 a3, v53
    s_waitcnt lgkmcnt(10)
    ds_read2_b32 v[78:79], v148 offset0:0 offset1:24
    ds_read2_b32 v[80:81], v148 offset0:48 offset1:72
    v_add_u32 v148, 1536, v148
    v_mov_b32_dpp v47, v54 quad_perm:[1,0,3,2] row_mask:0xf bank_mask:0xf
    v_perm_b32 v54, v54, v47, v46
    v_accvgpr_write_b32 a4, v54
    v_mov_b32_dpp v47, v55 quad_perm:[1,0,3,2] row_mask:0xf bank_mask:0xf
    v_perm_b32 v55, v55, v47, v46
    v_accvgpr_write_b32 a5, v55
    v_mov_b32_dpp v47, v56 quad_perm:[1,0,3,2] row_mask:0xf bank_mask:0xf
    v_perm_b32 v56, v56, v47, v46
    v_accvgpr_write_b32 a6, v56
    v_mov_b32_dpp v47, v57 quad_perm:[1,0,3,2] row_mask:0xf bank_mask:0xf
    v_perm_b32 v57, v57, v47, v46
    v_accvgpr_write_b32 a7, v57
    s_waitcnt lgkmcnt(10)
    ds_read2_b32 v[82:83], v148 offset0:0 offset1:24
    ds_read2_b32 v[84:85], v148 offset0:48 offset1:72
    v_add_u32 v148, 1536, v148
    v_mov_b32_dpp v47, v58 quad_perm:[1,0,3,2] row_mask:0xf bank_mask:0xf
    v_perm_b32 v58, v58, v47, v46
    v_accvgpr_write_b32 a8, v58
    v_mov_b32_dpp v47, v59 quad_perm:[1,0,3,2] row_mask:0xf bank_mask:0xf
    v_perm_b32 v59, v59, v47, v46
    v_accvgpr_write_b32 a9, v59
    v_mov_b32_dpp v47, v60 quad_perm:[1,0,3,2] row_mask:0xf bank_mask:0xf
    v_perm_b32 v60, v60, v47, v46
    v_accvgpr_write_b32 a10, v60
    v_mov_b32_dpp v47, v61 quad_perm:[1,0,3,2] row_mask:0xf bank_mask:0xf
    v_perm_b32 v61, v61, v47, v46
    v_accvgpr_write_b32 a11, v61
    s_waitcnt lgkmcnt(10)
    ds_read2_b32 v[86:87], v148 offset0:0 offset1:24
    ds_read2_b32 v[88:89], v148 offset0:48 offset1:72
    v_add_u32 v148, 1536, v148
    v_mov_b32_dpp v47, v62 quad_perm:[1,0,3,2] row_mask:0xf bank_mask:0xf
    v_perm_b32 v62, v62, v47, v46
    v_accvgpr_write_b32 a12, v62
    v_mov_b32_dpp v47, v63 quad_perm:[1,0,3,2] row_mask:0xf bank_mask:0xf
    v_perm_b32 v63, v63, v47, v46
    v_accvgpr_write_b32 a13, v63
    v_mov_b32_dpp v47, v64 quad_perm:[1,0,3,2] row_mask:0xf bank_mask:0xf
    v_perm_b32 v64, v64, v47, v46
    v_accvgpr_write_b32 a14, v64
    v_mov_b32_dpp v47, v65 quad_perm:[1,0,3,2] row_mask:0xf bank_mask:0xf
    v_perm_b32 v65, v65, v47, v46
    v_accvgpr_write_b32 a15, v65
    s_waitcnt lgkmcnt(10)
    ds_read2_b32 v[90:91], v148 offset0:0 offset1:24
    ds_read2_b32 v[92:93], v148 offset0:48 offset1:72
    v_add_u32 v148, 1536, v148
    v_mov_b32_dpp v47, v66 quad_perm:[1,0,3,2] row_mask:0xf bank_mask:0xf
    v_perm_b32 v66, v66, v47, v46
    v_accvgpr_write_b32 a16, v66
    v_mov_b32_dpp v47, v67 quad_perm:[1,0,3,2] row_mask:0xf bank_mask:0xf
    v_perm_b32 v67, v67, v47, v46
    v_accvgpr_write_b32 a17, v67
    v_mov_b32_dpp v47, v68 quad_perm:[1,0,3,2] row_mask:0xf bank_mask:0xf
    v_perm_b32 v68, v68, v47, v46
    v_accvgpr_write_b32 a18, v68
    v_mov_b32_dpp v47, v69 quad_perm:[1,0,3,2] row_mask:0xf bank_mask:0xf
    v_perm_b32 v69, v69, v47, v46
    v_accvgpr_write_b32 a19, v69
    s_waitcnt lgkmcnt(10)
    ds_read2_b32 v[94:95], v148 offset0:0 offset1:24
    ds_read2_b32 v[96:97], v148 offset0:48 offset1:72
    v_add_u32 v148, 1536, v148
    v_mov_b32_dpp v47, v70 quad_perm:[1,0,3,2] row_mask:0xf bank_mask:0xf
    v_perm_b32 v70, v70, v47, v46
    v_accvgpr_write_b32 a20, v70
    v_mov_b32_dpp v47, v71 quad_perm:[1,0,3,2] row_mask:0xf bank_mask:0xf
    v_perm_b32 v71, v71, v47, v46
    v_accvgpr_write_b32 a21, v71
    v_mov_b32_dpp v47, v72 quad_perm:[1,0,3,2] row_mask:0xf bank_mask:0xf
    v_perm_b32 v72, v72, v47, v46
    v_accvgpr_write_b32 a22, v72
    v_mov_b32_dpp v47, v73 quad_perm:[1,0,3,2] row_mask:0xf bank_mask:0xf
    v_perm_b32 v73, v73, v47, v46
    v_accvgpr_write_b32 a23, v73
    s_waitcnt lgkmcnt(10)
    ds_read2_b32 v[98:99], v148 offset0:0 offset1:24
    ds_read2_b32 v[100:101], v148 offset0:48 offset1:72
    v_add_u32 v148, 1536, v148
    v_mov_b32_dpp v47, v74 quad_perm:[1,0,3,2] row_mask:0xf bank_mask:0xf
    v_perm_b32 v74, v74, v47, v46
    v_accvgpr_write_b32 a24, v74
    v_mov_b32_dpp v47, v75 quad_perm:[1,0,3,2] row_mask:0xf bank_mask:0xf
    v_perm_b32 v75, v75, v47, v46
    v_accvgpr_write_b32 a25, v75
    v_mov_b32_dpp v47, v76 quad_perm:[1,0,3,2] row_mask:0xf bank_mask:0xf
    v_perm_b32 v76, v76, v47, v46
    v_accvgpr_write_b32 a26, v76
    v_mov_b32_dpp v47, v77 quad_perm:[1,0,3,2] row_mask:0xf bank_mask:0xf
    v_perm_b32 v77, v77, v47, v46
    v_accvgpr_write_b32 a27, v77
    s_waitcnt lgkmcnt(10)
    ds_read2_b32 v[102:103], v148 offset0:0 offset1:24
    ds_read2_b32 v[104:105], v148 offset0:48 offset1:72
    v_add_u32 v148, 1536, v148
    v_mov_b32_dpp v47, v78 quad_perm:[1,0,3,2] row_mask:0xf bank_mask:0xf
    v_perm_b32 v78, v78, v47, v46
    v_accvgpr_write_b32 a28, v78
    v_mov_b32_dpp v47, v79 quad_perm:[1,0,3,2] row_mask:0xf bank_mask:0xf
    v_perm_b32 v79, v79, v47, v46
    v_accvgpr_write_b32 a29, v79
    v_mov_b32_dpp v47, v80 quad_perm:[1,0,3,2] row_mask:0xf bank_mask:0xf
    v_perm_b32 v80, v80, v47, v46
    v_accvgpr_write_b32 a30, v80
    v_mov_b32_dpp v47, v81 quad_perm:[1,0,3,2] row_mask:0xf bank_mask:0xf
    v_perm_b32 v81, v81, v47, v46
    v_accvgpr_write_b32 a31, v81
    s_waitcnt lgkmcnt(10)
    ds_read2_b32 v[106:107], v148 offset0:0 offset1:24
    ds_read2_b32 v[108:109], v148 offset0:48 offset1:72
    v_add_u32 v148, 1536, v148
    v_mov_b32_dpp v47, v82 quad_perm:[1,0,3,2] row_mask:0xf bank_mask:0xf
    v_perm_b32 v82, v82, v47, v46
    v_accvgpr_write_b32 a32, v82
    v_mov_b32_dpp v47, v83 quad_perm:[1,0,3,2] row_mask:0xf bank_mask:0xf
    v_perm_b32 v83, v83, v47, v46
    v_accvgpr_write_b32 a33, v83
    v_mov_b32_dpp v47, v84 quad_perm:[1,0,3,2] row_mask:0xf bank_mask:0xf
    v_perm_b32 v84, v84, v47, v46
    v_accvgpr_write_b32 a34, v84
    v_mov_b32_dpp v47, v85 quad_perm:[1,0,3,2] row_mask:0xf bank_mask:0xf
    v_perm_b32 v85, v85, v47, v46
    v_accvgpr_write_b32 a35, v85
    s_waitcnt lgkmcnt(10)
    ds_read2_b32 v[110:111], v148 offset0:0 offset1:24
    ds_read2_b32 v[112:113], v148 offset0:48 offset1:72
    v_add_u32 v148, 1536, v148
    v_mov_b32_dpp v47, v86 quad_perm:[1,0,3,2] row_mask:0xf bank_mask:0xf
    v_perm_b32 v86, v86, v47, v46
    v_accvgpr_write_b32 a36, v86
    v_mov_b32_dpp v47, v87 quad_perm:[1,0,3,2] row_mask:0xf bank_mask:0xf
    v_perm_b32 v87, v87, v47, v46
    v_accvgpr_write_b32 a37, v87
    v_mov_b32_dpp v47, v88 quad_perm:[1,0,3,2] row_mask:0xf bank_mask:0xf
    v_perm_b32 v88, v88, v47, v46
    v_accvgpr_write_b32 a38, v88
    v_mov_b32_dpp v47, v89 quad_perm:[1,0,3,2] row_mask:0xf bank_mask:0xf
    v_perm_b32 v89, v89, v47, v46
    v_accvgpr_write_b32 a39, v89
    s_waitcnt lgkmcnt(10)
    ds_read2_b32 v[114:115], v148 offset0:0 offset1:24
    ds_read2_b32 v[116:117], v148 offset0:48 offset1:72
    v_add_u32 v148, 1536, v148
    v_mov_b32_dpp v47, v90 quad_perm:[1,0,3,2] row_mask:0xf bank_mask:0xf
    v_perm_b32 v90, v90, v47, v46
    v_accvgpr_write_b32 a40, v90
    v_mov_b32_dpp v47, v91 quad_perm:[1,0,3,2] row_mask:0xf bank_mask:0xf
    v_perm_b32 v91, v91, v47, v46
    v_accvgpr_write_b32 a41, v91
    v_mov_b32_dpp v47, v92 quad_perm:[1,0,3,2] row_mask:0xf bank_mask:0xf
    v_perm_b32 v92, v92, v47, v46
    v_accvgpr_write_b32 a42, v92
    v_mov_b32_dpp v47, v93 quad_perm:[1,0,3,2] row_mask:0xf bank_mask:0xf
    v_perm_b32 v93, v93, v47, v46
    v_accvgpr_write_b32 a43, v93
    s_waitcnt lgkmcnt(10)
    ds_read2_b32 v[118:119], v148 offset0:0 offset1:24
    ds_read2_b32 v[120:121], v148 offset0:48 offset1:72
    v_add_u32 v148, 1536, v148
    v_mov_b32_dpp v47, v94 quad_perm:[1,0,3,2] row_mask:0xf bank_mask:0xf
    v_perm_b32 v94, v94, v47, v46
    v_accvgpr_write_b32 a44, v94
    v_mov_b32_dpp v47, v95 quad_perm:[1,0,3,2] row_mask:0xf bank_mask:0xf
    v_perm_b32 v95, v95, v47, v46
    v_accvgpr_write_b32 a45, v95
    v_mov_b32_dpp v47, v96 quad_perm:[1,0,3,2] row_mask:0xf bank_mask:0xf
    v_perm_b32 v96, v96, v47, v46
    v_accvgpr_write_b32 a46, v96
    v_mov_b32_dpp v47, v97 quad_perm:[1,0,3,2] row_mask:0xf bank_mask:0xf
    v_perm_b32 v97, v97, v47, v46
    v_accvgpr_write_b32 a47, v97
    s_waitcnt lgkmcnt(10)
    ds_read2_b32 v[122:123], v148 offset0:0 offset1:24
    ds_read2_b32 v[124:125], v148 offset0:48 offset1:72
    v_add_u32 v148, 1536, v148
    v_mov_b32_dpp v47, v98 quad_perm:[1,0,3,2] row_mask:0xf bank_mask:0xf
    v_perm_b32 v98, v98, v47, v46
    v_accvgpr_write_b32 a48, v98
    v_mov_b32_dpp v47, v99 quad_perm:[1,0,3,2] row_mask:0xf bank_mask:0xf
    v_perm_b32 v99, v99, v47, v46
    v_accvgpr_write_b32 a49, v99
    v_mov_b32_dpp v47, v100 quad_perm:[1,0,3,2] row_mask:0xf bank_mask:0xf
    v_perm_b32 v100, v100, v47, v46
    v_accvgpr_write_b32 a50, v100
    v_mov_b32_dpp v47, v101 quad_perm:[1,0,3,2] row_mask:0xf bank_mask:0xf
    v_perm_b32 v101, v101, v47, v46
    v_accvgpr_write_b32 a51, v101
    s_waitcnt lgkmcnt(10)
    ds_read2_b32 v[126:127], v148 offset0:0 offset1:24
    ds_read2_b32 v[128:129], v148 offset0:48 offset1:72
    v_add_u32 v148, 1536, v148
    v_mov_b32_dpp v47, v102 quad_perm:[1,0,3,2] row_mask:0xf bank_mask:0xf
    v_perm_b32 v102, v102, v47, v46
    v_accvgpr_write_b32 a52, v102
    v_mov_b32_dpp v47, v103 quad_perm:[1,0,3,2] row_mask:0xf bank_mask:0xf
    v_perm_b32 v103, v103, v47, v46
    v_accvgpr_write_b32 a53, v103
    v_mov_b32_dpp v47, v104 quad_perm:[1,0,3,2] row_mask:0xf bank_mask:0xf
    v_perm_b32 v104, v104, v47, v46
    v_accvgpr_write_b32 a54, v104
    v_mov_b32_dpp v47, v105 quad_perm:[1,0,3,2] row_mask:0xf bank_mask:0xf
    v_perm_b32 v105, v105, v47, v46
    v_accvgpr_write_b32 a55, v105
    s_waitcnt lgkmcnt(10)
    v_mov_b32_dpp v47, v106 quad_perm:[1,0,3,2] row_mask:0xf bank_mask:0xf
    v_perm_b32 v106, v106, v47, v46
    v_accvgpr_write_b32 a56, v106
    v_mov_b32_dpp v47, v107 quad_perm:[1,0,3,2] row_mask:0xf bank_mask:0xf
    v_perm_b32 v107, v107, v47, v46
    v_accvgpr_write_b32 a57, v107
    v_mov_b32_dpp v47, v108 quad_perm:[1,0,3,2] row_mask:0xf bank_mask:0xf
    v_perm_b32 v108, v108, v47, v46
    v_accvgpr_write_b32 a58, v108
    v_mov_b32_dpp v47, v109 quad_perm:[1,0,3,2] row_mask:0xf bank_mask:0xf
    v_perm_b32 v109, v109, v47, v46
    v_accvgpr_write_b32 a59, v109
    s_waitcnt lgkmcnt(8)
    v_mov_b32_dpp v47, v110 quad_perm:[1,0,3,2] row_mask:0xf bank_mask:0xf
    v_perm_b32 v110, v110, v47, v46
    v_accvgpr_write_b32 a60, v110
    v_mov_b32_dpp v47, v111 quad_perm:[1,0,3,2] row_mask:0xf bank_mask:0xf
    v_perm_b32 v111, v111, v47, v46
    v_accvgpr_write_b32 a61, v111
    v_mov_b32_dpp v47, v112 quad_perm:[1,0,3,2] row_mask:0xf bank_mask:0xf
    v_perm_b32 v112, v112, v47, v46
    v_accvgpr_write_b32 a62, v112
    v_mov_b32_dpp v47, v113 quad_perm:[1,0,3,2] row_mask:0xf bank_mask:0xf
    v_perm_b32 v113, v113, v47, v46
    v_accvgpr_write_b32 a63, v113
    s_waitcnt lgkmcnt(6)
    v_mov_b32_dpp v47, v114 quad_perm:[1,0,3,2] row_mask:0xf bank_mask:0xf
    v_perm_b32 v114, v114, v47, v46
    v_accvgpr_write_b32 a64, v114
    v_mov_b32_dpp v47, v115 quad_perm:[1,0,3,2] row_mask:0xf bank_mask:0xf
    v_perm_b32 v115, v115, v47, v46
    v_accvgpr_write_b32 a65, v115
    v_mov_b32_dpp v47, v116 quad_perm:[1,0,3,2] row_mask:0xf bank_mask:0xf
    v_perm_b32 v116, v116, v47, v46
    v_accvgpr_write_b32 a66, v116
    v_mov_b32_dpp v47, v117 quad_perm:[1,0,3,2] row_mask:0xf bank_mask:0xf
    v_perm_b32 v117, v117, v47, v46
    v_accvgpr_write_b32 a67, v117
    s_waitcnt lgkmcnt(4)
    v_mov_b32_dpp v47, v118 quad_perm:[1,0,3,2] row_mask:0xf bank_mask:0xf
    v_perm_b32 v118, v118, v47, v46
    v_accvgpr_write_b32 a68, v118
    v_mov_b32_dpp v47, v119 quad_perm:[1,0,3,2] row_mask:0xf bank_mask:0xf
    v_perm_b32 v119, v119, v47, v46
    v_accvgpr_write_b32 a69, v119
    v_mov_b32_dpp v47, v120 quad_perm:[1,0,3,2] row_mask:0xf bank_mask:0xf
    v_perm_b32 v120, v120, v47, v46
    v_accvgpr_write_b32 a70, v120
    v_mov_b32_dpp v47, v121 quad_perm:[1,0,3,2] row_mask:0xf bank_mask:0xf
    v_perm_b32 v121, v121, v47, v46
    v_accvgpr_write_b32 a71, v121
    s_waitcnt lgkmcnt(2)
    v_mov_b32_dpp v47, v122 quad_perm:[1,0,3,2] row_mask:0xf bank_mask:0xf
    v_perm_b32 v122, v122, v47, v46
    v_accvgpr_write_b32 a72, v122
    v_mov_b32_dpp v47, v123 quad_perm:[1,0,3,2] row_mask:0xf bank_mask:0xf
    v_perm_b32 v123, v123, v47, v46
    v_accvgpr_write_b32 a73, v123
    v_mov_b32_dpp v47, v124 quad_perm:[1,0,3,2] row_mask:0xf bank_mask:0xf
    v_perm_b32 v124, v124, v47, v46
    v_accvgpr_write_b32 a74, v124
    v_mov_b32_dpp v47, v125 quad_perm:[1,0,3,2] row_mask:0xf bank_mask:0xf
    v_perm_b32 v125, v125, v47, v46
    v_accvgpr_write_b32 a75, v125
    s_waitcnt lgkmcnt(0)
    v_mov_b32_dpp v47, v126 quad_perm:[1,0,3,2] row_mask:0xf bank_mask:0xf
    v_perm_b32 v126, v126, v47, v46
    v_accvgpr_write_b32 a76, v126
    v_mov_b32_dpp v47, v127 quad_perm:[1,0,3,2] row_mask:0xf bank_mask:0xf
    v_perm_b32 v127, v127, v47, v46
    v_accvgpr_write_b32 a77, v127
    v_mov_b32_dpp v47, v128 quad_perm:[1,0,3,2] row_mask:0xf bank_mask:0xf
    v_perm_b32 v128, v128, v47, v46
    v_accvgpr_write_b32 a78, v128
    v_mov_b32_dpp v47, v129 quad_perm:[1,0,3,2] row_mask:0xf bank_mask:0xf
    v_perm_b32 v129, v129, v47, v46
    v_accvgpr_write_b32 a79, v129
    s_barrier
    s_add_u32 m0, s72, 104448
    s_mov_b32 s75, 40960
    buffer_load_dwordx4 v140, s[32:35], s75 offen lds
    s_add_u32 m0, s72, 109568
    s_mov_b32 s75, 46080
    buffer_load_dwordx4 v141, s[32:35], s75 offen lds
    s_add_u32 m0, s72, 114688
    s_mov_b32 s75, 51200
    buffer_load_dwordx4 v140, s[32:35], s75 offen lds
    s_add_u32 m0, s72, 119808
    s_mov_b32 s75, 56320
    buffer_load_dwordx4 v141, s[32:35], s75 offen lds
    s_add_u32 m0, s72, 124928
    s_mov_b32 s75, 61440
    buffer_load_dwordx4 v140, s[32:35], s75 offen lds
    s_add_u32 m0, s72, 130048
    s_mov_b32 s75, 66560
    buffer_load_dwordx4 v141, s[32:35], s75 offen lds
    s_add_u32 m0, s72, 135168
    s_mov_b32 s75, 71680
    buffer_load_dwordx4 v140, s[32:35], s75 offen lds
    s_add_u32 m0, s72, 140288
    s_mov_b32 s75, 76800
    buffer_load_dwordx4 v141, s[32:35], s75 offen lds
    v_add_u32 v5, 0, v0
    v_mul_u32_u24 v6, 205, v5
    v_lshrrev_b32 v6, 14, v6
    v_mul_u32_u24 v7, 80, v6
    v_sub_u32 v7, v5, v7
    v_mul_u32_u24 v44, 1296, v6
    v_lshl_add_u32 v44, v7, 4, v44
    v_add_u32 v5, 320, v0
    v_mul_u32_u24 v6, 205, v5
    v_lshrrev_b32 v6, 14, v6
    v_mul_u32_u24 v7, 80, v6
    v_sub_u32 v7, v5, v7
    v_mul_u32_u24 v45, 1296, v6
    v_lshl_add_u32 v45, v7, 4, v45
    v_lshlrev_b32 v17, 4, v0
    v_add_u32 v5, 0, v0
    v_and_b32 v6, 3, v5
    v_lshrrev_b32 v7, 2, v5
    v_mul_u32_u24 v42, 2592, v6
    v_lshl_add_u32 v42, v7, 3, v42
    v_add_u32 v5, 320, v0
    v_and_b32 v6, 3, v5
    v_lshrrev_b32 v7, 2, v5
    v_mul_u32_u24 v43, 2592, v6
    v_lshl_add_u32 v43, v7, 3, v43
    buffer_load_dwordx4 v[20:23], v17, s[16:19], 0 offen
    s_movk_i32 s27, 5120
    buffer_load_dwordx4 v[24:27], v17, s[16:19], s27 offen
    s_waitcnt vmcnt(0)
    ds_write_b128 v44, v[20:23] offset:0
    ds_write_b128 v45, v[24:27] offset:0
    v_mul_u32_u24 v5, 1296, v10
    v_lshl_add_u32 v5, v2, 4, v5
    v_lshrrev_b32 v6, 3, v1
    v_lshl_add_u32 v5, v6, 6, v5
    v_lshl_add_u32 v6, v2, 2, s25
    v_cmp_lt_u32 vcc, 23, v6
    v_subrev_u32 v7, 24, v6
    s_nop 0
    v_cndmask_b32 v7, v6, v7, vcc
    v_cndmask_b32 v8, 0, 1, vcc
    v_add_u32 v7, s23, v7
    v_lshlrev_b32 v22, 1, v7
    v_mul_u32_u24 v9, 384, v1
    v_add_u32 v22, v22, v9
    v_mul_u32_u24 v9, 3072, v8
    v_add_u32 v22, v22, v9
    v_mul_lo_u32 v34, v1, s26
    v_add_u32 v9, s57, v7
    v_lshl_add_u32 v34, v9, 1, v34
    v_mov_b32 v35, v8
    s_sub_u32 s27, s25, 48
    v_add_u32 v6, s27, v1
    v_add_u32 v7, s23, v6
    v_lshlrev_b32 v23, 4, v7
    v_lshl_add_u32 v23, v2, 3, v23
    v_add_u32 v36, s57, v7
    v_lshlrev_b32 v36, 4, v36
    v_lshl_add_u32 v36, v2, 3, v36
    v_add_u32 v23, 6144, v23
    v_mov_b32 v37, v6
    s_mul_i32 s51, s20, 9216
    v_add_u32 v6, 0, v0
    v_mul_u32_u24 v7, 2731, v6
    v_lshrrev_b32 v7, 16, v7
    v_mul_u32_u24 v8, 24, v7
    v_sub_u32 v8, v6, v8
    v_and_b32 v9, 7, v7
    v_lshrrev_b32 v7, 3, v7
    v_mul_u32_u24 v46, 400, v9
    v_lshl_add_u32 v46, v8, 4, v46
    v_mul_u32_u24 v7, 4800, v7
    v_add_u32 v46, v46, v7
    v_add_u32 v46, 10368, v46
    v_subrev_u32 v7, 384, v6
    v_mul_u32_u24 v7, 112, v7
    v_add_u32 v7, 34368, v7
    v_cmp_lt_u32 vcc, 383, v6
    s_nop 1
    v_cndmask_b32 v46, v46, v7, vcc
    v_add_u32 v6, 320, v0
    v_mul_u32_u24 v7, 2731, v6
    v_lshrrev_b32 v7, 16, v7
    v_mul_u32_u24 v8, 24, v7
    v_sub_u32 v8, v6, v8
    v_and_b32 v9, 7, v7
    v_lshrrev_b32 v7, 3, v7
    v_mul_u32_u24 v47, 400, v9
    v_lshl_add_u32 v47, v8, 4, v47
    v_mul_u32_u24 v7, 4800, v7
    v_add_u32 v47, v47, v7
    v_add_u32 v47, 10368, v47
    v_subrev_u32 v7, 384, v6
    v_mul_u32_u24 v7, 112, v7
    v_add_u32 v7, 34368, v7
    v_cmp_lt_u32 vcc, 383, v6
    s_nop 1
    v_cndmask_b32 v47, v47, v7, vcc
    s_cmp_ge_u32 s24, 3
    s_cselect_b32 s74, 192, 0
    v_add_u32 v6, s74, v0
    v_mul_u32_u24 v7, 683, v6
    v_lshrrev_b32 v7, 16, v7
    v_mul_u32_u24 v8, 96, v7
    v_sub_u32 v8, v6, v8
    v_mul_u32_u24 v12, 4608, v7
    v_lshl_add_u32 v12, v8, 4, v12
    v_add_u32 v12, 1536, v12
    v_mul_u32_u24 v9, 86, v8
    v_lshrrev_b32 v9, 8, v9
    v_mul_u32_u24 v28, 400, v9
    v_mul_u32_u24 v9, 3, v9
    v_sub_u32 v9, v8, v9
    v_lshl_add_u32 v28, v9, 4, v28
    v_mul_u32_u24 v9, 48, v7
    v_add_u32 v28, v28, v9
    v_add_u32 v28, 18368, v28
    v_lshrrev_b32 v7, 2, v6
    v_and_b32 v8, 3, v6
    v_mul_u32_u24 v38, 112, v7
    v_lshl_add_u32 v38, v8, 4, v38
    v_add_u32 v38, 34384, v38
    s_cmp_ge_u32 s24, 3
    s_cselect_b32 s74, 320, 0
    s_cselect_b32 s75, 0, 192
    s_add_u32 s74, s74, s75
    v_add_u32 v6, s74, v0
    v_mul_u32_u24 v7, 683, v6
    v_lshrrev_b32 v7, 16, v7
    v_mul_u32_u24 v8, 96, v7
    v_sub_u32 v8, v6, v8
    v_mul_u32_u24 v13, 4608, v7
    v_lshl_add_u32 v13, v8, 4, v13
    v_add_u32 v13, 1536, v13
    v_mul_u32_u24 v9, 86, v8
    v_lshrrev_b32 v9, 8, v9
    v_mul_u32_u24 v29, 400, v9
    v_mul_u32_u24 v9, 3, v9
    v_sub_u32 v9, v8, v9
    v_lshl_add_u32 v29, v9, 4, v29
    v_mul_u32_u24 v9, 48, v7
    v_add_u32 v29, v29, v9
    v_add_u32 v29, 18368, v29
    v_lshrrev_b32 v7, 2, v6
    v_and_b32 v8, 3, v6
    v_mul_u32_u24 v39, 112, v7
    v_lshl_add_u32 v39, v8, 4, v39
    v_add_u32 v39, 34384, v39
    s_cmp_ge_u32 s24, 3
    s_cselect_b32 s74, 448, 0
    s_cselect_b32 s75, 0, 192
    s_add_u32 s74, s74, s75
    v_add_u32 v6, s74, v0
    v_mul_u32_u24 v7, 683, v6
    v_lshrrev_b32 v7, 16, v7
    v_mul_u32_u24 v8, 96, v7
    v_sub_u32 v8, v6, v8
    v_mul_u32_u24 v14, 4608, v7
    v_lshl_add_u32 v14, v8, 4, v14
    v_add_u32 v14, 1536, v14
    v_mul_u32_u24 v9, 86, v8
    v_lshrrev_b32 v9, 8, v9
    v_mul_u32_u24 v30, 400, v9
    v_mul_u32_u24 v9, 3, v9
    v_sub_u32 v9, v8, v9
    v_lshl_add_u32 v30, v9, 4, v30
    v_mul_u32_u24 v9, 48, v7
    v_add_u32 v30, v30, v9
    v_add_u32 v30, 18368, v30
    v_lshrrev_b32 v7, 2, v6
    v_and_b32 v8, 3, v6
    v_mul_u32_u24 v40, 112, v7
    v_lshl_add_u32 v40, v8, 4, v40
    v_add_u32 v40, 34384, v40
    v_cmp_lt_u32 vcc, 191, v0
    s_mov_b64 s[48:49], vcc
    v_cmp_gt_u32 vcc, 12, v1
    s_nop 1
    v_cndmask_b32 v19, 0, v1, vcc
    v_mul_u32_u24 v19, 400, v19
    v_lshl_add_u32 v19, v2, 4, v19
    v_subrev_u32 v6, 192, v0
    v_and_b32 v6, 127, v6
    v_mul_u32_u24 v7, 43, v6
    v_lshrrev_b32 v7, 9, v7
    v_mul_u32_u24 v8, 12, v7
    v_sub_u32 v8, v6, v8
    s_lshl_b32 s27, s21, 2
    s_mul_i32 s53, s21, 192
    v_mul_u32_u24 v34, 4608, v7
    v_lshl_add_u32 v34, v8, 4, v34
    v_add_u32 v34, s53, v34
    v_mul_u32_u24 v9, 86, v8
    v_lshrrev_b32 v9, 8, v9
    v_mul_u32_u24 v35, 400, v9
    v_mul_u32_u24 v9, 3, v9
    v_sub_u32 v9, v8, v9
    v_lshl_add_u32 v35, v9, 4, v35
    v_mul_u32_u24 v9, 48, v7
    v_add_u32 v35, v35, v9
    v_add_u32 v35, 13568, v35
    v_cmp_gt_u32 vcc, 96, v6
    s_and_b64 s[100:101], vcc, s[48:49]
    v_add_u32 v36, s27, v1
    v_subrev_u32 v36, 8, v36
    v_mul_lo_u32 v36, v36, s26
    v_lshl_add_u32 v36, v2, 3, v36
    v_cmp_lt_u32 vcc, 7, v1
    v_cmp_gt_u32 s[74:75], 12, v1
    s_and_b64 s[12:13], vcc, s[74:75]
    v_lshlrev_b32 v7, 2, v2
    v_add_u32 v8, s27, v1
    v_sub_u32 v8, v8, v7
    v_mov_b32 v7, 1000
    v_cndmask_b32 v8, v7, v8, vcc
    v_cmp_lt_i32 s[76:77], v8, 0
    v_cmp_lt_i32 s[78:79], v8, 1
    v_cmp_lt_i32 s[80:81], v8, 2
    v_cmp_lt_i32 s[82:83], v8, 3
    v_cmp_lt_i32 s[84:85], v8, 16
    v_cmp_lt_i32 s[86:87], v8, 17
    v_cmp_lt_i32 s[88:89], v8, 18
    v_cmp_lt_i32 s[90:91], v8, 19
    v_cmp_lt_i32 s[92:93], v8, 32
    s_orn2_b64 s[92:93], s[92:93], s[64:65]
    v_cmp_lt_i32 s[94:95], v8, 33
    s_orn2_b64 s[94:95], s[94:95], s[64:65]
    v_cmp_lt_i32 s[96:97], v8, 34
    s_orn2_b64 s[96:97], s[96:97], s[64:65]
    v_cmp_lt_i32 s[98:99], v8, 35
    s_orn2_b64 s[98:99], s[98:99], s[64:65]
    v_mul_u32_u24 v15, 400, v1
    v_lshl_add_u32 v15, v2, 4, v15
    v_mul_u32_u24 v20, 112, v1
    v_lshl_add_u32 v20, v2, 3, v20
    v_mov_b32 v6, 0
    v_mov_b32 v7, 0
    v_mov_b32 v8, 0
    v_mov_b32 v9, 0
    v_cmp_gt_u32 vcc, 200, v0
    s_and_saveexec_b64 s[72:73], vcc
    ds_write_b128 v17, v[6:9] offset:31168
    s_mov_b64 exec, s[72:73]
    v_cmp_gt_u32 vcc, 192, v0
    s_and_saveexec_b64 s[72:73], vcc
    v_mul_u32_u24 v16, 112, v0
    ds_write_b128 v16, v[6:9] offset:34448
    s_mov_b64 exec, s[72:73]
    v_xor_b32 v31, 16, v3
    v_lshlrev_b32 v31, 2, v31
    v_xor_b32 v32, 32, v3
    v_lshlrev_b32 v32, 2, v32
    s_mul_i32 s27, s21, 20
    s_lshl_b32 s53, s24, 2
    s_add_u32 s27, s27, s53
    v_add_u32 v33, s27, v2
    v_lshlrev_b32 v33, 11, v33
    v_lshl_add_u32 v33, v1, 3, v33
    s_lshl_b32 s53, s20, 6
    s_add_u32 s53, s53, 0x60000
    s_lshr_b32 s52, s2, 3
    s_mul_i32 s52, s52, 5
    s_add_u32 s3, s52, s24
    s_lshl_b32 s52, s3, 11
    s_add_u32 s52, s52, 0x60000
    v_lshlrev_b32 v18, 4, v3
    v_mov_b32 v24, 0
    v_mov_b32 v25, 0
    v_mov_b32 v26, 0
    v_mov_b32 v27, 0
    v_cmp_eq_u32 vcc, 0, v1
    v_mov_b32 v6, 0x3f80
    s_nop 0
    v_cndmask_b32 v24, v24, v6, vcc
    v_cmp_eq_u32 vcc, 1, v1
    v_mov_b32 v6, 0x3f800000
    s_nop 0
    v_cndmask_b32 v24, v24, v6, vcc
    v_cmp_eq_u32 vcc, 2, v1
    v_mov_b32 v6, 0x3f80
    s_nop 0
    v_cndmask_b32 v25, v25, v6, vcc
    v_cmp_eq_u32 vcc, 3, v1
    v_mov_b32 v6, 0x3f800000
    s_nop 0
    v_cndmask_b32 v25, v25, v6, vcc
    v_cmp_eq_u32 vcc, 4, v1
    v_mov_b32 v6, 0x3f80
    s_nop 0
    v_cndmask_b32 v26, v26, v6, vcc
    v_cmp_eq_u32 vcc, 5, v1
    v_mov_b32 v6, 0x3f800000
    s_nop 0
    v_cndmask_b32 v26, v26, v6, vcc
    v_cmp_eq_u32 vcc, 6, v1
    v_mov_b32 v6, 0x3f80
    s_nop 0
    v_cndmask_b32 v27, v27, v6, vcc
    v_cmp_eq_u32 vcc, 7, v1
    v_mov_b32 v6, 0x3f800000
    s_nop 0
    v_cndmask_b32 v27, v27, v6, vcc
    v_lshlrev_b32 v41, 1, v1
    v_add_u32 v41, v41, v2
    v_lshlrev_b32 v41, 3, v41
    s_lshl_b32 s54, s3, 6
    s_and_b32 s55, s2, 7
    s_mul_i32 s55, s55, 10240
    s_add_u32 s55, s55, 0x4a000
    s_add_u32 s56, s55, 5120
    s_add_u32 s54, s54, s55
    s_add_u32 s50, s51, 5120
    s_lshl_b32 s58, s57, 1
    s_lshl_b32 s59, s57, 6
    v_cmp_gt_u32 s[62:63], 8, v1
    v_cmp_gt_u32 s[64:65], 2, v2
    v_cmp_gt_u32 vcc, 256, v0
    s_mov_b64 s[66:67], vcc
    s_mov_b32 s60, 0
    s_mov_b32 s8, 0x3fb8aa3b
    s_mov_b32 s10, 0x3d93cd3a
    s_mov_b32 s11, 0x3d93cd3a
    v_xor_b32 v6, v2, v10
    v_mul_u32_u24 v4, 1280, v1
    v_lshl_add_u32 v4, v6, 4, v4
    v_xor_b32 v11, 64, v4
    v_add_u32 v4, 63488, v4
    v_add_u32 v11, 63488, v11
    s_mov_b32 s9, 40960
    v_lshlrev_b32 v45, 7, v3
    s_mov_b32 s37, 0x50000
    v_mul_u32_u24 v6, 52429, v0
    v_lshrrev_b32 v6, 22, v6
    v_mul_u32_u24 v7, 80, v6
    v_sub_u32 v7, v0, v7
    v_and_b32 v8, 7, v6
    v_xor_b32 v7, v7, v8
    v_mul_u32_u24 v16, 1280, v6
    v_lshl_add_u32 v16, v7, 4, v16
    v_xor_b32 v21, 64, v16
    v_lshl_add_u32 v6, v2, 2, s25
    v_cmp_lt_u32 vcc, 23, v6
    v_subrev_u32 v7, 24, v6
    s_nop 0
    v_cndmask_b32 v7, v6, v7, vcc
    v_cndmask_b32 v8, 0, 1, vcc
    v_mul_u32_u24 v8, 1536, v8
    v_lshl_add_u32 v8, v7, 1, v8
    v_mul_u32_u24 v7, 48, v1
    v_add_u32 v8, v8, v7
    v_lshlrev_b32 v7, 6, v37
    v_lshl_add_u32 v7, v2, 3, v7
    v_add_u32 v7, 3072, v7
    s_cmp_ge_u32 s24, 3
    s_cselect_b64 vcc, -1, 0
    s_nop 0
    v_cndmask_b32 v44, v8, v7, vcc
    s_mul_i32 s27, s21, 4608
    v_add_u32 v44, s27, v44
    s_mul_i32 s14, s20, 36864
    s_lshl_b32 s15, s24, 10
    v_cmp_gt_u32 s[18:19], 24, v37
    s_cmp_ge_u32 s24, 3
    s_cselect_b64 s[18:19], s[18:19], -1
    s_cselect_b32 s16, 32, 768
    v_mov_b32 v48, 0
    v_mov_b32 v49, 0
    ds_write_b64 v48, v[48:49] offset:62464
    ds_write_b64 v48, v[48:49] offset:62472
    s_waitcnt vmcnt(0) lgkmcnt(0)
    s_barrier
    s_mov_b32 s27, 0
    buffer_load_dword v50, v133, s[4:7], s27 offen offset:0
    buffer_load_dword v51, v133, s[4:7], s27 offen offset:2560
    s_mov_b32 s27, 20480
    buffer_load_dword v52, v133, s[4:7], s27 offen offset:0
    buffer_load_dword v53, v133, s[4:7], s27 offen offset:2560
    s_mov_b32 s27, 40960
    buffer_load_dword v54, v133, s[4:7], s27 offen offset:0
    buffer_load_dword v55, v133, s[4:7], s27 offen offset:2560
    s_mov_b32 s27, 61440
    buffer_load_dword v56, v133, s[4:7], s27 offen offset:0
    buffer_load_dword v57, v133, s[4:7], s27 offen offset:2560
    s_mov_b32 s27, 81920
    buffer_load_dword v58, v133, s[4:7], s27 offen offset:0
    buffer_load_dword v59, v133, s[4:7], s27 offen offset:2560
    s_mov_b32 s27, 102400
    buffer_load_dword v60, v133, s[4:7], s27 offen offset:0
    buffer_load_dword v61, v133, s[4:7], s27 offen offset:2560
    s_mov_b32 s27, 122880
    buffer_load_dword v62, v133, s[4:7], s27 offen offset:0
    buffer_load_dword v63, v133, s[4:7], s27 offen offset:2560
    s_mov_b32 s27, 143360
    buffer_load_dword v64, v133, s[4:7], s27 offen offset:0
    buffer_load_dword v65, v133, s[4:7], s27 offen offset:2560
    s_mov_b32 s27, 163840
    buffer_load_dword v66, v133, s[4:7], s27 offen offset:0
    buffer_load_dword v67, v133, s[4:7], s27 offen offset:2560
    s_mov_b32 s27, 184320
    buffer_load_dword v68, v133, s[4:7], s27 offen offset:0
    buffer_load_dword v69, v133, s[4:7], s27 offen offset:2560
    s_mov_b32 s27, 204800
    buffer_load_dword v70, v133, s[4:7], s27 offen offset:0
    buffer_load_dword v71, v133, s[4:7], s27 offen offset:2560
    s_mov_b32 s27, 225280
    buffer_load_dword v72, v133, s[4:7], s27 offen offset:0
    buffer_load_dword v73, v133, s[4:7], s27 offen offset:2560
    s_mov_b32 s73, s14
    s_cmp_ge_u32 s24, 3
    s_cbranch_scc1 L_xp_swp0
    ds_read_b128 v[74:77], v4 offset:0
    ds_read_b128 v[78:81], v4 offset:20480
    ds_read_b128 v[82:85], v11 offset:0
    ds_read_b128 v[86:89], v11 offset:20480
    ds_read_b128 v[90:93], v4 offset:128
    ds_read_b128 v[94:97], v4 offset:20608
    ds_read_b128 v[98:101], v11 offset:128
    ds_read_b128 v[102:105], v11 offset:20608
    ds_read_b128 v[106:109], v4 offset:256
    ds_read_b128 v[110:113], v4 offset:20736
    s_waitcnt lgkmcnt(9)
    v_mfma_f32_16x16x32_bf16 v[122:125], a[0:3], v[74:77], 0
    ds_read_b128 v[74:77], v11 offset:256
    s_waitcnt lgkmcnt(9)
    v_mfma_f32_16x16x32_bf16 v[126:129], a[0:3], v[78:81], 0
    ds_read_b128 v[78:81], v11 offset:20736
    s_waitcnt lgkmcnt(9)
    v_mfma_f32_16x16x32_bf16 v[122:125], a[4:7], v[82:85], v[122:125]
    ds_read_b128 v[82:85], v4 offset:384
    s_waitcnt lgkmcnt(9)
    v_mfma_f32_16x16x32_bf16 v[126:129], a[4:7], v[86:89], v[126:129]
    ds_read_b128 v[86:89], v4 offset:20864
    s_waitcnt lgkmcnt(9)
    v_mfma_f32_16x16x32_bf16 v[122:125], a[8:11], v[90:93], v[122:125]
    ds_read_b128 v[90:93], v11 offset:384
    s_waitcnt lgkmcnt(9)
    v_mfma_f32_16x16x32_bf16 v[126:129], a[8:11], v[94:97], v[126:129]
    ds_read_b128 v[94:97], v11 offset:20864
    s_waitcnt lgkmcnt(9)
    v_mfma_f32_16x16x32_bf16 v[122:125], a[12:15], v[98:101], v[122:125]
    ds_read_b128 v[98:101], v4 offset:512
    s_waitcnt lgkmcnt(9)
    v_mfma_f32_16x16x32_bf16 v[126:129], a[12:15], v[102:105], v[126:129]
    ds_read_b128 v[102:105], v4 offset:20992
    s_waitcnt lgkmcnt(9)
    v_mfma_f32_16x16x32_bf16 v[122:125], a[16:19], v[106:109], v[122:125]
    ds_read_b128 v[106:109], v11 offset:512
    s_waitcnt lgkmcnt(9)
    v_mfma_f32_16x16x32_bf16 v[126:129], a[16:19], v[110:113], v[126:129]
    ds_read_b128 v[110:113], v11 offset:20992
    s_waitcnt lgkmcnt(9)
    v_mfma_f32_16x16x32_bf16 v[122:125], a[20:23], v[74:77], v[122:125]
    ds_read_b128 v[74:77], v4 offset:640
    s_waitcnt lgkmcnt(9)
    v_mfma_f32_16x16x32_bf16 v[126:129], a[20:23], v[78:81], v[126:129]
    ds_read_b128 v[78:81], v4 offset:21120
    s_waitcnt lgkmcnt(9)
    v_mfma_f32_16x16x32_bf16 v[122:125], a[24:27], v[82:85], v[122:125]
    ds_read_b128 v[82:85], v11 offset:640
    s_waitcnt lgkmcnt(9)
    v_mfma_f32_16x16x32_bf16 v[126:129], a[24:27], v[86:89], v[126:129]
    ds_read_b128 v[86:89], v11 offset:21120
    s_waitcnt lgkmcnt(9)
    v_mfma_f32_16x16x32_bf16 v[122:125], a[28:31], v[90:93], v[122:125]
    ds_read_b128 v[90:93], v4 offset:768
    s_waitcnt lgkmcnt(9)
    v_mfma_f32_16x16x32_bf16 v[126:129], a[28:31], v[94:97], v[126:129]
    ds_read_b128 v[94:97], v4 offset:21248
    s_waitcnt lgkmcnt(9)
    v_mfma_f32_16x16x32_bf16 v[122:125], a[32:35], v[98:101], v[122:125]
    ds_read_b128 v[98:101], v11 offset:768
    s_waitcnt lgkmcnt(9)
    v_mfma_f32_16x16x32_bf16 v[126:129], a[32:35], v[102:105], v[126:129]
    ds_read_b128 v[102:105], v11 offset:21248
    s_waitcnt lgkmcnt(9)
    v_mfma_f32_16x16x32_bf16 v[122:125], a[36:39], v[106:109], v[122:125]
    ds_read_b128 v[106:109], v4 offset:896
    s_waitcnt lgkmcnt(9)
    v_mfma_f32_16x16x32_bf16 v[126:129], a[36:39], v[110:113], v[126:129]
    ds_read_b128 v[110:113], v4 offset:21376
    s_waitcnt lgkmcnt(9)
    v_mfma_f32_16x16x32_bf16 v[122:125], a[40:43], v[74:77], v[122:125]
    ds_read_b128 v[74:77], v11 offset:896
    s_waitcnt lgkmcnt(9)
    v_mfma_f32_16x16x32_bf16 v[126:129], a[40:43], v[78:81], v[126:129]
    ds_read_b128 v[78:81], v11 offset:21376
    s_waitcnt lgkmcnt(9)
    v_mfma_f32_16x16x32_bf16 v[122:125], a[44:47], v[82:85], v[122:125]
    ds_read_b128 v[82:85], v4 offset:1024
    s_waitcnt lgkmcnt(9)
    v_mfma_f32_16x16x32_bf16 v[126:129], a[44:47], v[86:89], v[126:129]
    ds_read_b128 v[86:89], v4 offset:21504
    s_waitcnt lgkmcnt(9)
    v_mfma_f32_16x16x32_bf16 v[122:125], a[48:51], v[90:93], v[122:125]
    ds_read_b128 v[90:93], v11 offset:1024
    s_waitcnt lgkmcnt(9)
    v_mfma_f32_16x16x32_bf16 v[126:129], a[48:51], v[94:97], v[126:129]
    ds_read_b128 v[94:97], v11 offset:21504
    s_waitcnt lgkmcnt(9)
    v_mfma_f32_16x16x32_bf16 v[122:125], a[52:55], v[98:101], v[122:125]
    ds_read_b128 v[98:101], v4 offset:1152
    s_waitcnt lgkmcnt(9)
    v_mfma_f32_16x16x32_bf16 v[126:129], a[52:55], v[102:105], v[126:129]
    ds_read_b128 v[102:105], v4 offset:21632
    s_waitcnt lgkmcnt(9)
    v_mfma_f32_16x16x32_bf16 v[122:125], a[56:59], v[106:109], v[122:125]
    ds_read_b128 v[106:109], v11 offset:1152
    s_waitcnt lgkmcnt(9)
    v_mfma_f32_16x16x32_bf16 v[126:129], a[56:59], v[110:113], v[126:129]
    ds_read_b128 v[110:113], v11 offset:21632
    s_waitcnt lgkmcnt(9)
    v_mfma_f32_16x16x32_bf16 v[122:125], a[60:63], v[74:77], v[122:125]
    s_waitcnt lgkmcnt(8)
    v_mfma_f32_16x16x32_bf16 v[126:129], a[60:63], v[78:81], v[126:129]
    s_waitcnt lgkmcnt(7)
    v_mfma_f32_16x16x32_bf16 v[122:125], a[64:67], v[82:85], v[122:125]
    s_waitcnt lgkmcnt(6)
    v_mfma_f32_16x16x32_bf16 v[126:129], a[64:67], v[86:89], v[126:129]
    s_waitcnt lgkmcnt(5)
    v_mfma_f32_16x16x32_bf16 v[122:125], a[68:71], v[90:93], v[122:125]
    s_waitcnt lgkmcnt(4)
    v_mfma_f32_16x16x32_bf16 v[126:129], a[68:71], v[94:97], v[126:129]
    s_waitcnt lgkmcnt(3)
    v_mfma_f32_16x16x32_bf16 v[122:125], a[72:75], v[98:101], v[122:125]
    s_waitcnt lgkmcnt(2)
    v_mfma_f32_16x16x32_bf16 v[126:129], a[72:75], v[102:105], v[126:129]
    s_waitcnt lgkmcnt(1)
    v_mfma_f32_16x16x32_bf16 v[122:125], a[76:79], v[106:109], v[122:125]
    s_waitcnt lgkmcnt(0)
    v_mfma_f32_16x16x32_bf16 v[126:129], a[76:79], v[110:113], v[126:129]
    s_nop 7
    v_cvt_pk_bf16_f32 v6, v122, v123
    v_cvt_pk_bf16_f32 v7, v124, v125
    v_cvt_pk_bf16_f32 v8, v126, v127
    v_cvt_pk_bf16_f32 v9, v128, v129
    s_branch L_xp_donep0
L_xp_swp0:
    ds_read_b128 v[74:77], v4 offset:0
    ds_read_b128 v[78:81], v4 offset:20480
    ds_read_b128 v[82:85], v11 offset:0
    ds_read_b128 v[86:89], v11 offset:20480
    ds_read_b128 v[90:93], v4 offset:128
    ds_read_b128 v[94:97], v4 offset:20608
    ds_read_b128 v[98:101], v11 offset:128
    ds_read_b128 v[102:105], v11 offset:20608
    ds_read_b128 v[106:109], v4 offset:256
    ds_read_b128 v[110:113], v4 offset:20736
    s_waitcnt lgkmcnt(9)
    v_mfma_f32_16x16x32_bf16 v[122:125], v[74:77], a[0:3], 0
    ds_read_b128 v[74:77], v11 offset:256
    s_waitcnt lgkmcnt(9)
    v_mfma_f32_16x16x32_bf16 v[126:129], v[78:81], a[0:3], 0
    ds_read_b128 v[78:81], v11 offset:20736
    s_waitcnt lgkmcnt(9)
    v_mfma_f32_16x16x32_bf16 v[122:125], v[82:85], a[4:7], v[122:125]
    ds_read_b128 v[82:85], v4 offset:384
    s_waitcnt lgkmcnt(9)
    v_mfma_f32_16x16x32_bf16 v[126:129], v[86:89], a[4:7], v[126:129]
    ds_read_b128 v[86:89], v4 offset:20864
    s_waitcnt lgkmcnt(9)
    v_mfma_f32_16x16x32_bf16 v[122:125], v[90:93], a[8:11], v[122:125]
    ds_read_b128 v[90:93], v11 offset:384
    s_waitcnt lgkmcnt(9)
    v_mfma_f32_16x16x32_bf16 v[126:129], v[94:97], a[8:11], v[126:129]
    ds_read_b128 v[94:97], v11 offset:20864
    s_waitcnt lgkmcnt(9)
    v_mfma_f32_16x16x32_bf16 v[122:125], v[98:101], a[12:15], v[122:125]
    ds_read_b128 v[98:101], v4 offset:512
    s_waitcnt lgkmcnt(9)
    v_mfma_f32_16x16x32_bf16 v[126:129], v[102:105], a[12:15], v[126:129]
    ds_read_b128 v[102:105], v4 offset:20992
    s_waitcnt lgkmcnt(9)
    v_mfma_f32_16x16x32_bf16 v[122:125], v[106:109], a[16:19], v[122:125]
    ds_read_b128 v[106:109], v11 offset:512
    s_waitcnt lgkmcnt(9)
    v_mfma_f32_16x16x32_bf16 v[126:129], v[110:113], a[16:19], v[126:129]
    ds_read_b128 v[110:113], v11 offset:20992
    s_waitcnt lgkmcnt(9)
    v_mfma_f32_16x16x32_bf16 v[122:125], v[74:77], a[20:23], v[122:125]
    ds_read_b128 v[74:77], v4 offset:640
    s_waitcnt lgkmcnt(9)
    v_mfma_f32_16x16x32_bf16 v[126:129], v[78:81], a[20:23], v[126:129]
    ds_read_b128 v[78:81], v4 offset:21120
    s_waitcnt lgkmcnt(9)
    v_mfma_f32_16x16x32_bf16 v[122:125], v[82:85], a[24:27], v[122:125]
    ds_read_b128 v[82:85], v11 offset:640
    s_waitcnt lgkmcnt(9)
    v_mfma_f32_16x16x32_bf16 v[126:129], v[86:89], a[24:27], v[126:129]
    ds_read_b128 v[86:89], v11 offset:21120
    s_waitcnt lgkmcnt(9)
    v_mfma_f32_16x16x32_bf16 v[122:125], v[90:93], a[28:31], v[122:125]
    ds_read_b128 v[90:93], v4 offset:768
    s_waitcnt lgkmcnt(9)
    v_mfma_f32_16x16x32_bf16 v[126:129], v[94:97], a[28:31], v[126:129]
    ds_read_b128 v[94:97], v4 offset:21248
    s_waitcnt lgkmcnt(9)
    v_mfma_f32_16x16x32_bf16 v[122:125], v[98:101], a[32:35], v[122:125]
    ds_read_b128 v[98:101], v11 offset:768
    s_waitcnt lgkmcnt(9)
    v_mfma_f32_16x16x32_bf16 v[126:129], v[102:105], a[32:35], v[126:129]
    ds_read_b128 v[102:105], v11 offset:21248
    s_waitcnt lgkmcnt(9)
    v_mfma_f32_16x16x32_bf16 v[122:125], v[106:109], a[36:39], v[122:125]
    ds_read_b128 v[106:109], v4 offset:896
    s_waitcnt lgkmcnt(9)
    v_mfma_f32_16x16x32_bf16 v[126:129], v[110:113], a[36:39], v[126:129]
    ds_read_b128 v[110:113], v4 offset:21376
    s_waitcnt lgkmcnt(9)
    v_mfma_f32_16x16x32_bf16 v[122:125], v[74:77], a[40:43], v[122:125]
    ds_read_b128 v[74:77], v11 offset:896
    s_waitcnt lgkmcnt(9)
    v_mfma_f32_16x16x32_bf16 v[126:129], v[78:81], a[40:43], v[126:129]
    ds_read_b128 v[78:81], v11 offset:21376
    s_waitcnt lgkmcnt(9)
    v_mfma_f32_16x16x32_bf16 v[122:125], v[82:85], a[44:47], v[122:125]
    ds_read_b128 v[82:85], v4 offset:1024
    s_waitcnt lgkmcnt(9)
    v_mfma_f32_16x16x32_bf16 v[126:129], v[86:89], a[44:47], v[126:129]
    ds_read_b128 v[86:89], v4 offset:21504
    s_waitcnt lgkmcnt(9)
    v_mfma_f32_16x16x32_bf16 v[122:125], v[90:93], a[48:51], v[122:125]
    ds_read_b128 v[90:93], v11 offset:1024
    s_waitcnt lgkmcnt(9)
    v_mfma_f32_16x16x32_bf16 v[126:129], v[94:97], a[48:51], v[126:129]
    ds_read_b128 v[94:97], v11 offset:21504
    s_waitcnt lgkmcnt(9)
    v_mfma_f32_16x16x32_bf16 v[122:125], v[98:101], a[52:55], v[122:125]
    ds_read_b128 v[98:101], v4 offset:1152
    s_waitcnt lgkmcnt(9)
    v_mfma_f32_16x16x32_bf16 v[126:129], v[102:105], a[52:55], v[126:129]
    ds_read_b128 v[102:105], v4 offset:21632
    s_waitcnt lgkmcnt(9)
    v_mfma_f32_16x16x32_bf16 v[122:125], v[106:109], a[56:59], v[122:125]
    ds_read_b128 v[106:109], v11 offset:1152
    s_waitcnt lgkmcnt(9)
    v_mfma_f32_16x16x32_bf16 v[126:129], v[110:113], a[56:59], v[126:129]
    ds_read_b128 v[110:113], v11 offset:21632
    s_waitcnt lgkmcnt(9)
    v_mfma_f32_16x16x32_bf16 v[122:125], v[74:77], a[60:63], v[122:125]
    s_waitcnt lgkmcnt(8)
    v_mfma_f32_16x16x32_bf16 v[126:129], v[78:81], a[60:63], v[126:129]
    s_waitcnt lgkmcnt(7)
    v_mfma_f32_16x16x32_bf16 v[122:125], v[82:85], a[64:67], v[122:125]
    s_waitcnt lgkmcnt(6)
    v_mfma_f32_16x16x32_bf16 v[126:129], v[86:89], a[64:67], v[126:129]
    s_waitcnt lgkmcnt(5)
    v_mfma_f32_16x16x32_bf16 v[122:125], v[90:93], a[68:71], v[122:125]
    s_waitcnt lgkmcnt(4)
    v_mfma_f32_16x16x32_bf16 v[126:129], v[94:97], a[68:71], v[126:129]
    s_waitcnt lgkmcnt(3)
    v_mfma_f32_16x16x32_bf16 v[122:125], v[98:101], a[72:75], v[122:125]
    s_waitcnt lgkmcnt(2)
    v_mfma_f32_16x16x32_bf16 v[126:129], v[102:105], a[72:75], v[126:129]
    s_waitcnt lgkmcnt(1)
    v_mfma_f32_16x16x32_bf16 v[122:125], v[106:109], a[76:79], v[122:125]
    s_waitcnt lgkmcnt(0)
    v_mfma_f32_16x16x32_bf16 v[126:129], v[110:113], a[76:79], v[126:129]
    s_nop 7
    v_cvt_pk_bf16_f32 v6, v122, v123
    v_cvt_pk_bf16_f32 v7, v124, v125
    v_cvt_pk_bf16_f32 v8, v126, v127
    v_cvt_pk_bf16_f32 v9, v128, v129
L_xp_donep0:
    v_add_u32 v4, s9, v4
    v_add_u32 v11, s9, v11
    s_sub_u32 s9, 0, s9
    s_add_u32 s17, s73, s16
    s_mov_b64 exec, s[18:19]
    buffer_store_dwordx2 v[6:7], v44, s[28:31], s73 offen sc1
    buffer_store_dwordx2 v[8:9], v44, s[28:31], s17 offen sc1
    s_mov_b64 exec, -1
    s_waitcnt vmcnt(0)
    s_and_b32 s27, s2, 7
    s_mul_i32 s27, s27, 640
    s_add_u32 s27, s27, 0x48000
    s_lshl_b32 s75, s3, 2
    s_add_u32 s75, s75, s27
    s_getreg_b32 s38, hwreg(HW_REG_XCC_ID)
    s_and_b32 s38, s38, 15
    s_add_u32 s38, s38, 1
    v_mov_b32 v134, 0
    v_mov_b32 v135, s38
    s_waitcnt vmcnt(0)
    s_mov_b64 exec, 1
    buffer_store_dword v135, v134, s[44:47], s75 offen sc1
    s_mov_b64 exec, -1
    v_mov_b32_dpp v132, v50 quad_perm:[1,0,3,2] row_mask:0xf bank_mask:0xf
    v_perm_b32 v50, v50, v132, v131
    v_accvgpr_write_b32 a80, v50
    v_mov_b32_dpp v132, v51 quad_perm:[1,0,3,2] row_mask:0xf bank_mask:0xf
    v_perm_b32 v51, v51, v132, v131
    v_accvgpr_write_b32 a81, v51
    v_mov_b32_dpp v132, v52 quad_perm:[1,0,3,2] row_mask:0xf bank_mask:0xf
    v_perm_b32 v52, v52, v132, v131
    v_accvgpr_write_b32 a82, v52
    v_mov_b32_dpp v132, v53 quad_perm:[1,0,3,2] row_mask:0xf bank_mask:0xf
    v_perm_b32 v53, v53, v132, v131
    v_accvgpr_write_b32 a83, v53
    v_mov_b32_dpp v132, v54 quad_perm:[1,0,3,2] row_mask:0xf bank_mask:0xf
    v_perm_b32 v54, v54, v132, v131
    v_accvgpr_write_b32 a84, v54
    v_mov_b32_dpp v132, v55 quad_perm:[1,0,3,2] row_mask:0xf bank_mask:0xf
    v_perm_b32 v55, v55, v132, v131
    v_accvgpr_write_b32 a85, v55
    v_mov_b32_dpp v132, v56 quad_perm:[1,0,3,2] row_mask:0xf bank_mask:0xf
    v_perm_b32 v56, v56, v132, v131
    v_accvgpr_write_b32 a86, v56
    v_mov_b32_dpp v132, v57 quad_perm:[1,0,3,2] row_mask:0xf bank_mask:0xf
    v_perm_b32 v57, v57, v132, v131
    v_accvgpr_write_b32 a87, v57
    v_mov_b32_dpp v132, v58 quad_perm:[1,0,3,2] row_mask:0xf bank_mask:0xf
    v_perm_b32 v58, v58, v132, v131
    v_accvgpr_write_b32 a88, v58
    v_mov_b32_dpp v132, v59 quad_perm:[1,0,3,2] row_mask:0xf bank_mask:0xf
    v_perm_b32 v59, v59, v132, v131
    v_accvgpr_write_b32 a89, v59
    v_mov_b32_dpp v132, v60 quad_perm:[1,0,3,2] row_mask:0xf bank_mask:0xf
    v_perm_b32 v60, v60, v132, v131
    v_accvgpr_write_b32 a90, v60
    v_mov_b32_dpp v132, v61 quad_perm:[1,0,3,2] row_mask:0xf bank_mask:0xf
    v_perm_b32 v61, v61, v132, v131
    v_accvgpr_write_b32 a91, v61
    v_mov_b32_dpp v132, v62 quad_perm:[1,0,3,2] row_mask:0xf bank_mask:0xf
    v_perm_b32 v62, v62, v132, v131
    v_accvgpr_write_b32 a92, v62
    v_mov_b32_dpp v132, v63 quad_perm:[1,0,3,2] row_mask:0xf bank_mask:0xf
    v_perm_b32 v63, v63, v132, v131
    v_accvgpr_write_b32 a93, v63
    v_mov_b32_dpp v132, v64 quad_perm:[1,0,3,2] row_mask:0xf bank_mask:0xf
    v_perm_b32 v64, v64, v132, v131
    v_accvgpr_write_b32 a94, v64
    v_mov_b32_dpp v132, v65 quad_perm:[1,0,3,2] row_mask:0xf bank_mask:0xf
    v_perm_b32 v65, v65, v132, v131
    v_accvgpr_write_b32 a95, v65
    v_mov_b32_dpp v132, v66 quad_perm:[1,0,3,2] row_mask:0xf bank_mask:0xf
    v_perm_b32 v66, v66, v132, v131
    v_accvgpr_write_b32 a96, v66
    v_mov_b32_dpp v132, v67 quad_perm:[1,0,3,2] row_mask:0xf bank_mask:0xf
    v_perm_b32 v67, v67, v132, v131
    v_accvgpr_write_b32 a97, v67
    v_mov_b32_dpp v132, v68 quad_perm:[1,0,3,2] row_mask:0xf bank_mask:0xf
    v_perm_b32 v68, v68, v132, v131
    v_accvgpr_write_b32 a98, v68
    v_mov_b32_dpp v132, v69 quad_perm:[1,0,3,2] row_mask:0xf bank_mask:0xf
    v_perm_b32 v69, v69, v132, v131
    v_accvgpr_write_b32 a99, v69
    v_mov_b32_dpp v132, v70 quad_perm:[1,0,3,2] row_mask:0xf bank_mask:0xf
    v_perm_b32 v70, v70, v132, v131
    v_accvgpr_write_b32 a100, v70
    v_mov_b32_dpp v132, v71 quad_perm:[1,0,3,2] row_mask:0xf bank_mask:0xf
    v_perm_b32 v71, v71, v132, v131
    v_accvgpr_write_b32 a101, v71
    v_mov_b32_dpp v132, v72 quad_perm:[1,0,3,2] row_mask:0xf bank_mask:0xf
    v_perm_b32 v72, v72, v132, v131
    v_accvgpr_write_b32 a102, v72
    v_mov_b32_dpp v132, v73 quad_perm:[1,0,3,2] row_mask:0xf bank_mask:0xf
    v_perm_b32 v73, v73, v132, v131
    v_accvgpr_write_b32 a103, v73
    buffer_store_dwordx2 v[50:51], v130, s[68:71], 0 offen offset:0
    buffer_store_dwordx2 v[52:53], v130, s[68:71], 0 offen offset:32
    buffer_store_dwordx2 v[54:55], v130, s[68:71], 0 offen offset:64
    buffer_store_dwordx2 v[56:57], v130, s[68:71], 0 offen offset:96
    buffer_store_dwordx2 v[58:59], v130, s[68:71], 0 offen offset:128
    buffer_store_dwordx2 v[60:61], v130, s[68:71], 0 offen offset:160
    buffer_store_dwordx2 v[62:63], v130, s[68:71], 0 offen offset:192
    buffer_store_dwordx2 v[64:65], v130, s[68:71], 0 offen offset:224
    buffer_store_dwordx2 v[66:67], v130, s[68:71], 0 offen offset:256
    buffer_store_dwordx2 v[68:69], v130, s[68:71], 0 offen offset:288
    buffer_store_dwordx2 v[70:71], v130, s[68:71], 0 offen offset:320
    buffer_store_dwordx2 v[72:73], v130, s[68:71], 0 offen offset:352
    s_add_u32 s73, s14, 1179648
    s_cmp_ge_u32 s24, 3
    s_cbranch_scc1 L_xp_swp1
    ds_read_b128 v[74:77], v4 offset:0
    ds_read_b128 v[78:81], v4 offset:20480
    ds_read_b128 v[82:85], v11 offset:0
    ds_read_b128 v[86:89], v11 offset:20480
    ds_read_b128 v[90:93], v4 offset:128
    ds_read_b128 v[94:97], v4 offset:20608
    ds_read_b128 v[98:101], v11 offset:128
    ds_read_b128 v[102:105], v11 offset:20608
    ds_read_b128 v[106:109], v4 offset:256
    ds_read_b128 v[110:113], v4 offset:20736
    s_waitcnt lgkmcnt(9)
    v_mfma_f32_16x16x32_bf16 v[122:125], a[0:3], v[74:77], 0
    ds_read_b128 v[74:77], v11 offset:256
    s_waitcnt lgkmcnt(9)
    v_mfma_f32_16x16x32_bf16 v[126:129], a[0:3], v[78:81], 0
    ds_read_b128 v[78:81], v11 offset:20736
    s_waitcnt lgkmcnt(9)
    v_mfma_f32_16x16x32_bf16 v[122:125], a[4:7], v[82:85], v[122:125]
    ds_read_b128 v[82:85], v4 offset:384
    s_waitcnt lgkmcnt(9)
    v_mfma_f32_16x16x32_bf16 v[126:129], a[4:7], v[86:89], v[126:129]
    ds_read_b128 v[86:89], v4 offset:20864
    s_waitcnt lgkmcnt(9)
    v_mfma_f32_16x16x32_bf16 v[122:125], a[8:11], v[90:93], v[122:125]
    ds_read_b128 v[90:93], v11 offset:384
    s_waitcnt lgkmcnt(9)
    v_mfma_f32_16x16x32_bf16 v[126:129], a[8:11], v[94:97], v[126:129]
    ds_read_b128 v[94:97], v11 offset:20864
    s_waitcnt lgkmcnt(9)
    v_mfma_f32_16x16x32_bf16 v[122:125], a[12:15], v[98:101], v[122:125]
    ds_read_b128 v[98:101], v4 offset:512
    s_waitcnt lgkmcnt(9)
    v_mfma_f32_16x16x32_bf16 v[126:129], a[12:15], v[102:105], v[126:129]
    ds_read_b128 v[102:105], v4 offset:20992
    s_waitcnt lgkmcnt(9)
    v_mfma_f32_16x16x32_bf16 v[122:125], a[16:19], v[106:109], v[122:125]
    ds_read_b128 v[106:109], v11 offset:512
    s_waitcnt lgkmcnt(9)
    v_mfma_f32_16x16x32_bf16 v[126:129], a[16:19], v[110:113], v[126:129]
    ds_read_b128 v[110:113], v11 offset:20992
    s_waitcnt lgkmcnt(9)
    v_mfma_f32_16x16x32_bf16 v[122:125], a[20:23], v[74:77], v[122:125]
    ds_read_b128 v[74:77], v4 offset:640
    s_waitcnt lgkmcnt(9)
    v_mfma_f32_16x16x32_bf16 v[126:129], a[20:23], v[78:81], v[126:129]
    ds_read_b128 v[78:81], v4 offset:21120
    s_waitcnt lgkmcnt(9)
    v_mfma_f32_16x16x32_bf16 v[122:125], a[24:27], v[82:85], v[122:125]
    ds_read_b128 v[82:85], v11 offset:640
    s_waitcnt lgkmcnt(9)
    v_mfma_f32_16x16x32_bf16 v[126:129], a[24:27], v[86:89], v[126:129]
    ds_read_b128 v[86:89], v11 offset:21120
    s_waitcnt lgkmcnt(9)
    v_mfma_f32_16x16x32_bf16 v[122:125], a[28:31], v[90:93], v[122:125]
    ds_read_b128 v[90:93], v4 offset:768
    s_waitcnt lgkmcnt(9)
    v_mfma_f32_16x16x32_bf16 v[126:129], a[28:31], v[94:97], v[126:129]
    ds_read_b128 v[94:97], v4 offset:21248
    s_waitcnt lgkmcnt(9)
    v_mfma_f32_16x16x32_bf16 v[122:125], a[32:35], v[98:101], v[122:125]
    ds_read_b128 v[98:101], v11 offset:768
    s_waitcnt lgkmcnt(9)
    v_mfma_f32_16x16x32_bf16 v[126:129], a[32:35], v[102:105], v[126:129]
    ds_read_b128 v[102:105], v11 offset:21248
    s_waitcnt lgkmcnt(9)
    v_mfma_f32_16x16x32_bf16 v[122:125], a[36:39], v[106:109], v[122:125]
    ds_read_b128 v[106:109], v4 offset:896
    s_waitcnt lgkmcnt(9)
    v_mfma_f32_16x16x32_bf16 v[126:129], a[36:39], v[110:113], v[126:129]
    ds_read_b128 v[110:113], v4 offset:21376
    s_waitcnt lgkmcnt(9)
    v_mfma_f32_16x16x32_bf16 v[122:125], a[40:43], v[74:77], v[122:125]
    ds_read_b128 v[74:77], v11 offset:896
    s_waitcnt lgkmcnt(9)
    v_mfma_f32_16x16x32_bf16 v[126:129], a[40:43], v[78:81], v[126:129]
    ds_read_b128 v[78:81], v11 offset:21376
    s_waitcnt lgkmcnt(9)
    v_mfma_f32_16x16x32_bf16 v[122:125], a[44:47], v[82:85], v[122:125]
    ds_read_b128 v[82:85], v4 offset:1024
    s_waitcnt lgkmcnt(9)
    v_mfma_f32_16x16x32_bf16 v[126:129], a[44:47], v[86:89], v[126:129]
    ds_read_b128 v[86:89], v4 offset:21504
    s_waitcnt lgkmcnt(9)
    v_mfma_f32_16x16x32_bf16 v[122:125], a[48:51], v[90:93], v[122:125]
    ds_read_b128 v[90:93], v11 offset:1024
    s_waitcnt lgkmcnt(9)
    v_mfma_f32_16x16x32_bf16 v[126:129], a[48:51], v[94:97], v[126:129]
    ds_read_b128 v[94:97], v11 offset:21504
    s_waitcnt lgkmcnt(9)
    v_mfma_f32_16x16x32_bf16 v[122:125], a[52:55], v[98:101], v[122:125]
    ds_read_b128 v[98:101], v4 offset:1152
    s_waitcnt lgkmcnt(9)
    v_mfma_f32_16x16x32_bf16 v[126:129], a[52:55], v[102:105], v[126:129]
    ds_read_b128 v[102:105], v4 offset:21632
    s_waitcnt lgkmcnt(9)
    v_mfma_f32_16x16x32_bf16 v[122:125], a[56:59], v[106:109], v[122:125]
    ds_read_b128 v[106:109], v11 offset:1152
    s_waitcnt lgkmcnt(9)
    v_mfma_f32_16x16x32_bf16 v[126:129], a[56:59], v[110:113], v[126:129]
    ds_read_b128 v[110:113], v11 offset:21632
    s_waitcnt lgkmcnt(9)
    v_mfma_f32_16x16x32_bf16 v[122:125], a[60:63], v[74:77], v[122:125]
    s_waitcnt lgkmcnt(8)
    v_mfma_f32_16x16x32_bf16 v[126:129], a[60:63], v[78:81], v[126:129]
    s_waitcnt lgkmcnt(7)
    v_mfma_f32_16x16x32_bf16 v[122:125], a[64:67], v[82:85], v[122:125]
    s_waitcnt lgkmcnt(6)
    v_mfma_f32_16x16x32_bf16 v[126:129], a[64:67], v[86:89], v[126:129]
    s_waitcnt lgkmcnt(5)
    v_mfma_f32_16x16x32_bf16 v[122:125], a[68:71], v[90:93], v[122:125]
    s_waitcnt lgkmcnt(4)
    v_mfma_f32_16x16x32_bf16 v[126:129], a[68:71], v[94:97], v[126:129]
    s_waitcnt lgkmcnt(3)
    v_mfma_f32_16x16x32_bf16 v[122:125], a[72:75], v[98:101], v[122:125]
    s_waitcnt lgkmcnt(2)
    v_mfma_f32_16x16x32_bf16 v[126:129], a[72:75], v[102:105], v[126:129]
    s_waitcnt lgkmcnt(1)
    v_mfma_f32_16x16x32_bf16 v[122:125], a[76:79], v[106:109], v[122:125]
    s_waitcnt lgkmcnt(0)
    v_mfma_f32_16x16x32_bf16 v[126:129], a[76:79], v[110:113], v[126:129]
    s_nop 7
    v_cvt_pk_bf16_f32 v6, v122, v123
    v_cvt_pk_bf16_f32 v7, v124, v125
    v_cvt_pk_bf16_f32 v8, v126, v127
    v_cvt_pk_bf16_f32 v9, v128, v129
    s_branch L_xp_donep1
L_xp_swp1:
    ds_read_b128 v[74:77], v4 offset:0
    ds_read_b128 v[78:81], v4 offset:20480
    ds_read_b128 v[82:85], v11 offset:0
    ds_read_b128 v[86:89], v11 offset:20480
    ds_read_b128 v[90:93], v4 offset:128
    ds_read_b128 v[94:97], v4 offset:20608
    ds_read_b128 v[98:101], v11 offset:128
    ds_read_b128 v[102:105], v11 offset:20608
    ds_read_b128 v[106:109], v4 offset:256
    ds_read_b128 v[110:113], v4 offset:20736
    s_waitcnt lgkmcnt(9)
    v_mfma_f32_16x16x32_bf16 v[122:125], v[74:77], a[0:3], 0
    ds_read_b128 v[74:77], v11 offset:256
    s_waitcnt lgkmcnt(9)
    v_mfma_f32_16x16x32_bf16 v[126:129], v[78:81], a[0:3], 0
    ds_read_b128 v[78:81], v11 offset:20736
    s_waitcnt lgkmcnt(9)
    v_mfma_f32_16x16x32_bf16 v[122:125], v[82:85], a[4:7], v[122:125]
    ds_read_b128 v[82:85], v4 offset:384
    s_waitcnt lgkmcnt(9)
    v_mfma_f32_16x16x32_bf16 v[126:129], v[86:89], a[4:7], v[126:129]
    ds_read_b128 v[86:89], v4 offset:20864
    s_waitcnt lgkmcnt(9)
    v_mfma_f32_16x16x32_bf16 v[122:125], v[90:93], a[8:11], v[122:125]
    ds_read_b128 v[90:93], v11 offset:384
    s_waitcnt lgkmcnt(9)
    v_mfma_f32_16x16x32_bf16 v[126:129], v[94:97], a[8:11], v[126:129]
    ds_read_b128 v[94:97], v11 offset:20864
    s_waitcnt lgkmcnt(9)
    v_mfma_f32_16x16x32_bf16 v[122:125], v[98:101], a[12:15], v[122:125]
    ds_read_b128 v[98:101], v4 offset:512
    s_waitcnt lgkmcnt(9)
    v_mfma_f32_16x16x32_bf16 v[126:129], v[102:105], a[12:15], v[126:129]
    ds_read_b128 v[102:105], v4 offset:20992
    s_waitcnt lgkmcnt(9)
    v_mfma_f32_16x16x32_bf16 v[122:125], v[106:109], a[16:19], v[122:125]
    ds_read_b128 v[106:109], v11 offset:512
    s_waitcnt lgkmcnt(9)
    v_mfma_f32_16x16x32_bf16 v[126:129], v[110:113], a[16:19], v[126:129]
    ds_read_b128 v[110:113], v11 offset:20992
    s_waitcnt lgkmcnt(9)
    v_mfma_f32_16x16x32_bf16 v[122:125], v[74:77], a[20:23], v[122:125]
    ds_read_b128 v[74:77], v4 offset:640
    s_waitcnt lgkmcnt(9)
    v_mfma_f32_16x16x32_bf16 v[126:129], v[78:81], a[20:23], v[126:129]
    ds_read_b128 v[78:81], v4 offset:21120
    s_waitcnt lgkmcnt(9)
    v_mfma_f32_16x16x32_bf16 v[122:125], v[82:85], a[24:27], v[122:125]
    ds_read_b128 v[82:85], v11 offset:640
    s_waitcnt lgkmcnt(9)
    v_mfma_f32_16x16x32_bf16 v[126:129], v[86:89], a[24:27], v[126:129]
    ds_read_b128 v[86:89], v11 offset:21120
    s_waitcnt lgkmcnt(9)
    v_mfma_f32_16x16x32_bf16 v[122:125], v[90:93], a[28:31], v[122:125]
    ds_read_b128 v[90:93], v4 offset:768
    s_waitcnt lgkmcnt(9)
    v_mfma_f32_16x16x32_bf16 v[126:129], v[94:97], a[28:31], v[126:129]
    ds_read_b128 v[94:97], v4 offset:21248
    s_waitcnt lgkmcnt(9)
    v_mfma_f32_16x16x32_bf16 v[122:125], v[98:101], a[32:35], v[122:125]
    ds_read_b128 v[98:101], v11 offset:768
    s_waitcnt lgkmcnt(9)
    v_mfma_f32_16x16x32_bf16 v[126:129], v[102:105], a[32:35], v[126:129]
    ds_read_b128 v[102:105], v11 offset:21248
    s_waitcnt lgkmcnt(9)
    v_mfma_f32_16x16x32_bf16 v[122:125], v[106:109], a[36:39], v[122:125]
    ds_read_b128 v[106:109], v4 offset:896
    s_waitcnt lgkmcnt(9)
    v_mfma_f32_16x16x32_bf16 v[126:129], v[110:113], a[36:39], v[126:129]
    ds_read_b128 v[110:113], v4 offset:21376
    s_waitcnt lgkmcnt(9)
    v_mfma_f32_16x16x32_bf16 v[122:125], v[74:77], a[40:43], v[122:125]
    ds_read_b128 v[74:77], v11 offset:896
    s_waitcnt lgkmcnt(9)
    v_mfma_f32_16x16x32_bf16 v[126:129], v[78:81], a[40:43], v[126:129]
    ds_read_b128 v[78:81], v11 offset:21376
    s_waitcnt lgkmcnt(9)
    v_mfma_f32_16x16x32_bf16 v[122:125], v[82:85], a[44:47], v[122:125]
    ds_read_b128 v[82:85], v4 offset:1024
    s_waitcnt lgkmcnt(9)
    v_mfma_f32_16x16x32_bf16 v[126:129], v[86:89], a[44:47], v[126:129]
    ds_read_b128 v[86:89], v4 offset:21504
    s_waitcnt lgkmcnt(9)
    v_mfma_f32_16x16x32_bf16 v[122:125], v[90:93], a[48:51], v[122:125]
    ds_read_b128 v[90:93], v11 offset:1024
    s_waitcnt lgkmcnt(9)
    v_mfma_f32_16x16x32_bf16 v[126:129], v[94:97], a[48:51], v[126:129]
    ds_read_b128 v[94:97], v11 offset:21504
    s_waitcnt lgkmcnt(9)
    v_mfma_f32_16x16x32_bf16 v[122:125], v[98:101], a[52:55], v[122:125]
    ds_read_b128 v[98:101], v4 offset:1152
    s_waitcnt lgkmcnt(9)
    v_mfma_f32_16x16x32_bf16 v[126:129], v[102:105], a[52:55], v[126:129]
    ds_read_b128 v[102:105], v4 offset:21632
    s_waitcnt lgkmcnt(9)
    v_mfma_f32_16x16x32_bf16 v[122:125], v[106:109], a[56:59], v[122:125]
    ds_read_b128 v[106:109], v11 offset:1152
    s_waitcnt lgkmcnt(9)
    v_mfma_f32_16x16x32_bf16 v[126:129], v[110:113], a[56:59], v[126:129]
    ds_read_b128 v[110:113], v11 offset:21632
    s_waitcnt lgkmcnt(9)
    v_mfma_f32_16x16x32_bf16 v[122:125], v[74:77], a[60:63], v[122:125]
    s_waitcnt lgkmcnt(8)
    v_mfma_f32_16x16x32_bf16 v[126:129], v[78:81], a[60:63], v[126:129]
    s_waitcnt lgkmcnt(7)
    v_mfma_f32_16x16x32_bf16 v[122:125], v[82:85], a[64:67], v[122:125]
    s_waitcnt lgkmcnt(6)
    v_mfma_f32_16x16x32_bf16 v[126:129], v[86:89], a[64:67], v[126:129]
    s_waitcnt lgkmcnt(5)
    v_mfma_f32_16x16x32_bf16 v[122:125], v[90:93], a[68:71], v[122:125]
    s_waitcnt lgkmcnt(4)
    v_mfma_f32_16x16x32_bf16 v[126:129], v[94:97], a[68:71], v[126:129]
    s_waitcnt lgkmcnt(3)
    v_mfma_f32_16x16x32_bf16 v[122:125], v[98:101], a[72:75], v[122:125]
    s_waitcnt lgkmcnt(2)
    v_mfma_f32_16x16x32_bf16 v[126:129], v[102:105], a[72:75], v[126:129]
    s_waitcnt lgkmcnt(1)
    v_mfma_f32_16x16x32_bf16 v[122:125], v[106:109], a[76:79], v[122:125]
    s_waitcnt lgkmcnt(0)
    v_mfma_f32_16x16x32_bf16 v[126:129], v[110:113], a[76:79], v[126:129]
    s_nop 7
    v_cvt_pk_bf16_f32 v6, v122, v123
    v_cvt_pk_bf16_f32 v7, v124, v125
    v_cvt_pk_bf16_f32 v8, v126, v127
    v_cvt_pk_bf16_f32 v9, v128, v129
L_xp_donep1:
    v_add_u32 v4, s9, v4
    v_add_u32 v11, s9, v11
    s_sub_u32 s9, 0, s9
    s_add_u32 s17, s73, s16
    s_mov_b64 exec, s[18:19]
    buffer_store_dwordx2 v[6:7], v44, s[28:31], s73 offen sc1
    buffer_store_dwordx2 v[8:9], v44, s[28:31], s17 offen sc1
    s_mov_b64 exec, -1
    s_barrier
    s_mov_b32 s71, 81920
    s_add_u32 s72, s15, 63488
    s_add_u32 s75, s72, 0
    s_mov_b32 m0, s75
    s_add_u32 s75, s71, 0
    buffer_load_dwordx4 v16, s[32:35], s75 offen lds
    s_add_u32 s75, s72, 5120
    s_mov_b32 m0, s75
    s_add_u32 s75, s71, 5120
    buffer_load_dwordx4 v21, s[32:35], s75 offen lds
    s_add_u32 s75, s72, 10240
    s_mov_b32 m0, s75
    s_add_u32 s75, s71, 10240
    buffer_load_dwordx4 v16, s[32:35], s75 offen lds
    s_add_u32 s75, s72, 15360
    s_mov_b32 m0, s75
    s_add_u32 s75, s71, 15360
    buffer_load_dwordx4 v21, s[32:35], s75 offen lds
    s_add_u32 s75, s72, 20480
    s_mov_b32 m0, s75
    s_add_u32 s75, s71, 20480
    buffer_load_dwordx4 v16, s[32:35], s75 offen lds
    s_add_u32 s75, s72, 25600
    s_mov_b32 m0, s75
    s_add_u32 s75, s71, 25600
    buffer_load_dwordx4 v21, s[32:35], s75 offen lds
    s_add_u32 s75, s72, 30720
    s_mov_b32 m0, s75
    s_add_u32 s75, s71, 30720
    buffer_load_dwordx4 v16, s[32:35], s75 offen lds
    s_add_u32 s75, s72, 35840
    s_mov_b32 m0, s75
    s_add_u32 s75, s71, 35840
    buffer_load_dwordx4 v21, s[32:35], s75 offen lds
    s_mov_b32 s71, 122880
    s_add_u32 s72, s15, 104448
    s_add_u32 s75, s72, 0
    s_mov_b32 m0, s75
    s_add_u32 s75, s71, 0
    buffer_load_dwordx4 v16, s[32:35], s75 offen lds
    s_add_u32 s75, s72, 5120
    s_mov_b32 m0, s75
    s_add_u32 s75, s71, 5120
    buffer_load_dwordx4 v21, s[32:35], s75 offen lds
    s_add_u32 s75, s72, 10240
    s_mov_b32 m0, s75
    s_add_u32 s75, s71, 10240
    buffer_load_dwordx4 v16, s[32:35], s75 offen lds
    s_add_u32 s75, s72, 15360
    s_mov_b32 m0, s75
    s_add_u32 s75, s71, 15360
    buffer_load_dwordx4 v21, s[32:35], s75 offen lds
    s_add_u32 s75, s72, 20480
    s_mov_b32 m0, s75
    s_add_u32 s75, s71, 20480
    buffer_load_dwordx4 v16, s[32:35], s75 offen lds
    s_add_u32 s75, s72, 25600
    s_mov_b32 m0, s75
    s_add_u32 s75, s71, 25600
    buffer_load_dwordx4 v21, s[32:35], s75 offen lds
    s_add_u32 s75, s72, 30720
    s_mov_b32 m0, s75
    s_add_u32 s75, s71, 30720
    buffer_load_dwordx4 v16, s[32:35], s75 offen lds
    s_add_u32 s75, s72, 35840
    s_mov_b32 m0, s75
    s_add_u32 s75, s71, 35840
    buffer_load_dwordx4 v21, s[32:35], s75 offen lds
    s_mov_b32 s71, 163840
    s_add_u32 s72, s15, 63488
    s_mov_b32 s74, 0
L_chain_poll0:
    v_mov_b32 v74, s38
    v_mov_b32 v75, s38
    v_mov_b32 v76, s38
    v_mov_b32 v77, s38
    v_cmp_gt_u32 vcc, 40, v3
    s_mov_b64 exec, vcc
    buffer_load_dwordx4 v[74:77], v18, s[44:47], s27 offen sc1
    s_mov_b64 exec, -1
    s_waitcnt vmcnt(0)
    v_min_u32 v130, v74, v75
    v_min3_u32 v130, v130, v76, v77
    v_cmp_eq_u32 vcc, 0, v130
    s_add_u32 s74, s74, 1
    s_cmp_gt_u32 s74, 4194304
    s_cbranch_scc1 L_chain_done
    s_cbranch_vccnz L_chain_poll0
    v_max_u32 v131, v74, v75
    v_max3_u32 v131, v131, v76, v77
    v_cmp_ne_u32 vcc, s38, v130
    v_cmp_ne_u32 s[74:75], s38, v131
    s_or_b64 vcc, vcc, s[74:75]
    s_cmp_eq_u64 vcc, 0
    s_cselect_b32 s36, 1, 0
    s_lshl_b32 s25, 1, s24
    s_and_b32 s25, s25, 24
    s_lshl_b32 s3, s15, 1
    s_add_u32 s3, s3, 167936
    s_mov_b32 s61, s14
    buffer_load_dwordx4 v[50:53], v12, s[28:31], s61 offen sc1
    buffer_load_dwordx4 v[62:65], v12, s[28:31], s61 offen offset:1536 sc1
    buffer_load_dwordx4 v[54:57], v13, s[28:31], s61 offen sc1
    buffer_load_dwordx4 v[66:69], v13, s[28:31], s61 offen offset:1536 sc1
    s_mov_b64 exec, s[48:49]
    buffer_load_dwordx4 v[58:61], v14, s[28:31], s61 offen sc1
    buffer_load_dwordx4 v[70:73], v14, s[28:31], s61 offen offset:1536 sc1
    s_mov_b64 exec, s[100:101]
    buffer_load_dwordx4 v[148:151], v34, s[28:31], s61 offen sc1
    s_mov_b64 exec, -1
    s_barrier
    s_cmp_ge_u32 s24, 3
    s_cbranch_scc1 L_xp_swp2
    ds_read_b128 v[74:77], v4 offset:0
    ds_read_b128 v[78:81], v4 offset:20480
    ds_read_b128 v[82:85], v11 offset:0
    ds_read_b128 v[86:89], v11 offset:20480
    ds_read_b128 v[90:93], v4 offset:128
    ds_read_b128 v[94:97], v4 offset:20608
    ds_read_b128 v[98:101], v11 offset:128
    ds_read_b128 v[102:105], v11 offset:20608
    ds_read_b128 v[106:109], v4 offset:256
    ds_read_b128 v[110:113], v4 offset:20736
    s_waitcnt lgkmcnt(9)
    v_mfma_f32_16x16x32_bf16 v[122:125], a[0:3], v[74:77], 0
    ds_read_b128 v[74:77], v11 offset:256
    s_waitcnt lgkmcnt(9)
    v_mfma_f32_16x16x32_bf16 v[126:129], a[0:3], v[78:81], 0
    ds_read_b128 v[78:81], v11 offset:20736
    s_waitcnt lgkmcnt(9)
    v_mfma_f32_16x16x32_bf16 v[122:125], a[4:7], v[82:85], v[122:125]
    ds_read_b128 v[82:85], v4 offset:384
    s_waitcnt lgkmcnt(9)
    v_mfma_f32_16x16x32_bf16 v[126:129], a[4:7], v[86:89], v[126:129]
    ds_read_b128 v[86:89], v4 offset:20864
    s_waitcnt lgkmcnt(9)
    v_mfma_f32_16x16x32_bf16 v[122:125], a[8:11], v[90:93], v[122:125]
    ds_read_b128 v[90:93], v11 offset:384
    s_waitcnt lgkmcnt(9)
    v_mfma_f32_16x16x32_bf16 v[126:129], a[8:11], v[94:97], v[126:129]
    ds_read_b128 v[94:97], v11 offset:20864
    s_waitcnt lgkmcnt(9)
    v_mfma_f32_16x16x32_bf16 v[122:125], a[12:15], v[98:101], v[122:125]
    ds_read_b128 v[98:101], v4 offset:512
    s_waitcnt lgkmcnt(9)
    v_mfma_f32_16x16x32_bf16 v[126:129], a[12:15], v[102:105], v[126:129]
    ds_read_b128 v[102:105], v4 offset:20992
    s_waitcnt lgkmcnt(9)
    v_mfma_f32_16x16x32_bf16 v[122:125], a[16:19], v[106:109], v[122:125]
    ds_read_b128 v[106:109], v11 offset:512
    s_waitcnt lgkmcnt(9)
    v_mfma_f32_16x16x32_bf16 v[126:129], a[16:19], v[110:113], v[126:129]
    ds_read_b128 v[110:113], v11 offset:20992
    s_waitcnt lgkmcnt(9)
    v_mfma_f32_16x16x32_bf16 v[122:125], a[20:23], v[74:77], v[122:125]
    ds_read_b128 v[74:77], v4 offset:640
    s_waitcnt lgkmcnt(9)
    v_mfma_f32_16x16x32_bf16 v[126:129], a[20:23], v[78:81], v[126:129]
    ds_read_b128 v[78:81], v4 offset:21120
    s_waitcnt lgkmcnt(9)
    v_mfma_f32_16x16x32_bf16 v[122:125], a[24:27], v[82:85], v[122:125]
    ds_read_b128 v[82:85], v11 offset:640
    s_waitcnt lgkmcnt(9)
    v_mfma_f32_16x16x32_bf16 v[126:129], a[24:27], v[86:89], v[126:129]
    ds_read_b128 v[86:89], v11 offset:21120
    s_waitcnt lgkmcnt(9)
    v_mfma_f32_16x16x32_bf16 v[122:125], a[28:31], v[90:93], v[122:125]
    ds_read_b128 v[90:93], v4 offset:768
    s_waitcnt lgkmcnt(9)
    v_mfma_f32_16x16x32_bf16 v[126:129], a[28:31], v[94:97], v[126:129]
    ds_read_b128 v[94:97], v4 offset:21248
    s_waitcnt lgkmcnt(9)
    v_mfma_f32_16x16x32_bf16 v[122:125], a[32:35], v[98:101], v[122:125]
    ds_read_b128 v[98:101], v11 offset:768
    s_waitcnt lgkmcnt(9)
    v_mfma_f32_16x16x32_bf16 v[126:129], a[32:35], v[102:105], v[126:129]
    ds_read_b128 v[102:105], v11 offset:21248
    s_waitcnt lgkmcnt(9)
    v_mfma_f32_16x16x32_bf16 v[122:125], a[36:39], v[106:109], v[122:125]
    ds_read_b128 v[106:109], v4 offset:896
    s_waitcnt lgkmcnt(9)
    v_mfma_f32_16x16x32_bf16 v[126:129], a[36:39], v[110:113], v[126:129]
    ds_read_b128 v[110:113], v4 offset:21376
    s_waitcnt lgkmcnt(9)
    v_mfma_f32_16x16x32_bf16 v[122:125], a[40:43], v[74:77], v[122:125]
    ds_read_b128 v[74:77], v11 offset:896
    s_waitcnt lgkmcnt(9)
    v_mfma_f32_16x16x32_bf16 v[126:129], a[40:43], v[78:81], v[126:129]
    ds_read_b128 v[78:81], v11 offset:21376
    s_waitcnt lgkmcnt(9)
    v_mfma_f32_16x16x32_bf16 v[122:125], a[44:47], v[82:85], v[122:125]
    ds_read_b128 v[82:85], v4 offset:1024
    s_waitcnt lgkmcnt(9)
    v_mfma_f32_16x16x32_bf16 v[126:129], a[44:47], v[86:89], v[126:129]
    ds_read_b128 v[86:89], v4 offset:21504
    s_waitcnt lgkmcnt(9)
    v_mfma_f32_16x16x32_bf16 v[122:125], a[48:51], v[90:93], v[122:125]
    ds_read_b128 v[90:93], v11 offset:1024
    s_waitcnt lgkmcnt(9)
    v_mfma_f32_16x16x32_bf16 v[126:129], a[48:51], v[94:97], v[126:129]
    ds_read_b128 v[94:97], v11 offset:21504
    s_waitcnt lgkmcnt(9)
    v_mfma_f32_16x16x32_bf16 v[122:125], a[52:55], v[98:101], v[122:125]
    ds_read_b128 v[98:101], v4 offset:1152
    s_waitcnt lgkmcnt(9)
    v_mfma_f32_16x16x32_bf16 v[126:129], a[52:55], v[102:105], v[126:129]
    ds_read_b128 v[102:105], v4 offset:21632
    s_waitcnt lgkmcnt(9)
    v_mfma_f32_16x16x32_bf16 v[122:125], a[56:59], v[106:109], v[122:125]
    ds_read_b128 v[106:109], v11 offset:1152
    s_waitcnt lgkmcnt(9)
    v_mfma_f32_16x16x32_bf16 v[126:129], a[56:59], v[110:113], v[126:129]
    ds_read_b128 v[110:113], v11 offset:21632
    s_waitcnt lgkmcnt(9)
    v_mfma_f32_16x16x32_bf16 v[122:125], a[60:63], v[74:77], v[122:125]
    s_waitcnt lgkmcnt(8)
    v_mfma_f32_16x16x32_bf16 v[126:129], a[60:63], v[78:81], v[126:129]
    s_waitcnt lgkmcnt(7)
    v_mfma_f32_16x16x32_bf16 v[122:125], a[64:67], v[82:85], v[122:125]
    s_waitcnt lgkmcnt(6)
    v_mfma_f32_16x16x32_bf16 v[126:129], a[64:67], v[86:89], v[126:129]
    s_waitcnt lgkmcnt(5)
    v_mfma_f32_16x16x32_bf16 v[122:125], a[68:71], v[90:93], v[122:125]
    s_waitcnt lgkmcnt(4)
    v_mfma_f32_16x16x32_bf16 v[126:129], a[68:71], v[94:97], v[126:129]
    s_waitcnt lgkmcnt(3)
    v_mfma_f32_16x16x32_bf16 v[122:125], a[72:75], v[98:101], v[122:125]
    s_waitcnt lgkmcnt(2)
    v_mfma_f32_16x16x32_bf16 v[126:129], a[72:75], v[102:105], v[126:129]
    s_waitcnt lgkmcnt(1)
    v_mfma_f32_16x16x32_bf16 v[122:125], a[76:79], v[106:109], v[122:125]
    s_waitcnt lgkmcnt(0)
    v_mfma_f32_16x16x32_bf16 v[126:129], a[76:79], v[110:113], v[126:129]
    s_nop 7
    v_cvt_pk_bf16_f32 v6, v122, v123
    v_cvt_pk_bf16_f32 v7, v124, v125
    v_cvt_pk_bf16_f32 v8, v126, v127
    v_cvt_pk_bf16_f32 v9, v128, v129
    s_branch L_xp_donep2
L_xp_swp2:
    ds_read_b128 v[74:77], v4 offset:0
    ds_read_b128 v[78:81], v4 offset:20480
    ds_read_b128 v[82:85], v11 offset:0
    ds_read_b128 v[86:89], v11 offset:20480
    ds_read_b128 v[90:93], v4 offset:128
    ds_read_b128 v[94:97], v4 offset:20608
    ds_read_b128 v[98:101], v11 offset:128
    ds_read_b128 v[102:105], v11 offset:20608
    ds_read_b128 v[106:109], v4 offset:256
    ds_read_b128 v[110:113], v4 offset:20736
    s_waitcnt lgkmcnt(9)
    v_mfma_f32_16x16x32_bf16 v[122:125], v[74:77], a[0:3], 0
    ds_read_b128 v[74:77], v11 offset:256
    s_waitcnt lgkmcnt(9)
    v_mfma_f32_16x16x32_bf16 v[126:129], v[78:81], a[0:3], 0
    ds_read_b128 v[78:81], v11 offset:20736
    s_waitcnt lgkmcnt(9)
    v_mfma_f32_16x16x32_bf16 v[122:125], v[82:85], a[4:7], v[122:125]
    ds_read_b128 v[82:85], v4 offset:384
    s_waitcnt lgkmcnt(9)
    v_mfma_f32_16x16x32_bf16 v[126:129], v[86:89], a[4:7], v[126:129]
    ds_read_b128 v[86:89], v4 offset:20864
    s_waitcnt lgkmcnt(9)
    v_mfma_f32_16x16x32_bf16 v[122:125], v[90:93], a[8:11], v[122:125]
    ds_read_b128 v[90:93], v11 offset:384
    s_waitcnt lgkmcnt(9)
    v_mfma_f32_16x16x32_bf16 v[126:129], v[94:97], a[8:11], v[126:129]
    ds_read_b128 v[94:97], v11 offset:20864
    s_waitcnt lgkmcnt(9)
    v_mfma_f32_16x16x32_bf16 v[122:125], v[98:101], a[12:15], v[122:125]
    ds_read_b128 v[98:101], v4 offset:512
    s_waitcnt lgkmcnt(9)
    v_mfma_f32_16x16x32_bf16 v[126:129], v[102:105], a[12:15], v[126:129]
    ds_read_b128 v[102:105], v4 offset:20992
    s_waitcnt lgkmcnt(9)
    v_mfma_f32_16x16x32_bf16 v[122:125], v[106:109], a[16:19], v[122:125]
    ds_read_b128 v[106:109], v11 offset:512
    s_waitcnt lgkmcnt(9)
    v_mfma_f32_16x16x32_bf16 v[126:129], v[110:113], a[16:19], v[126:129]
    ds_read_b128 v[110:113], v11 offset:20992
    s_waitcnt lgkmcnt(9)
    v_mfma_f32_16x16x32_bf16 v[122:125], v[74:77], a[20:23], v[122:125]
    ds_read_b128 v[74:77], v4 offset:640
    s_waitcnt lgkmcnt(9)
    v_mfma_f32_16x16x32_bf16 v[126:129], v[78:81], a[20:23], v[126:129]
    ds_read_b128 v[78:81], v4 offset:21120
    s_waitcnt lgkmcnt(9)
    v_mfma_f32_16x16x32_bf16 v[122:125], v[82:85], a[24:27], v[122:125]
    ds_read_b128 v[82:85], v11 offset:640
    s_waitcnt lgkmcnt(9)
    v_mfma_f32_16x16x32_bf16 v[126:129], v[86:89], a[24:27], v[126:129]
    ds_read_b128 v[86:89], v11 offset:21120
    s_waitcnt lgkmcnt(9)
    v_mfma_f32_16x16x32_bf16 v[122:125], v[90:93], a[28:31], v[122:125]
    ds_read_b128 v[90:93], v4 offset:768
    s_waitcnt lgkmcnt(9)
    v_mfma_f32_16x16x32_bf16 v[126:129], v[94:97], a[28:31], v[126:129]
    ds_read_b128 v[94:97], v4 offset:21248
    s_waitcnt lgkmcnt(9)
    v_mfma_f32_16x16x32_bf16 v[122:125], v[98:101], a[32:35], v[122:125]
    ds_read_b128 v[98:101], v11 offset:768
    s_waitcnt lgkmcnt(9)
    v_mfma_f32_16x16x32_bf16 v[126:129], v[102:105], a[32:35], v[126:129]
    ds_read_b128 v[102:105], v11 offset:21248
    s_waitcnt lgkmcnt(9)
    v_mfma_f32_16x16x32_bf16 v[122:125], v[106:109], a[36:39], v[122:125]
    ds_read_b128 v[106:109], v4 offset:896
    s_waitcnt lgkmcnt(9)
    v_mfma_f32_16x16x32_bf16 v[126:129], v[110:113], a[36:39], v[126:129]
    ds_read_b128 v[110:113], v4 offset:21376
    s_waitcnt lgkmcnt(9)
    v_mfma_f32_16x16x32_bf16 v[122:125], v[74:77], a[40:43], v[122:125]
    ds_read_b128 v[74:77], v11 offset:896
    s_waitcnt lgkmcnt(9)
    v_mfma_f32_16x16x32_bf16 v[126:129], v[78:81], a[40:43], v[126:129]
    ds_read_b128 v[78:81], v11 offset:21376
    s_waitcnt lgkmcnt(9)
    v_mfma_f32_16x16x32_bf16 v[122:125], v[82:85], a[44:47], v[122:125]
    ds_read_b128 v[82:85], v4 offset:1024
    s_waitcnt lgkmcnt(9)
    v_mfma_f32_16x16x32_bf16 v[126:129], v[86:89], a[44:47], v[126:129]
    ds_read_b128 v[86:89], v4 offset:21504
    s_waitcnt lgkmcnt(9)
    v_mfma_f32_16x16x32_bf16 v[122:125], v[90:93], a[48:51], v[122:125]
    ds_read_b128 v[90:93], v11 offset:1024
    s_waitcnt lgkmcnt(9)
    v_mfma_f32_16x16x32_bf16 v[126:129], v[94:97], a[48:51], v[126:129]
    ds_read_b128 v[94:97], v11 offset:21504
    s_waitcnt lgkmcnt(9)
    v_mfma_f32_16x16x32_bf16 v[122:125], v[98:101], a[52:55], v[122:125]
    ds_read_b128 v[98:101], v4 offset:1152
    s_waitcnt lgkmcnt(9)
    v_mfma_f32_16x16x32_bf16 v[126:129], v[102:105], a[52:55], v[126:129]
    ds_read_b128 v[102:105], v4 offset:21632
    s_waitcnt lgkmcnt(9)
    v_mfma_f32_16x16x32_bf16 v[122:125], v[106:109], a[56:59], v[122:125]
    ds_read_b128 v[106:109], v11 offset:1152
    s_waitcnt lgkmcnt(9)
    v_mfma_f32_16x16x32_bf16 v[126:129], v[110:113], a[56:59], v[126:129]
    ds_read_b128 v[110:113], v11 offset:21632
    s_waitcnt lgkmcnt(9)
    v_mfma_f32_16x16x32_bf16 v[122:125], v[74:77], a[60:63], v[122:125]
    s_waitcnt lgkmcnt(8)
    v_mfma_f32_16x16x32_bf16 v[126:129], v[78:81], a[60:63], v[126:129]
    s_waitcnt lgkmcnt(7)
    v_mfma_f32_16x16x32_bf16 v[122:125], v[82:85], a[64:67], v[122:125]
    s_waitcnt lgkmcnt(6)
    v_mfma_f32_16x16x32_bf16 v[126:129], v[86:89], a[64:67], v[126:129]
    s_waitcnt lgkmcnt(5)
    v_mfma_f32_16x16x32_bf16 v[122:125], v[90:93], a[68:71], v[122:125]
    s_waitcnt lgkmcnt(4)
    v_mfma_f32_16x16x32_bf16 v[126:129], v[94:97], a[68:71], v[126:129]
    s_waitcnt lgkmcnt(3)
    v_mfma_f32_16x16x32_bf16 v[122:125], v[98:101], a[72:75], v[122:125]
    s_waitcnt lgkmcnt(2)
    v_mfma_f32_16x16x32_bf16 v[126:129], v[102:105], a[72:75], v[126:129]
    s_waitcnt lgkmcnt(1)
    v_mfma_f32_16x16x32_bf16 v[122:125], v[106:109], a[76:79], v[122:125]
    s_waitcnt lgkmcnt(0)
    v_mfma_f32_16x16x32_bf16 v[126:129], v[110:113], a[76:79], v[126:129]
    s_nop 7
    v_cvt_pk_bf16_f32 v6, v122, v123
    v_cvt_pk_bf16_f32 v7, v124, v125
    v_cvt_pk_bf16_f32 v8, v126, v127
    v_cvt_pk_bf16_f32 v9, v128, v129
L_xp_donep2:
    v_add_u32 v4, s9, v4
    v_add_u32 v11, s9, v11
    s_sub_u32 s9, 0, s9
    s_waitcnt vmcnt(0)
    s_mov_b64 exec, s[100:101]
    ds_write_b128 v35, v[148:151]
    s_mov_b64 exec, -1
    ds_write_b128 v28, v[50:53]
    ds_write_b128 v38, v[62:65]
    ds_write_b128 v29, v[54:57]
    ds_write_b128 v39, v[66:69]
    s_mov_b64 exec, s[48:49]
    ds_write_b128 v30, v[58:61]
    ds_write_b128 v40, v[70:73]
    s_mov_b64 exec, -1
    s_mov_b32 s57, s51
    s_cmp_eq_u32 s24, 4
    s_cselect_b32 s50, s51, s50
    s_cselect_b64 vcc, -1, 0
    s_nop 1
    v_cndmask_b32 v47, v47, v46, vcc
    s_and_b64 s[66:67], s[64:65], s[18:19]
    v_cmp_gt_u32 vcc, 4, v1
    s_and_b64 s[22:23], vcc, s[64:65]
    v_mov_b32 v49, 0
    s_cmp_lg_u32 s25, 0
    s_cbranch_scc1 L_setup_h
    s_mul_i32 s75, s24, 7168
    v_add_u32 v20, s75, v20
    s_lshl_b32 s75, s24, 11
    v_add_u32 v45, s75, v18
    v_mov_b32 v36, 0x3f803f80
    v_mov_b32 v37, 0x3f803f80
    v_mov_b32 v31, 1
    v_mov_b32 v32, 0xf149f2ca
L_setup_h:
    s_cmp_eq_u32 s36, 1
    s_cbranch_scc0 L_disp_r
    s_cmp_eq_u32 s24, 4
    s_cbranch_scc1 L_top_gl
    s_cmp_lg_u32 s25, 0
    s_cbranch_scc1 L_top_hl
    s_branch L_top_cl
L_disp_r:
    s_cmp_eq_u32 s24, 4
    s_cbranch_scc1 L_top_gr
    s_cmp_lg_u32 s25, 0
    s_cbranch_scc1 L_top_hr
    s_branch L_top_cr
.p2align 5
L_top_cl:
    s_waitcnt lgkmcnt(0)
    s_barrier
    ds_read_b128 v[74:77], v5 offset:0
    ds_read_b128 v[78:81], v5 offset:128
    ds_read_b128 v[82:85], v5 offset:256
    ds_read_b128 v[86:89], v5 offset:384
    ds_read_b128 v[90:93], v5 offset:512
    ds_read_b128 v[94:97], v5 offset:640
    ds_read_b128 v[98:101], v5 offset:768
    ds_read_b128 v[102:105], v5 offset:896
    ds_read_b128 v[106:109], v5 offset:1024
    ds_read_b128 v[110:113], v5 offset:1152
    s_add_u32 s68, s60, 1
    s_and_b32 s68, s68, 1
    s_xor_b32 s69, s68, 1
    s_bfe_u32 s39, s60, 0x10001
    s_xor_b32 s38, s39, 1
    s_waitcnt lgkmcnt(9)
    v_mfma_f32_16x16x32_bf16 v[114:117], a[0:3], v[74:77], 0
    v_mfma_f32_16x16x32_bf16 v[118:121], a[4:7], v[74:77], 0
    s_waitcnt lgkmcnt(8)
    v_mfma_f32_16x16x32_bf16 v[114:117], a[8:11], v[78:81], v[114:117]
    v_mfma_f32_16x16x32_bf16 v[118:121], a[12:15], v[78:81], v[118:121]
    s_waitcnt lgkmcnt(7)
    v_mfma_f32_16x16x32_bf16 v[114:117], a[16:19], v[82:85], v[114:117]
    v_mfma_f32_16x16x32_bf16 v[118:121], a[20:23], v[82:85], v[118:121]
    s_waitcnt lgkmcnt(6)
    v_mfma_f32_16x16x32_bf16 v[114:117], a[24:27], v[86:89], v[114:117]
    v_mfma_f32_16x16x32_bf16 v[118:121], a[28:31], v[86:89], v[118:121]
    s_waitcnt lgkmcnt(5)
    v_mfma_f32_16x16x32_bf16 v[114:117], a[32:35], v[90:93], v[114:117]
    v_mfma_f32_16x16x32_bf16 v[118:121], a[36:39], v[90:93], v[118:121]
    s_waitcnt lgkmcnt(4)
    v_mfma_f32_16x16x32_bf16 v[114:117], a[40:43], v[94:97], v[114:117]
    v_mfma_f32_16x16x32_bf16 v[118:121], a[44:47], v[94:97], v[118:121]
    s_waitcnt lgkmcnt(3)
    v_mfma_f32_16x16x32_bf16 v[114:117], a[48:51], v[98:101], v[114:117]
    v_mfma_f32_16x16x32_bf16 v[118:121], a[52:55], v[98:101], v[118:121]
    s_waitcnt lgkmcnt(2)
    v_mfma_f32_16x16x32_bf16 v[114:117], a[56:59], v[102:105], v[114:117]
    v_mfma_f32_16x16x32_bf16 v[118:121], a[60:63], v[102:105], v[118:121]
    s_waitcnt lgkmcnt(1)
    v_mfma_f32_16x16x32_bf16 v[114:117], a[64:67], v[106:109], v[114:117]
    v_mfma_f32_16x16x32_bf16 v[118:121], a[68:71], v[106:109], v[118:121]
    s_waitcnt lgkmcnt(0)
    v_mfma_f32_16x16x32_bf16 v[114:117], a[72:75], v[110:113], v[114:117]
    v_mfma_f32_16x16x32_bf16 v[118:121], a[76:79], v[110:113], v[118:121]
    s_nop 7
    v_add_f32_dpp v114, v118, v114 row_ror:8 row_mask:0xf bank_mask:0xf
    v_add_f32_dpp v115, v119, v115 row_ror:8 row_mask:0xf bank_mask:0xf
    v_add_f32_dpp v116, v120, v116 row_ror:8 row_mask:0xf bank_mask:0xf
    v_add_f32_dpp v117, v121, v117 row_ror:8 row_mask:0xf bank_mask:0xf
    s_mov_b64 exec, s[62:63]
    v_cvt_pk_bf16_f32 v132, v114, v115
    v_cvt_pk_bf16_f32 v133, v116, v117
    v_and_or_b32 v132, v132, -2, s68
    buffer_store_dwordx2 v[132:133], v22, s[44:47], s51 offen
    s_mov_b64 exec, -1
    ds_read_b128 v[74:77], v15 offset:21568
    ds_read_b128 v[78:81], v15 offset:21632
    ds_read_b128 v[82:85], v15 offset:21696
    ds_read_b128 v[86:89], v15 offset:21760
    ds_read_b128 v[90:93], v15 offset:21824
    ds_read_b128 v[94:97], v15 offset:21888
    ds_read_b128 v[98:101], v15 offset:27968
    ds_read_b128 v[102:105], v15 offset:28032
    ds_read_b128 v[106:109], v15 offset:28096
    ds_read_b128 v[110:113], v15 offset:28160
    ds_read_b128 v[50:53], v15 offset:28224
    ds_read_b128 v[54:57], v15 offset:28288
    s_add_u32 s75, s60, 2
    s_and_b32 s73, s75, 3
    s_mul_i32 s73, s73, 1179648
    s_add_u32 s73, s73, s14
    s_add_u32 s75, s60, 1
    s_and_b32 s61, s75, 3
    s_mul_i32 s61, s61, 1179648
    s_add_u32 s61, s61, s14
    s_mul_i32 s70, s60, 393216
    s_add_u32 s70, s70, s58
    v_mov_b32 v48, s75
    v_cndmask_b32 v114, 0, v32, s[76:77]
    v_cndmask_b32 v115, 0, v32, s[78:79]
    v_cndmask_b32 v116, 0, v32, s[80:81]
    v_cndmask_b32 v117, 0, v32, s[82:83]
    v_cndmask_b32 v118, 0, v32, s[84:85]
    v_cndmask_b32 v119, 0, v32, s[86:87]
    v_cndmask_b32 v120, 0, v32, s[88:89]
    v_cndmask_b32 v121, 0, v32, s[90:91]
    v_cndmask_b32 v122, 0, v32, s[92:93]
    v_cndmask_b32 v123, 0, v32, s[94:95]
    v_cndmask_b32 v124, 0, v32, s[96:97]
    v_cndmask_b32 v125, 0, v32, s[98:99]
    s_mul_i32 s75, s75, 3
    s_mov_b32 s74, 0
    buffer_load_dwordx4 v[130:133], v17, s[44:47], s57 offen sc1
    buffer_load_dwordx4 v[134:137], v17, s[44:47], s50 offen sc1
    s_sleep 4
.p2align 5
L_p1_cl:
    buffer_load_dwordx4 v[140:143], v17, s[44:47], s57 offen sc1
    buffer_load_dwordx4 v[144:147], v17, s[44:47], s50 offen sc1
    s_waitcnt vmcnt(2)
    v_bitop3_b32 v138, v130, s69, v132 bitop3:0x24
    v_bitop3_b32 v139, v134, s69, v136 bitop3:0x24
    v_bitop3_b32 v138, v138, 1, v139 bitop3:0x80
    v_cmp_eq_u32 vcc, 0, v138
    s_cbranch_vccnz L_p1b_cl
    ds_write_b128 v46, v[130:133]
    ds_write_b128 v47, v[134:137]
L_p1e_cl:
    s_waitcnt lgkmcnt(0)
    s_barrier
    ds_read_b128 v[62:65], v19 offset:10368
    ds_read_b128 v[58:61], v15 offset:15168
    ds_read_b128 v[70:73], v19 offset:10432
    ds_read_b128 v[66:69], v15 offset:15232
    ds_read_b128 v[126:129], v19 offset:10496
    ds_read_b128 v[148:151], v15 offset:15296
    s_waitcnt lgkmcnt(5)
    v_mfma_f32_16x16x32_bf16 v[118:121], v[74:77], v[62:65], v[118:121]
    v_mfma_f32_16x16x32_bf16 v[122:125], v[98:101], v[62:65], v[122:125]
    s_waitcnt lgkmcnt(4)
    v_mfma_f32_16x16x32_bf16 v[114:117], v[58:61], v[62:65], v[114:117]
    ds_read_b128 v[62:65], v19 offset:10560
    ds_read_b128 v[58:61], v15 offset:15360
    s_waitcnt lgkmcnt(5)
    v_mfma_f32_16x16x32_bf16 v[118:121], v[78:81], v[70:73], v[118:121]
    v_mfma_f32_16x16x32_bf16 v[122:125], v[102:105], v[70:73], v[122:125]
    s_waitcnt lgkmcnt(4)
    v_mfma_f32_16x16x32_bf16 v[114:117], v[66:69], v[70:73], v[114:117]
    ds_read_b128 v[70:73], v19 offset:10624
    ds_read_b128 v[66:69], v15 offset:15424
    s_waitcnt lgkmcnt(5)
    v_mfma_f32_16x16x32_bf16 v[118:121], v[82:85], v[126:129], v[118:121]
    v_mfma_f32_16x16x32_bf16 v[122:125], v[106:109], v[126:129], v[122:125]
    s_waitcnt lgkmcnt(4)
    v_mfma_f32_16x16x32_bf16 v[114:117], v[148:151], v[126:129], v[114:117]
    ds_read_b128 v[126:129], v19 offset:10688
    ds_read_b128 v[148:151], v15 offset:15488
    s_waitcnt lgkmcnt(5)
    v_mfma_f32_16x16x32_bf16 v[118:121], v[86:89], v[62:65], v[118:121]
    v_mfma_f32_16x16x32_bf16 v[122:125], v[110:113], v[62:65], v[122:125]
    s_waitcnt lgkmcnt(4)
    v_mfma_f32_16x16x32_bf16 v[114:117], v[58:61], v[62:65], v[114:117]
    s_waitcnt lgkmcnt(3)
    v_mfma_f32_16x16x32_bf16 v[118:121], v[90:93], v[70:73], v[118:121]
    v_mfma_f32_16x16x32_bf16 v[122:125], v[50:53], v[70:73], v[122:125]
    s_waitcnt lgkmcnt(2)
    v_mfma_f32_16x16x32_bf16 v[114:117], v[66:69], v[70:73], v[114:117]
    s_waitcnt lgkmcnt(1)
    v_mfma_f32_16x16x32_bf16 v[118:121], v[94:97], v[126:129], v[118:121]
    v_mfma_f32_16x16x32_bf16 v[122:125], v[54:57], v[126:129], v[122:125]
    s_waitcnt lgkmcnt(0)
    v_mfma_f32_16x16x32_bf16 v[114:117], v[148:151], v[126:129], v[114:117]
    s_waitcnt vmcnt(0)
    buffer_load_dwordx4 v[50:53], v12, s[28:31], s61 offen sc1
    buffer_load_dwordx4 v[62:65], v12, s[28:31], s61 offen offset:1536 sc1
    buffer_load_dwordx4 v[54:57], v13, s[28:31], s61 offen sc1
    buffer_load_dwordx4 v[66:69], v13, s[28:31], s61 offen offset:1536 sc1
    s_cmp_gt_u32 s60, 61
    s_cbranch_scc1 L_chain_nostcl
    buffer_store_dwordx2 v[6:7], v44, s[28:31], s73 offen sc1
    buffer_store_dwordx2 v[8:9], v44, s[28:31], s73 offen offset:768 sc1
L_chain_nostcl:
    ds_read_b64 v[74:75], v20 offset:34368
    ds_read_b64 v[76:77], v20 offset:34400
    ds_read_b64 v[78:79], v20 offset:34432
    ds_read_b64 v[80:81], v20 offset:36160
    ds_read_b64 v[82:83], v20 offset:36192
    ds_read_b64 v[84:85], v20 offset:36224
    ds_read_b64 v[86:87], v20 offset:37952
    ds_read_b64 v[88:89], v20 offset:37984
    ds_read_b64 v[90:91], v20 offset:38016
    ds_read_b64 v[92:93], v20 offset:39744
    ds_read_b64 v[94:95], v20 offset:39776
    ds_read_b64 v[96:97], v20 offset:39808
    v_max3_f32 v130, v114, v115, v116
    v_max3_f32 v130, v130, v117, v118
    v_max3_f32 v130, v130, v119, v120
    v_max3_f32 v130, v130, v121, v122
    v_max3_f32 v130, v130, v123, v124
    v_max_f32 v130, v130, v125
    v_mov_b32 v131, v130
    v_cvt_pk_bf16_f32 v132, v114, v115
    v_lshlrev_b32 v114, 16, v132
    v_and_b32 v115, 0xffff0000, v132
    v_permlane16_swap_b32 v130, v131
    v_cvt_pk_bf16_f32 v133, v116, v117
    v_lshlrev_b32 v116, 16, v133
    v_and_b32 v117, 0xffff0000, v133
    v_max_f32 v130, v130, v131
    v_cvt_pk_bf16_f32 v132, v118, v119
    v_lshlrev_b32 v118, 16, v132
    v_and_b32 v119, 0xffff0000, v132
    v_mov_b32 v131, v130
    v_cvt_pk_bf16_f32 v133, v120, v121
    v_lshlrev_b32 v120, 16, v133
    v_and_b32 v121, 0xffff0000, v133
    v_permlane32_swap_b32 v130, v131
    v_cvt_pk_bf16_f32 v132, v122, v123
    v_lshlrev_b32 v122, 16, v132
    v_and_b32 v123, 0xffff0000, v132
    v_max_f32 v130, v130, v131
    v_cvt_pk_bf16_f32 v133, v124, v125
    v_lshlrev_b32 v124, 16, v133
    v_and_b32 v125, 0xffff0000, v133
    v_mul_f32 v130, 0x3dd53b95, v130
    v_pk_mul_f32 v[114:115], v[114:115], s[10:11]
    v_pk_mul_f32 v[116:117], v[116:117], s[10:11]
    v_pk_mul_f32 v[118:119], v[118:119], s[10:11]
    v_pk_mul_f32 v[120:121], v[120:121], s[10:11]
    v_pk_mul_f32 v[122:123], v[122:123], s[10:11]
    v_pk_mul_f32 v[124:125], v[124:125], s[10:11]
    v_cvt_pk_bf16_f32 v132, v114, v115
    v_lshlrev_b32 v114, 16, v132
    v_and_b32 v115, 0xffff0000, v132
    v_cvt_pk_bf16_f32 v133, v116, v117
    v_lshlrev_b32 v116, 16, v133
    v_and_b32 v117, 0xffff0000, v133
    v_cvt_pk_bf16_f32 v132, v118, v119
    v_lshlrev_b32 v118, 16, v132
    v_and_b32 v119, 0xffff0000, v132
    v_cvt_pk_bf16_f32 v133, v120, v121
    v_lshlrev_b32 v120, 16, v133
    v_and_b32 v121, 0xffff0000, v133
    v_cvt_pk_bf16_f32 v132, v122, v123
    v_lshlrev_b32 v122, 16, v132
    v_and_b32 v123, 0xffff0000, v132
    v_cvt_pk_bf16_f32 v133, v124, v125
    v_lshlrev_b32 v124, 16, v133
    v_and_b32 v125, 0xffff0000, v133
    v_pk_fma_f32 v[114:115], v[114:115], s[8:9], v[130:131] op_sel_hi:[1,0,0] neg_lo:[0,0,1] neg_hi:[0,0,1]
    v_pk_fma_f32 v[116:117], v[116:117], s[8:9], v[130:131] op_sel_hi:[1,0,0] neg_lo:[0,0,1] neg_hi:[0,0,1]
    v_pk_fma_f32 v[118:119], v[118:119], s[8:9], v[130:131] op_sel_hi:[1,0,0] neg_lo:[0,0,1] neg_hi:[0,0,1]
    v_pk_fma_f32 v[120:121], v[120:121], s[8:9], v[130:131] op_sel_hi:[1,0,0] neg_lo:[0,0,1] neg_hi:[0,0,1]
    v_pk_fma_f32 v[122:123], v[122:123], s[8:9], v[130:131] op_sel_hi:[1,0,0] neg_lo:[0,0,1] neg_hi:[0,0,1]
    v_pk_fma_f32 v[124:125], v[124:125], s[8:9], v[130:131] op_sel_hi:[1,0,0] neg_lo:[0,0,1] neg_hi:[0,0,1]
    v_exp_f32 v114, v114
    v_exp_f32 v115, v115
    v_exp_f32 v116, v116
    v_exp_f32 v117, v117
    v_cvt_pk_bf16_f32 v138, v114, v115
    v_exp_f32 v118, v118
    v_exp_f32 v119, v119
    v_cvt_pk_bf16_f32 v139, v116, v117
    v_exp_f32 v120, v120
    v_exp_f32 v121, v121
    v_cvt_pk_bf16_f32 v140, v118, v119
    v_exp_f32 v122, v122
    v_exp_f32 v123, v123
    v_cvt_pk_bf16_f32 v141, v120, v121
    v_exp_f32 v124, v124
    v_exp_f32 v125, v125
    v_cvt_pk_bf16_f32 v142, v122, v123
    s_nop 0
    v_cvt_pk_bf16_f32 v143, v124, v125
    s_waitcnt lgkmcnt(0)
    v_mfma_f32_16x16x16_bf16 v[130:133], v[36:37], v[138:139], 0
    v_mfma_f32_16x16x32_bf16 v[98:101], v[74:77], v[138:141], 0
    v_mfma_f32_16x16x32_bf16 v[102:105], v[80:83], v[138:141], 0
    v_mfma_f32_16x16x16_bf16 v[130:133], v[36:37], v[140:141], v[130:133]
    v_mfma_f32_16x16x32_bf16 v[106:109], v[86:89], v[138:141], 0
    v_mfma_f32_16x16x32_bf16 v[110:113], v[92:95], v[138:141], 0
    v_mfma_f32_16x16x16_bf16 v[130:133], v[36:37], v[142:143], v[130:133]
    v_mfma_f32_16x16x16_bf16 v[98:101], v[78:79], v[142:143], v[98:101]
    v_mfma_f32_16x16x16_bf16 v[102:105], v[84:85], v[142:143], v[102:105]
    v_mfma_f32_16x16x16_bf16 v[106:109], v[90:91], v[142:143], v[106:109]
    v_mfma_f32_16x16x16_bf16 v[110:113], v[96:97], v[142:143], v[110:113]
    s_nop 0
    v_rcp_f32 v130, v130
    s_nop 2
    v_pk_mul_f32 v[98:99], v[98:99], v[130:131] op_sel_hi:[1,0]
    v_pk_mul_f32 v[100:101], v[100:101], v[130:131] op_sel_hi:[1,0]
    v_cvt_pk_bf16_f32 v114, v98, v99
    v_cvt_pk_bf16_f32 v115, v100, v101
    v_pk_mul_f32 v[102:103], v[102:103], v[130:131] op_sel_hi:[1,0]
    v_pk_mul_f32 v[104:105], v[104:105], v[130:131] op_sel_hi:[1,0]
    v_cvt_pk_bf16_f32 v116, v102, v103
    v_cvt_pk_bf16_f32 v117, v104, v105
    ds_write_b128 v45, v[114:117] offset:56320
    v_pk_mul_f32 v[106:107], v[106:107], v[130:131] op_sel_hi:[1,0]
    v_pk_mul_f32 v[108:109], v[108:109], v[130:131] op_sel_hi:[1,0]
    v_cvt_pk_bf16_f32 v118, v106, v107
    v_cvt_pk_bf16_f32 v119, v108, v109
    v_pk_mul_f32 v[110:111], v[110:111], v[130:131] op_sel_hi:[1,0]
    v_pk_mul_f32 v[112:113], v[112:113], v[130:131] op_sel_hi:[1,0]
    v_cvt_pk_bf16_f32 v120, v110, v111
    v_cvt_pk_bf16_f32 v121, v112, v113
    ds_write_b128 v45, v[118:121] offset:57344
    s_mov_b64 exec, 1
    ds_add_u32 v49, v31 offset:62464
    s_mov_b64 exec, -1
    s_mov_b32 s74, 0
L_f_cl:
    ds_read_b32 v134, v49 offset:62464
    ds_read_b128 v[74:77], v18 offset:56320
    ds_read_b128 v[78:81], v18 offset:57344
    ds_read_b128 v[82:85], v18 offset:58368
    ds_read_b128 v[86:89], v18 offset:59392
    ds_read_b128 v[90:93], v18 offset:60416
    ds_read_b128 v[94:97], v18 offset:61440
    s_add_u32 s74, s74, 1
    s_cmp_gt_u32 s74, 4194304
    s_cbranch_scc1 L_chain_done
    s_waitcnt lgkmcnt(6)
    v_cmp_ne_u32 vcc, s75, v134
    s_cbranch_vccnz L_f_cl
    s_waitcnt lgkmcnt(5)
    v_mfma_f32_16x16x32_bf16 v[144:147], a[80:83], v[74:77], 0
    s_waitcnt lgkmcnt(4)
    v_mfma_f32_16x16x32_bf16 v[144:147], a[84:87], v[78:81], v[144:147]
    s_waitcnt lgkmcnt(3)
    v_mfma_f32_16x16x32_bf16 v[144:147], a[88:91], v[82:85], v[144:147]
    s_waitcnt lgkmcnt(2)
    v_mfma_f32_16x16x32_bf16 v[144:147], a[92:95], v[86:89], v[144:147]
    s_waitcnt lgkmcnt(1)
    v_mfma_f32_16x16x32_bf16 v[144:147], a[96:99], v[90:93], v[144:147]
    s_waitcnt lgkmcnt(0)
    v_mfma_f32_16x16x32_bf16 v[144:147], a[100:103], v[94:97], v[144:147]
    s_cmp_eq_u32 s60, 63
    s_cbranch_scc1 L_chain_done
    s_mov_b64 exec, s[62:63]
    s_nop 4
    v_cvt_pk_bf16_f32 v130, v144, v145
    v_cvt_pk_bf16_f32 v131, v146, v147
    v_and_or_b32 v130, v130, -2, s38
    buffer_store_dwordx2 v[130:131], v33, s[44:47], s53 offen sc1
    s_mov_b64 exec, -1
    s_sleep 4
    s_cmp_gt_u32 s60, 60
    s_cbranch_scc1 L_noxp_cl
    ds_read_b128 v[74:77], v4 offset:0
    ds_read_b128 v[78:81], v4 offset:20480
    ds_read_b128 v[82:85], v11 offset:0
    ds_read_b128 v[86:89], v11 offset:20480
    ds_read_b128 v[90:93], v4 offset:128
    ds_read_b128 v[94:97], v4 offset:20608
    ds_read_b128 v[98:101], v11 offset:128
    ds_read_b128 v[102:105], v11 offset:20608
    ds_read_b128 v[106:109], v4 offset:256
    ds_read_b128 v[110:113], v4 offset:20736
    s_waitcnt lgkmcnt(9)
    v_mfma_f32_16x16x32_bf16 v[122:125], a[0:3], v[74:77], 0
    ds_read_b128 v[74:77], v11 offset:256
    s_waitcnt lgkmcnt(9)
    v_mfma_f32_16x16x32_bf16 v[126:129], a[0:3], v[78:81], 0
    ds_read_b128 v[78:81], v11 offset:20736
    s_waitcnt lgkmcnt(9)
    v_mfma_f32_16x16x32_bf16 v[122:125], a[4:7], v[82:85], v[122:125]
    ds_read_b128 v[82:85], v4 offset:384
    s_waitcnt lgkmcnt(9)
    v_mfma_f32_16x16x32_bf16 v[126:129], a[4:7], v[86:89], v[126:129]
    ds_read_b128 v[86:89], v4 offset:20864
    s_waitcnt lgkmcnt(9)
    v_mfma_f32_16x16x32_bf16 v[122:125], a[8:11], v[90:93], v[122:125]
    ds_read_b128 v[90:93], v11 offset:384
    s_waitcnt lgkmcnt(9)
    v_mfma_f32_16x16x32_bf16 v[126:129], a[8:11], v[94:97], v[126:129]
    ds_read_b128 v[94:97], v11 offset:20864
    s_waitcnt lgkmcnt(9)
    v_mfma_f32_16x16x32_bf16 v[122:125], a[12:15], v[98:101], v[122:125]
    ds_read_b128 v[98:101], v4 offset:512
    s_waitcnt lgkmcnt(9)
    v_mfma_f32_16x16x32_bf16 v[126:129], a[12:15], v[102:105], v[126:129]
    ds_read_b128 v[102:105], v4 offset:20992
    s_waitcnt lgkmcnt(9)
    v_mfma_f32_16x16x32_bf16 v[122:125], a[16:19], v[106:109], v[122:125]
    ds_read_b128 v[106:109], v11 offset:512
    s_waitcnt lgkmcnt(9)
    v_mfma_f32_16x16x32_bf16 v[126:129], a[16:19], v[110:113], v[126:129]
    ds_read_b128 v[110:113], v11 offset:20992
    s_waitcnt lgkmcnt(9)
    v_mfma_f32_16x16x32_bf16 v[122:125], a[20:23], v[74:77], v[122:125]
    ds_read_b128 v[74:77], v4 offset:640
    s_waitcnt lgkmcnt(9)
    v_mfma_f32_16x16x32_bf16 v[126:129], a[20:23], v[78:81], v[126:129]
    ds_read_b128 v[78:81], v4 offset:21120
    s_waitcnt lgkmcnt(9)
    v_mfma_f32_16x16x32_bf16 v[122:125], a[24:27], v[82:85], v[122:125]
    ds_read_b128 v[82:85], v11 offset:640
    s_waitcnt lgkmcnt(9)
    v_mfma_f32_16x16x32_bf16 v[126:129], a[24:27], v[86:89], v[126:129]
    ds_read_b128 v[86:89], v11 offset:21120
    s_waitcnt lgkmcnt(9)
    v_mfma_f32_16x16x32_bf16 v[122:125], a[28:31], v[90:93], v[122:125]
    ds_read_b128 v[90:93], v4 offset:768
    s_waitcnt lgkmcnt(9)
    v_mfma_f32_16x16x32_bf16 v[126:129], a[28:31], v[94:97], v[126:129]
    ds_read_b128 v[94:97], v4 offset:21248
    s_waitcnt lgkmcnt(9)
    v_mfma_f32_16x16x32_bf16 v[122:125], a[32:35], v[98:101], v[122:125]
    ds_read_b128 v[98:101], v11 offset:768
    s_cmp_gt_u32 s60, 59
    s_cbranch_scc1 L_nodma_cl
    s_add_u32 s75, s72, 0
    s_mov_b32 m0, s75
    s_add_u32 s75, s71, 0
    buffer_load_dwordx4 v16, s[32:35], s75 offen lds
    s_add_u32 s75, s72, 5120
    s_mov_b32 m0, s75
    s_add_u32 s75, s71, 5120
    buffer_load_dwordx4 v21, s[32:35], s75 offen lds
    s_add_u32 s75, s72, 10240
    s_mov_b32 m0, s75
    s_add_u32 s75, s71, 10240
    buffer_load_dwordx4 v16, s[32:35], s75 offen lds
    s_add_u32 s75, s72, 15360
    s_mov_b32 m0, s75
    s_add_u32 s75, s71, 15360
    buffer_load_dwordx4 v21, s[32:35], s75 offen lds
    s_add_u32 s75, s72, 20480
    s_mov_b32 m0, s75
    s_add_u32 s75, s71, 20480
    buffer_load_dwordx4 v16, s[32:35], s75 offen lds
    s_add_u32 s75, s72, 25600
    s_mov_b32 m0, s75
    s_add_u32 s75, s71, 25600
    buffer_load_dwordx4 v21, s[32:35], s75 offen lds
    s_add_u32 s75, s72, 30720
    s_mov_b32 m0, s75
    s_add_u32 s75, s71, 30720
    buffer_load_dwordx4 v16, s[32:35], s75 offen lds
    s_add_u32 s75, s72, 35840
    s_mov_b32 m0, s75
    s_add_u32 s75, s71, 35840
    buffer_load_dwordx4 v21, s[32:35], s75 offen lds
    s_add_u32 s71, s71, 40960
    s_sub_u32 s72, s3, s72
L_nodma_cl:
    s_waitcnt lgkmcnt(9)
    v_mfma_f32_16x16x32_bf16 v[126:129], a[32:35], v[102:105], v[126:129]
    ds_read_b128 v[102:105], v11 offset:21248
    s_waitcnt lgkmcnt(9)
    v_mfma_f32_16x16x32_bf16 v[122:125], a[36:39], v[106:109], v[122:125]
    ds_read_b128 v[106:109], v4 offset:896
    s_waitcnt lgkmcnt(9)
    v_mfma_f32_16x16x32_bf16 v[126:129], a[36:39], v[110:113], v[126:129]
    ds_read_b128 v[110:113], v4 offset:21376
    s_waitcnt lgkmcnt(9)
    v_mfma_f32_16x16x32_bf16 v[122:125], a[40:43], v[74:77], v[122:125]
    ds_read_b128 v[74:77], v11 offset:896
    s_waitcnt lgkmcnt(9)
    v_mfma_f32_16x16x32_bf16 v[126:129], a[40:43], v[78:81], v[126:129]
    ds_read_b128 v[78:81], v11 offset:21376
    s_waitcnt lgkmcnt(9)
    v_mfma_f32_16x16x32_bf16 v[122:125], a[44:47], v[82:85], v[122:125]
    ds_read_b128 v[82:85], v4 offset:1024
    s_waitcnt lgkmcnt(9)
    v_mfma_f32_16x16x32_bf16 v[126:129], a[44:47], v[86:89], v[126:129]
    ds_read_b128 v[86:89], v4 offset:21504
    s_waitcnt lgkmcnt(9)
    v_mfma_f32_16x16x32_bf16 v[122:125], a[48:51], v[90:93], v[122:125]
    ds_read_b128 v[90:93], v11 offset:1024
    s_waitcnt lgkmcnt(9)
    v_mfma_f32_16x16x32_bf16 v[126:129], a[48:51], v[94:97], v[126:129]
    ds_read_b128 v[94:97], v11 offset:21504
    s_waitcnt lgkmcnt(9)
    v_mfma_f32_16x16x32_bf16 v[122:125], a[52:55], v[98:101], v[122:125]
    ds_read_b128 v[98:101], v4 offset:1152
    s_waitcnt lgkmcnt(9)
    v_mfma_f32_16x16x32_bf16 v[126:129], a[52:55], v[102:105], v[126:129]
    ds_read_b128 v[102:105], v4 offset:21632
    s_waitcnt lgkmcnt(9)
    v_mfma_f32_16x16x32_bf16 v[122:125], a[56:59], v[106:109], v[122:125]
    ds_read_b128 v[106:109], v11 offset:1152
    s_waitcnt lgkmcnt(9)
    v_mfma_f32_16x16x32_bf16 v[126:129], a[56:59], v[110:113], v[126:129]
    ds_read_b128 v[110:113], v11 offset:21632
    s_waitcnt lgkmcnt(9)
    v_mfma_f32_16x16x32_bf16 v[122:125], a[60:63], v[74:77], v[122:125]
    s_waitcnt lgkmcnt(8)
    v_mfma_f32_16x16x32_bf16 v[126:129], a[60:63], v[78:81], v[126:129]
    s_waitcnt lgkmcnt(7)
    v_mfma_f32_16x16x32_bf16 v[122:125], a[64:67], v[82:85], v[122:125]
    s_waitcnt lgkmcnt(6)
    v_mfma_f32_16x16x32_bf16 v[126:129], a[64:67], v[86:89], v[126:129]
    s_waitcnt lgkmcnt(5)
    v_mfma_f32_16x16x32_bf16 v[122:125], a[68:71], v[90:93], v[122:125]
    s_waitcnt lgkmcnt(4)
    v_mfma_f32_16x16x32_bf16 v[126:129], a[68:71], v[94:97], v[126:129]
    s_waitcnt lgkmcnt(3)
    v_mfma_f32_16x16x32_bf16 v[122:125], a[72:75], v[98:101], v[122:125]
    s_waitcnt lgkmcnt(2)
    v_mfma_f32_16x16x32_bf16 v[126:129], a[72:75], v[102:105], v[126:129]
    s_waitcnt lgkmcnt(1)
    v_mfma_f32_16x16x32_bf16 v[122:125], a[76:79], v[106:109], v[122:125]
    s_waitcnt lgkmcnt(0)
    v_mfma_f32_16x16x32_bf16 v[126:129], a[76:79], v[110:113], v[126:129]
    s_nop 7
    v_cvt_pk_bf16_f32 v6, v122, v123
    v_cvt_pk_bf16_f32 v7, v124, v125
    v_cvt_pk_bf16_f32 v8, v126, v127
    v_cvt_pk_bf16_f32 v9, v128, v129
    v_add_u32 v4, s9, v4
    v_add_u32 v11, s9, v11
    s_sub_u32 s9, 0, s9
L_noxp_cl:
    s_mov_b32 s74, 0
    buffer_load_dwordx4 v[114:117], v18, s[44:47], s52 offen sc1
    buffer_load_dwordx4 v[118:121], v18, s[44:47], s52 offen offset:1024 sc1
    s_sleep 8
.p2align 5
L_p2_cl:
    buffer_load_dwordx4 v[74:77], v18, s[44:47], s52 offen sc1
    buffer_load_dwordx4 v[78:81], v18, s[44:47], s52 offen offset:1024 sc1
    s_waitcnt vmcnt(2)
    v_bitop3_b32 v138, v114, s39, v116 bitop3:0x24
    v_bitop3_b32 v139, v118, s39, v120 bitop3:0x24
    v_bitop3_b32 v138, v138, 1, v139 bitop3:0x80
    v_cmp_eq_u32 vcc, 0, v138
    s_cbranch_vccnz L_p2b_cl
    v_mfma_f32_16x16x32_bf16 v[130:133], v[24:27], v[114:117], 0
    v_mfma_f32_16x16x32_bf16 v[130:133], v[24:27], v[118:121], v[130:133]
    s_add_u32 s52, s52, s37
    s_add_u32 s53, s53, s37
    s_sub_u32 s37, 0, s37
    s_nop 4
    v_add_f32_dpp v134, v130, v130 row_ror:4 row_mask:0xf bank_mask:0xf
    v_add_f32_dpp v135, v131, v131 row_ror:4 row_mask:0xf bank_mask:0xf
    v_add_f32_dpp v136, v132, v132 row_ror:4 row_mask:0xf bank_mask:0xf
    v_add_f32_dpp v137, v133, v133 row_ror:4 row_mask:0xf bank_mask:0xf
    v_add_f32_dpp v130, v134, v134 row_ror:8 row_mask:0xf bank_mask:0xf
    v_add_f32_dpp v131, v135, v135 row_ror:8 row_mask:0xf bank_mask:0xf
    v_add_f32_dpp v132, v136, v136 row_ror:8 row_mask:0xf bank_mask:0xf
    v_add_f32_dpp v133, v137, v137 row_ror:8 row_mask:0xf bank_mask:0xf
    s_mov_b64 exec, s[22:23]
    v_cvt_pk_bf16_f32 v130, v130, v131
    v_cvt_pk_bf16_f32 v131, v132, v133
    v_and_or_b32 v130, v130, -2, s68
    buffer_store_dwordx2 v[130:131], v41, s[44:47], s54 offen
    s_mov_b64 exec, -1
L_a3_cl:
    s_barrier
    ds_write_b128 v28, v[50:53]
    ds_write_b128 v38, v[62:65]
    ds_write_b128 v29, v[54:57]
    ds_write_b128 v39, v[66:69]
    s_mov_b32 s74, 0
.p2align 5
L_p3_cl:
    buffer_load_dwordx4 v[130:133], v17, s[44:47], s55 offen sc1
    buffer_load_dwordx4 v[134:137], v17, s[44:47], s56 offen sc1
    s_add_u32 s74, s74, 1
    s_cmp_gt_u32 s74, 4194304
    s_cbranch_scc1 L_chain_done
    s_waitcnt vmcnt(0)
    v_bitop3_b32 v138, v130, s69, v132 bitop3:0x24
    v_bitop3_b32 v139, v134, s69, v136 bitop3:0x24
    v_bitop3_b32 v138, v138, 1, v139 bitop3:0x80
    v_cmp_eq_u32 vcc, 0, v138
    s_cbranch_vccnz L_p3_cl
    ds_write_b64 v42, v[130:131] offset:0
    ds_write_b64 v42, v[132:133] offset:1296
    ds_write_b64 v43, v[134:135] offset:0
    ds_write_b64 v43, v[136:137] offset:1296
    s_add_u32 s60, s60, 1
    s_branch L_top_cl
.p2align 5
L_p1b_cl:
    buffer_load_dwordx4 v[130:133], v17, s[44:47], s57 offen sc1
    buffer_load_dwordx4 v[134:137], v17, s[44:47], s50 offen sc1
    s_add_u32 s74, s74, 1
    s_cmp_gt_u32 s74, 4194304
    s_cbranch_scc1 L_chain_done
    s_waitcnt vmcnt(2)
    v_bitop3_b32 v138, v140, s69, v142 bitop3:0x24
    v_bitop3_b32 v139, v144, s69, v146 bitop3:0x24
    v_bitop3_b32 v138, v138, 1, v139 bitop3:0x80
    v_cmp_eq_u32 vcc, 0, v138
    s_cbranch_vccnz L_p1_cl
    ds_write_b128 v46, v[140:143]
    ds_write_b128 v47, v[144:147]
    s_branch L_p1e_cl
.p2align 5
L_p2b_cl:
    buffer_load_dwordx4 v[114:117], v18, s[44:47], s52 offen sc1
    buffer_load_dwordx4 v[118:121], v18, s[44:47], s52 offen offset:1024 sc1
    s_add_u32 s74, s74, 1
    s_cmp_gt_u32 s74, 4194304
    s_cbranch_scc1 L_chain_done
    s_waitcnt vmcnt(2)
    v_bitop3_b32 v138, v74, s39, v76 bitop3:0x24
    v_bitop3_b32 v139, v78, s39, v80 bitop3:0x24
    v_bitop3_b32 v138, v138, 1, v139 bitop3:0x80
    v_cmp_eq_u32 vcc, 0, v138
    s_cbranch_vccnz L_p2_cl
    v_mfma_f32_16x16x32_bf16 v[130:133], v[24:27], v[74:77], 0
    v_mfma_f32_16x16x32_bf16 v[130:133], v[24:27], v[78:81], v[130:133]
    s_add_u32 s52, s52, s37
    s_add_u32 s53, s53, s37
    s_sub_u32 s37, 0, s37
    s_nop 4
    v_add_f32_dpp v134, v130, v130 row_ror:4 row_mask:0xf bank_mask:0xf
    v_add_f32_dpp v135, v131, v131 row_ror:4 row_mask:0xf bank_mask:0xf
    v_add_f32_dpp v136, v132, v132 row_ror:4 row_mask:0xf bank_mask:0xf
    v_add_f32_dpp v137, v133, v133 row_ror:4 row_mask:0xf bank_mask:0xf
    v_add_f32_dpp v130, v134, v134 row_ror:8 row_mask:0xf bank_mask:0xf
    v_add_f32_dpp v131, v135, v135 row_ror:8 row_mask:0xf bank_mask:0xf
    v_add_f32_dpp v132, v136, v136 row_ror:8 row_mask:0xf bank_mask:0xf
    v_add_f32_dpp v133, v137, v137 row_ror:8 row_mask:0xf bank_mask:0xf
    s_mov_b64 exec, s[22:23]
    v_cvt_pk_bf16_f32 v130, v130, v131
    v_cvt_pk_bf16_f32 v131, v132, v133
    v_and_or_b32 v130, v130, -2, s68
    buffer_store_dwordx2 v[130:131], v41, s[44:47], s54 offen
    s_mov_b64 exec, -1
    s_branch L_a3_cl
.p2align 5
L_top_hl:
    s_waitcnt lgkmcnt(0)
    s_barrier
    ds_read_b128 v[74:77], v5 offset:0
    ds_read_b128 v[78:81], v5 offset:128
    ds_read_b128 v[82:85], v5 offset:256
    ds_read_b128 v[86:89], v5 offset:384
    ds_read_b128 v[90:93], v5 offset:512
    ds_read_b128 v[94:97], v5 offset:640
    ds_read_b128 v[98:101], v5 offset:768
    ds_read_b128 v[102:105], v5 offset:896
    ds_read_b128 v[106:109], v5 offset:1024
    ds_read_b128 v[110:113], v5 offset:1152
    s_add_u32 s68, s60, 1
    s_and_b32 s68, s68, 1
    s_xor_b32 s69, s68, 1
    s_bfe_u32 s39, s60, 0x10001
    s_xor_b32 s38, s39, 1
    s_waitcnt lgkmcnt(9)
    v_mfma_f32_16x16x32_bf16 v[114:117], v[74:77], a[0:3], 0
    v_mfma_f32_16x16x32_bf16 v[118:121], v[74:77], a[4:7], 0
    s_waitcnt lgkmcnt(8)
    v_mfma_f32_16x16x32_bf16 v[114:117], v[78:81], a[8:11], v[114:117]
    v_mfma_f32_16x16x32_bf16 v[118:121], v[78:81], a[12:15], v[118:121]
    s_waitcnt lgkmcnt(7)
    v_mfma_f32_16x16x32_bf16 v[114:117], v[82:85], a[16:19], v[114:117]
    v_mfma_f32_16x16x32_bf16 v[118:121], v[82:85], a[20:23], v[118:121]
    s_waitcnt lgkmcnt(6)
    v_mfma_f32_16x16x32_bf16 v[114:117], v[86:89], a[24:27], v[114:117]
    v_mfma_f32_16x16x32_bf16 v[118:121], v[86:89], a[28:31], v[118:121]
    s_waitcnt lgkmcnt(5)
    v_mfma_f32_16x16x32_bf16 v[114:117], v[90:93], a[32:35], v[114:117]
    v_mfma_f32_16x16x32_bf16 v[118:121], v[90:93], a[36:39], v[118:121]
    s_waitcnt lgkmcnt(4)
    v_mfma_f32_16x16x32_bf16 v[114:117], v[94:97], a[40:43], v[114:117]
    v_mfma_f32_16x16x32_bf16 v[118:121], v[94:97], a[44:47], v[118:121]
    s_waitcnt lgkmcnt(3)
    v_mfma_f32_16x16x32_bf16 v[114:117], v[98:101], a[48:51], v[114:117]
    v_mfma_f32_16x16x32_bf16 v[118:121], v[98:101], a[52:55], v[118:121]
    s_waitcnt lgkmcnt(2)
    v_mfma_f32_16x16x32_bf16 v[114:117], v[102:105], a[56:59], v[114:117]
    v_mfma_f32_16x16x32_bf16 v[118:121], v[102:105], a[60:63], v[118:121]
    s_waitcnt lgkmcnt(1)
    v_mfma_f32_16x16x32_bf16 v[114:117], v[106:109], a[64:67], v[114:117]
    v_mfma_f32_16x16x32_bf16 v[118:121], v[106:109], a[68:71], v[118:121]
    s_waitcnt lgkmcnt(0)
    v_mfma_f32_16x16x32_bf16 v[114:117], v[110:113], a[72:75], v[114:117]
    v_mfma_f32_16x16x32_bf16 v[118:121], v[110:113], a[76:79], v[118:121]
    s_nop 7
    v_permlane32_swap_b32 v118, v122
    v_permlane32_swap_b32 v119, v123
    v_permlane32_swap_b32 v120, v124
    v_permlane32_swap_b32 v121, v125
    s_nop 1
    v_add_f32 v114, v114, v122
    v_add_f32 v115, v115, v123
    v_add_f32 v116, v116, v124
    v_add_f32 v117, v117, v125
    s_mov_b64 exec, s[66:67]
    v_cvt_pk_bf16_f32 v132, v114, v115
    v_cvt_pk_bf16_f32 v133, v116, v117
    v_and_or_b32 v132, v132, -2, s68
    buffer_store_dwordx2 v[132:133], v23, s[44:47], s51 offen
    s_mov_b64 exec, -1
    s_add_u32 s75, s60, 2
    s_and_b32 s73, s75, 3
    s_mul_i32 s73, s73, 1179648
    s_add_u32 s73, s73, s14
    s_add_u32 s75, s60, 1
    s_and_b32 s61, s75, 3
    s_mul_i32 s61, s61, 1179648
    s_add_u32 s61, s61, s14
    s_mul_i32 s70, s60, 393216
    s_add_u32 s70, s70, s58
    s_mul_i32 s75, s75, 3
    s_mov_b32 s74, 0
    buffer_load_dwordx4 v[130:133], v17, s[44:47], s57 offen sc1
    buffer_load_dwordx4 v[134:137], v17, s[44:47], s50 offen sc1
    s_sleep 4
.p2align 5
L_p1_hl:
    buffer_load_dwordx4 v[140:143], v17, s[44:47], s57 offen sc1
    buffer_load_dwordx4 v[144:147], v17, s[44:47], s50 offen sc1
    s_waitcnt vmcnt(2)
    v_bitop3_b32 v138, v130, s69, v132 bitop3:0x24
    v_bitop3_b32 v139, v134, s69, v136 bitop3:0x24
    v_bitop3_b32 v138, v138, 1, v139 bitop3:0x80
    v_cmp_eq_u32 vcc, 0, v138
    s_cbranch_vccnz L_p1b_hl
    ds_write_b128 v46, v[130:133]
    ds_write_b128 v47, v[134:137]
L_p1e_hl:
    s_waitcnt lgkmcnt(0)
    s_barrier
    s_waitcnt vmcnt(0)
    buffer_load_dwordx4 v[50:53], v12, s[28:31], s61 offen sc1
    buffer_load_dwordx4 v[62:65], v12, s[28:31], s61 offen offset:1536 sc1
    buffer_load_dwordx4 v[54:57], v13, s[28:31], s61 offen sc1
    buffer_load_dwordx4 v[66:69], v13, s[28:31], s61 offen offset:1536 sc1
    buffer_load_dwordx4 v[58:61], v14, s[28:31], s61 offen sc1
    buffer_load_dwordx4 v[70:73], v14, s[28:31], s61 offen offset:1536 sc1
    s_mov_b64 exec, s[100:101]
    buffer_load_dwordx4 v[148:151], v34, s[28:31], s61 offen sc1
    s_mov_b64 exec, -1
    s_cmp_gt_u32 s60, 61
    s_cbranch_scc1 L_chain_nosthl
    s_add_u32 s17, s73, s16
    s_mov_b64 exec, s[18:19]
    buffer_store_dwordx2 v[6:7], v44, s[28:31], s73 offen sc1
    buffer_store_dwordx2 v[8:9], v44, s[28:31], s17 offen sc1
    s_mov_b64 exec, -1
L_chain_nosthl:
    s_cmp_gt_u32 s60, 60
    s_cbranch_scc1 L_noxp_hl
    ds_read_b128 v[74:77], v4 offset:0
    ds_read_b128 v[78:81], v11 offset:0
    ds_read_b128 v[82:85], v4 offset:128
    ds_read_b128 v[86:89], v11 offset:128
    ds_read_b128 v[90:93], v4 offset:256
    ds_read_b128 v[94:97], v11 offset:256
    ds_read_b128 v[98:101], v4 offset:384
    ds_read_b128 v[102:105], v11 offset:384
    ds_read_b128 v[106:109], v4 offset:512
    ds_read_b128 v[110:113], v11 offset:512
    s_waitcnt lgkmcnt(9)
    v_mfma_f32_16x16x32_bf16 v[122:125], v[74:77], a[0:3], 0
    ds_read_b128 v[74:77], v4 offset:640
    s_waitcnt lgkmcnt(9)
    v_mfma_f32_16x16x32_bf16 v[126:129], v[78:81], a[4:7], 0
    ds_read_b128 v[78:81], v11 offset:640
    s_waitcnt lgkmcnt(9)
    v_mfma_f32_16x16x32_bf16 v[122:125], v[82:85], a[8:11], v[122:125]
    ds_read_b128 v[82:85], v4 offset:768
    s_waitcnt lgkmcnt(9)
    v_mfma_f32_16x16x32_bf16 v[126:129], v[86:89], a[12:15], v[126:129]
    ds_read_b128 v[86:89], v11 offset:768
    s_waitcnt lgkmcnt(9)
    v_mfma_f32_16x16x32_bf16 v[122:125], v[90:93], a[16:19], v[122:125]
    ds_read_b128 v[90:93], v4 offset:896
    s_waitcnt lgkmcnt(9)
    v_mfma_f32_16x16x32_bf16 v[126:129], v[94:97], a[20:23], v[126:129]
    ds_read_b128 v[94:97], v11 offset:896
    s_waitcnt lgkmcnt(9)
    v_mfma_f32_16x16x32_bf16 v[122:125], v[98:101], a[24:27], v[122:125]
    ds_read_b128 v[98:101], v4 offset:1024
    s_waitcnt lgkmcnt(9)
    v_mfma_f32_16x16x32_bf16 v[126:129], v[102:105], a[28:31], v[126:129]
    ds_read_b128 v[102:105], v11 offset:1024
    s_waitcnt lgkmcnt(9)
    v_mfma_f32_16x16x32_bf16 v[122:125], v[106:109], a[32:35], v[122:125]
    ds_read_b128 v[106:109], v4 offset:1152
    s_waitcnt lgkmcnt(9)
    v_mfma_f32_16x16x32_bf16 v[126:129], v[110:113], a[36:39], v[126:129]
    ds_read_b128 v[110:113], v11 offset:1152
    s_waitcnt lgkmcnt(9)
    v_mfma_f32_16x16x32_bf16 v[122:125], v[74:77], a[40:43], v[122:125]
    s_waitcnt lgkmcnt(8)
    v_mfma_f32_16x16x32_bf16 v[126:129], v[78:81], a[44:47], v[126:129]
    s_waitcnt lgkmcnt(7)
    v_mfma_f32_16x16x32_bf16 v[122:125], v[82:85], a[48:51], v[122:125]
    s_waitcnt lgkmcnt(6)
    v_mfma_f32_16x16x32_bf16 v[126:129], v[86:89], a[52:55], v[126:129]
    s_waitcnt lgkmcnt(5)
    v_mfma_f32_16x16x32_bf16 v[122:125], v[90:93], a[56:59], v[122:125]
    s_waitcnt lgkmcnt(4)
    v_mfma_f32_16x16x32_bf16 v[126:129], v[94:97], a[60:63], v[126:129]
    s_waitcnt lgkmcnt(3)
    v_mfma_f32_16x16x32_bf16 v[122:125], v[98:101], a[64:67], v[122:125]
    s_waitcnt lgkmcnt(2)
    v_mfma_f32_16x16x32_bf16 v[126:129], v[102:105], a[68:71], v[126:129]
    s_waitcnt lgkmcnt(1)
    v_mfma_f32_16x16x32_bf16 v[122:125], v[106:109], a[72:75], v[122:125]
    s_waitcnt lgkmcnt(0)
    v_mfma_f32_16x16x32_bf16 v[126:129], v[110:113], a[76:79], v[126:129]
    s_nop 7
    v_pk_add_f32 v[122:123], v[122:123], v[126:127]
    v_pk_add_f32 v[124:125], v[124:125], v[128:129]
    v_cvt_pk_bf16_f32 v6, v122, v123
    v_cvt_pk_bf16_f32 v7, v124, v125
L_noxp_hl:
    s_mov_b32 s17, s70
    s_add_u32 s70, s60, 1
    s_mov_b32 s74, 0
.p2align 5
L_f_hl:
    ds_read_b32 v134, v49 offset:62464
    s_add_u32 s74, s74, 1
    s_cmp_gt_u32 s74, 4194304
    s_cbranch_scc1 L_chain_done
    s_waitcnt lgkmcnt(0)
    v_cmp_ne_u32 vcc, s75, v134
    s_cbranch_vccnz L_f_hl
    ds_read_b128 v[74:77], v18 offset:56320
    ds_read_b128 v[78:81], v18 offset:57344
    ds_read_b128 v[82:85], v18 offset:58368
    ds_read_b128 v[86:89], v18 offset:59392
    ds_read_b128 v[90:93], v18 offset:60416
    ds_read_b128 v[94:97], v18 offset:61440
    s_waitcnt lgkmcnt(5)
    v_mfma_f32_16x16x32_bf16 v[144:147], a[80:83], v[74:77], 0
    s_waitcnt lgkmcnt(4)
    v_mfma_f32_16x16x32_bf16 v[144:147], a[84:87], v[78:81], v[144:147]
    s_waitcnt lgkmcnt(3)
    v_mfma_f32_16x16x32_bf16 v[144:147], a[88:91], v[82:85], v[144:147]
    s_waitcnt lgkmcnt(2)
    v_mfma_f32_16x16x32_bf16 v[144:147], a[92:95], v[86:89], v[144:147]
    s_waitcnt lgkmcnt(1)
    v_mfma_f32_16x16x32_bf16 v[144:147], a[96:99], v[90:93], v[144:147]
    s_waitcnt lgkmcnt(0)
    v_mfma_f32_16x16x32_bf16 v[144:147], a[100:103], v[94:97], v[144:147]
    s_cmp_eq_u32 s60, 63
    s_cselect_b64 exec, 0, s[62:63]
    s_nop 5
    v_cvt_pk_bf16_f32 v130, v144, v145
    v_cvt_pk_bf16_f32 v131, v146, v147
    v_and_or_b32 v130, v130, -2, s38
    buffer_store_dwordx2 v[130:131], v33, s[44:47], s53 offen sc1
    s_sleep 2
    s_mov_b64 exec, s[12:13]
    buffer_store_dwordx2 v[86:87], v36, s[40:43], s17 offen offset:192
    buffer_store_dwordx2 v[88:89], v36, s[40:43], s17 offen offset:224
    buffer_store_dwordx2 v[90:91], v36, s[40:43], s17 offen offset:256
    buffer_store_dwordx2 v[92:93], v36, s[40:43], s17 offen offset:288
    buffer_store_dwordx2 v[94:95], v36, s[40:43], s17 offen offset:320
    buffer_store_dwordx2 v[96:97], v36, s[40:43], s17 offen offset:352
    s_mov_b64 exec, -1
    s_cmp_eq_u32 s60, 63
    s_cbranch_scc1 L_chain_done
    s_cmp_gt_u32 s60, 59
    s_cbranch_scc1 L_nodma_hl
    s_add_u32 s75, s72, 0
    s_mov_b32 m0, s75
    s_add_u32 s75, s71, 0
    buffer_load_dwordx4 v16, s[32:35], s75 offen lds
    s_add_u32 s75, s72, 5120
    s_mov_b32 m0, s75
    s_add_u32 s75, s71, 5120
    buffer_load_dwordx4 v21, s[32:35], s75 offen lds
    s_add_u32 s75, s72, 10240
    s_mov_b32 m0, s75
    s_add_u32 s75, s71, 10240
    buffer_load_dwordx4 v16, s[32:35], s75 offen lds
    s_add_u32 s75, s72, 15360
    s_mov_b32 m0, s75
    s_add_u32 s75, s71, 15360
    buffer_load_dwordx4 v21, s[32:35], s75 offen lds
    s_add_u32 s75, s72, 20480
    s_mov_b32 m0, s75
    s_add_u32 s75, s71, 20480
    buffer_load_dwordx4 v16, s[32:35], s75 offen lds
    s_add_u32 s75, s72, 25600
    s_mov_b32 m0, s75
    s_add_u32 s75, s71, 25600
    buffer_load_dwordx4 v21, s[32:35], s75 offen lds
    s_add_u32 s75, s72, 30720
    s_mov_b32 m0, s75
    s_add_u32 s75, s71, 30720
    buffer_load_dwordx4 v16, s[32:35], s75 offen lds
    s_add_u32 s75, s72, 35840
    s_mov_b32 m0, s75
    s_add_u32 s75, s71, 35840
    buffer_load_dwordx4 v21, s[32:35], s75 offen lds
    s_add_u32 s71, s71, 40960
    s_sub_u32 s72, s3, s72
L_nodma_hl:
    s_cmp_gt_u32 s60, 60
    s_cbranch_scc1 L_noxq_hl
    ds_read_b128 v[74:77], v4 offset:20480
    ds_read_b128 v[78:81], v11 offset:20480
    ds_read_b128 v[82:85], v4 offset:20608
    ds_read_b128 v[86:89], v11 offset:20608
    ds_read_b128 v[90:93], v4 offset:20736
    ds_read_b128 v[94:97], v11 offset:20736
    ds_read_b128 v[98:101], v4 offset:20864
    ds_read_b128 v[102:105], v11 offset:20864
    ds_read_b128 v[106:109], v4 offset:20992
    ds_read_b128 v[110:113], v11 offset:20992
    s_waitcnt lgkmcnt(9)
    v_mfma_f32_16x16x32_bf16 v[122:125], v[74:77], a[0:3], 0
    ds_read_b128 v[74:77], v4 offset:21120
    s_waitcnt lgkmcnt(9)
    v_mfma_f32_16x16x32_bf16 v[126:129], v[78:81], a[4:7], 0
    ds_read_b128 v[78:81], v11 offset:21120
    s_waitcnt lgkmcnt(9)
    v_mfma_f32_16x16x32_bf16 v[122:125], v[82:85], a[8:11], v[122:125]
    ds_read_b128 v[82:85], v4 offset:21248
    s_waitcnt lgkmcnt(9)
    v_mfma_f32_16x16x32_bf16 v[126:129], v[86:89], a[12:15], v[126:129]
    ds_read_b128 v[86:89], v11 offset:21248
    s_waitcnt lgkmcnt(9)
    v_mfma_f32_16x16x32_bf16 v[122:125], v[90:93], a[16:19], v[122:125]
    ds_read_b128 v[90:93], v4 offset:21376
    s_waitcnt lgkmcnt(9)
    v_mfma_f32_16x16x32_bf16 v[126:129], v[94:97], a[20:23], v[126:129]
    ds_read_b128 v[94:97], v11 offset:21376
    s_waitcnt lgkmcnt(9)
    v_mfma_f32_16x16x32_bf16 v[122:125], v[98:101], a[24:27], v[122:125]
    ds_read_b128 v[98:101], v4 offset:21504
    s_waitcnt lgkmcnt(9)
    v_mfma_f32_16x16x32_bf16 v[126:129], v[102:105], a[28:31], v[126:129]
    ds_read_b128 v[102:105], v11 offset:21504
    s_waitcnt lgkmcnt(9)
    v_mfma_f32_16x16x32_bf16 v[122:125], v[106:109], a[32:35], v[122:125]
    ds_read_b128 v[106:109], v4 offset:21632
    s_waitcnt lgkmcnt(9)
    v_mfma_f32_16x16x32_bf16 v[126:129], v[110:113], a[36:39], v[126:129]
    ds_read_b128 v[110:113], v11 offset:21632
    s_waitcnt lgkmcnt(9)
    v_mfma_f32_16x16x32_bf16 v[122:125], v[74:77], a[40:43], v[122:125]
    s_waitcnt lgkmcnt(8)
    v_mfma_f32_16x16x32_bf16 v[126:129], v[78:81], a[44:47], v[126:129]
    s_waitcnt lgkmcnt(7)
    v_mfma_f32_16x16x32_bf16 v[122:125], v[82:85], a[48:51], v[122:125]
    s_waitcnt lgkmcnt(6)
    v_mfma_f32_16x16x32_bf16 v[126:129], v[86:89], a[52:55], v[126:129]
    s_waitcnt lgkmcnt(5)
    v_mfma_f32_16x16x32_bf16 v[122:125], v[90:93], a[56:59], v[122:125]
    s_waitcnt lgkmcnt(4)
    v_mfma_f32_16x16x32_bf16 v[126:129], v[94:97], a[60:63], v[126:129]
    s_waitcnt lgkmcnt(3)
    v_mfma_f32_16x16x32_bf16 v[122:125], v[98:101], a[64:67], v[122:125]
    s_waitcnt lgkmcnt(2)
    v_mfma_f32_16x16x32_bf16 v[126:129], v[102:105], a[68:71], v[126:129]
    s_waitcnt lgkmcnt(1)
    v_mfma_f32_16x16x32_bf16 v[122:125], v[106:109], a[72:75], v[122:125]
    s_waitcnt lgkmcnt(0)
    v_mfma_f32_16x16x32_bf16 v[126:129], v[110:113], a[76:79], v[126:129]
    s_nop 7
    v_pk_add_f32 v[122:123], v[122:123], v[126:127]
    v_pk_add_f32 v[124:125], v[124:125], v[128:129]
    v_cvt_pk_bf16_f32 v8, v122, v123
    v_cvt_pk_bf16_f32 v9, v124, v125
    v_add_u32 v4, s9, v4
    v_add_u32 v11, s9, v11
    s_sub_u32 s9, 0, s9
L_noxq_hl:
    s_mov_b32 s74, 0
    buffer_load_dwordx4 v[114:117], v18, s[44:47], s52 offen sc1
    buffer_load_dwordx4 v[118:121], v18, s[44:47], s52 offen offset:1024 sc1
    s_sleep 8
.p2align 5
L_p2_hl:
    buffer_load_dwordx4 v[74:77], v18, s[44:47], s52 offen sc1
    buffer_load_dwordx4 v[78:81], v18, s[44:47], s52 offen offset:1024 sc1
    s_waitcnt vmcnt(2)
    v_bitop3_b32 v138, v114, s39, v116 bitop3:0x24
    v_bitop3_b32 v139, v118, s39, v120 bitop3:0x24
    v_bitop3_b32 v138, v138, 1, v139 bitop3:0x80
    v_cmp_eq_u32 vcc, 0, v138
    s_cbranch_vccnz L_p2b_hl
    v_mfma_f32_16x16x32_bf16 v[130:133], v[24:27], v[114:117], 0
    v_mfma_f32_16x16x32_bf16 v[130:133], v[24:27], v[118:121], v[130:133]
    s_add_u32 s52, s52, s37
    s_add_u32 s53, s53, s37
    s_sub_u32 s37, 0, s37
    s_nop 4
    v_add_f32_dpp v134, v130, v130 row_ror:4 row_mask:0xf bank_mask:0xf
    v_add_f32_dpp v135, v131, v131 row_ror:4 row_mask:0xf bank_mask:0xf
    v_add_f32_dpp v136, v132, v132 row_ror:4 row_mask:0xf bank_mask:0xf
    v_add_f32_dpp v137, v133, v133 row_ror:4 row_mask:0xf bank_mask:0xf
    v_add_f32_dpp v130, v134, v134 row_ror:8 row_mask:0xf bank_mask:0xf
    v_add_f32_dpp v131, v135, v135 row_ror:8 row_mask:0xf bank_mask:0xf
    v_add_f32_dpp v132, v136, v136 row_ror:8 row_mask:0xf bank_mask:0xf
    v_add_f32_dpp v133, v137, v137 row_ror:8 row_mask:0xf bank_mask:0xf
    s_mov_b64 exec, s[22:23]
    v_cvt_pk_bf16_f32 v130, v130, v131
    v_cvt_pk_bf16_f32 v131, v132, v133
    v_and_or_b32 v130, v130, -2, s68
    buffer_store_dwordx2 v[130:131], v41, s[44:47], s54 offen
    s_mov_b64 exec, -1
L_a3_hl:
    s_barrier
    s_mov_b64 exec, s[100:101]
    ds_write_b128 v35, v[148:151]
    s_mov_b64 exec, -1
    ds_write_b128 v28, v[50:53]
    ds_write_b128 v38, v[62:65]
    ds_write_b128 v29, v[54:57]
    ds_write_b128 v39, v[66:69]
    ds_write_b128 v30, v[58:61]
    ds_write_b128 v40, v[70:73]
    s_mov_b64 exec, -1
    s_mov_b32 s74, 0
.p2align 5
L_p3_hl:
    buffer_load_dwordx4 v[130:133], v17, s[44:47], s55 offen sc1
    buffer_load_dwordx4 v[134:137], v17, s[44:47], s56 offen sc1
    s_add_u32 s74, s74, 1
    s_cmp_gt_u32 s74, 4194304
    s_cbranch_scc1 L_chain_done
    s_waitcnt vmcnt(0)
    v_bitop3_b32 v138, v130, s69, v132 bitop3:0x24
    v_bitop3_b32 v139, v134, s69, v136 bitop3:0x24
    v_bitop3_b32 v138, v138, 1, v139 bitop3:0x80
    v_cmp_eq_u32 vcc, 0, v138
    s_cbranch_vccnz L_p3_hl
    ds_write_b64 v42, v[130:131] offset:0
    ds_write_b64 v42, v[132:133] offset:1296
    ds_write_b64 v43, v[134:135] offset:0
    ds_write_b64 v43, v[136:137] offset:1296
    s_add_u32 s60, s60, 1
    s_branch L_top_hl
.p2align 5
L_p1b_hl:
    buffer_load_dwordx4 v[130:133], v17, s[44:47], s57 offen sc1
    buffer_load_dwordx4 v[134:137], v17, s[44:47], s50 offen sc1
    s_add_u32 s74, s74, 1
    s_cmp_gt_u32 s74, 4194304
    s_cbranch_scc1 L_chain_done
    s_waitcnt vmcnt(2)
    v_bitop3_b32 v138, v140, s69, v142 bitop3:0x24
    v_bitop3_b32 v139, v144, s69, v146 bitop3:0x24
    v_bitop3_b32 v138, v138, 1, v139 bitop3:0x80
    v_cmp_eq_u32 vcc, 0, v138
    s_cbranch_vccnz L_p1_hl
    ds_write_b128 v46, v[140:143]
    ds_write_b128 v47, v[144:147]
    s_branch L_p1e_hl
.p2align 5
L_p2b_hl:
    buffer_load_dwordx4 v[114:117], v18, s[44:47], s52 offen sc1
    buffer_load_dwordx4 v[118:121], v18, s[44:47], s52 offen offset:1024 sc1
    s_add_u32 s74, s74, 1
    s_cmp_gt_u32 s74, 4194304
    s_cbranch_scc1 L_chain_done
    s_waitcnt vmcnt(2)
    v_bitop3_b32 v138, v74, s39, v76 bitop3:0x24
    v_bitop3_b32 v139, v78, s39, v80 bitop3:0x24
    v_bitop3_b32 v138, v138, 1, v139 bitop3:0x80
    v_cmp_eq_u32 vcc, 0, v138
    s_cbranch_vccnz L_p2_hl
    v_mfma_f32_16x16x32_bf16 v[130:133], v[24:27], v[74:77], 0
    v_mfma_f32_16x16x32_bf16 v[130:133], v[24:27], v[78:81], v[130:133]
    s_add_u32 s52, s52, s37
    s_add_u32 s53, s53, s37
    s_sub_u32 s37, 0, s37
    s_nop 4
    v_add_f32_dpp v134, v130, v130 row_ror:4 row_mask:0xf bank_mask:0xf
    v_add_f32_dpp v135, v131, v131 row_ror:4 row_mask:0xf bank_mask:0xf
    v_add_f32_dpp v136, v132, v132 row_ror:4 row_mask:0xf bank_mask:0xf
    v_add_f32_dpp v137, v133, v133 row_ror:4 row_mask:0xf bank_mask:0xf
    v_add_f32_dpp v130, v134, v134 row_ror:8 row_mask:0xf bank_mask:0xf
    v_add_f32_dpp v131, v135, v135 row_ror:8 row_mask:0xf bank_mask:0xf
    v_add_f32_dpp v132, v136, v136 row_ror:8 row_mask:0xf bank_mask:0xf
    v_add_f32_dpp v133, v137, v137 row_ror:8 row_mask:0xf bank_mask:0xf
    s_mov_b64 exec, s[22:23]
    v_cvt_pk_bf16_f32 v130, v130, v131
    v_cvt_pk_bf16_f32 v131, v132, v133
    v_and_or_b32 v130, v130, -2, s68
    buffer_store_dwordx2 v[130:131], v41, s[44:47], s54 offen
    s_mov_b64 exec, -1
    s_branch L_a3_hl
.p2align 5
L_top_gl:
    s_waitcnt lgkmcnt(0)
    s_barrier
    ds_read_b128 v[74:77], v5 offset:0
    ds_read_b128 v[78:81], v5 offset:128
    ds_read_b128 v[82:85], v5 offset:256
    ds_read_b128 v[86:89], v5 offset:384
    ds_read_b128 v[90:93], v5 offset:512
    ds_read_b128 v[94:97], v5 offset:640
    ds_read_b128 v[98:101], v5 offset:768
    ds_read_b128 v[102:105], v5 offset:896
    ds_read_b128 v[106:109], v5 offset:1024
    ds_read_b128 v[110:113], v5 offset:1152
    s_add_u32 s68, s60, 1
    s_and_b32 s68, s68, 1
    s_xor_b32 s69, s68, 1
    s_bfe_u32 s39, s60, 0x10001
    s_xor_b32 s38, s39, 1
    s_waitcnt lgkmcnt(9)
    v_mfma_f32_16x16x32_bf16 v[114:117], v[74:77], a[0:3], 0
    s_waitcnt lgkmcnt(8)
    v_mfma_f32_16x16x32_bf16 v[118:121], v[78:81], a[8:11], 0
    s_waitcnt lgkmcnt(7)
    v_mfma_f32_16x16x32_bf16 v[114:117], v[82:85], a[16:19], v[114:117]
    s_waitcnt lgkmcnt(6)
    v_mfma_f32_16x16x32_bf16 v[118:121], v[86:89], a[24:27], v[118:121]
    s_waitcnt lgkmcnt(5)
    v_mfma_f32_16x16x32_bf16 v[114:117], v[90:93], a[32:35], v[114:117]
    s_waitcnt lgkmcnt(4)
    v_mfma_f32_16x16x32_bf16 v[118:121], v[94:97], a[40:43], v[118:121]
    s_waitcnt lgkmcnt(3)
    v_mfma_f32_16x16x32_bf16 v[114:117], v[98:101], a[48:51], v[114:117]
    s_waitcnt lgkmcnt(2)
    v_mfma_f32_16x16x32_bf16 v[118:121], v[102:105], a[56:59], v[118:121]
    s_waitcnt lgkmcnt(1)
    v_mfma_f32_16x16x32_bf16 v[114:117], v[106:109], a[64:67], v[114:117]
    s_waitcnt lgkmcnt(0)
    v_mfma_f32_16x16x32_bf16 v[118:121], v[110:113], a[72:75], v[118:121]
    s_nop 7
    v_pk_add_f32 v[114:115], v[114:115], v[118:119]
    v_pk_add_f32 v[116:117], v[116:117], v[120:121]
    s_nop 0
    v_mov_b32 v118, v114
    v_mov_b32 v119, v115
    v_mov_b32 v120, v116
    v_mov_b32 v121, v117
    v_permlane32_swap_b32 v118, v122
    v_permlane32_swap_b32 v119, v123
    v_permlane32_swap_b32 v120, v124
    v_permlane32_swap_b32 v121, v125
    v_add_f32_dpp v114, v122, v114 row_ror:8 row_mask:0xf bank_mask:0xf
    v_add_f32_dpp v115, v123, v115 row_ror:8 row_mask:0xf bank_mask:0xf
    v_add_f32_dpp v116, v124, v116 row_ror:8 row_mask:0xf bank_mask:0xf
    v_add_f32_dpp v117, v125, v117 row_ror:8 row_mask:0xf bank_mask:0xf
    s_mov_b64 exec, s[66:67]
    v_cvt_pk_bf16_f32 v132, v114, v115
    v_cvt_pk_bf16_f32 v133, v116, v117
    v_and_or_b32 v132, v132, -2, s68
    buffer_store_dwordx2 v[132:133], v23, s[44:47], s51 offen
    s_mov_b64 exec, -1
    s_add_u32 s75, s60, 2
    s_and_b32 s73, s75, 3
    s_mul_i32 s73, s73, 1179648
    s_add_u32 s73, s73, s14
    s_add_u32 s75, s60, 1
    s_and_b32 s61, s75, 3
    s_mul_i32 s61, s61, 1179648
    s_add_u32 s61, s61, s14
    s_mul_i32 s70, s60, 393216
    s_add_u32 s70, s70, s58
    s_mul_i32 s75, s75, 3
    s_mov_b32 s74, 0
    buffer_load_dwordx4 v[130:133], v17, s[44:47], s57 offen sc1
    buffer_load_dwordx4 v[134:137], v17, s[44:47], s50 offen sc1
    s_sleep 4
.p2align 5
L_p1_gl:
    buffer_load_dwordx4 v[140:143], v17, s[44:47], s57 offen sc1
    buffer_load_dwordx4 v[144:147], v17, s[44:47], s50 offen sc1
    s_waitcnt vmcnt(2)
    v_bitop3_b32 v138, v130, s69, v132 bitop3:0x24
    v_bitop3_b32 v139, v134, s69, v136 bitop3:0x24
    v_bitop3_b32 v138, v138, 1, v139 bitop3:0x80
    v_cmp_eq_u32 vcc, 0, v138
    s_cbranch_vccnz L_p1b_gl
    ds_write_b128 v46, v[130:133]
    ds_write_b128 v47, v[134:137]
L_p1e_gl:
    s_waitcnt lgkmcnt(0)
    s_barrier
    s_waitcnt vmcnt(0)
    buffer_load_dwordx4 v[50:53], v12, s[28:31], s61 offen sc1
    buffer_load_dwordx4 v[62:65], v12, s[28:31], s61 offen offset:1536 sc1
    buffer_load_dwordx4 v[54:57], v13, s[28:31], s61 offen sc1
    buffer_load_dwordx4 v[66:69], v13, s[28:31], s61 offen offset:1536 sc1
    buffer_load_dwordx4 v[58:61], v14, s[28:31], s61 offen sc1
    buffer_load_dwordx4 v[70:73], v14, s[28:31], s61 offen offset:1536 sc1
    s_mov_b64 exec, s[100:101]
    buffer_load_dwordx4 v[148:151], v34, s[28:31], s61 offen sc1
    s_mov_b64 exec, -1
    s_cmp_gt_u32 s60, 61
    s_cbranch_scc1 L_chain_nostgl
    s_add_u32 s17, s73, s16
    s_mov_b64 exec, s[18:19]
    buffer_store_dwordx2 v[6:7], v44, s[28:31], s73 offen sc1
    buffer_store_dwordx2 v[8:9], v44, s[28:31], s17 offen sc1
    s_mov_b64 exec, -1
L_chain_nostgl:
    s_cmp_gt_u32 s60, 60
    s_cbranch_scc1 L_noxp_gl
    ds_read_b128 v[74:77], v4 offset:0
    ds_read_b128 v[78:81], v11 offset:0
    ds_read_b128 v[82:85], v4 offset:128
    ds_read_b128 v[86:89], v11 offset:128
    ds_read_b128 v[90:93], v4 offset:256
    ds_read_b128 v[94:97], v11 offset:256
    ds_read_b128 v[98:101], v4 offset:384
    ds_read_b128 v[102:105], v11 offset:384
    ds_read_b128 v[106:109], v4 offset:512
    ds_read_b128 v[110:113], v11 offset:512
    s_waitcnt lgkmcnt(9)
    v_mfma_f32_16x16x32_bf16 v[122:125], v[74:77], a[0:3], 0
    ds_read_b128 v[74:77], v4 offset:640
    s_waitcnt lgkmcnt(9)
    v_mfma_f32_16x16x32_bf16 v[126:129], v[78:81], a[4:7], 0
    ds_read_b128 v[78:81], v11 offset:640
    s_waitcnt lgkmcnt(9)
    v_mfma_f32_16x16x32_bf16 v[122:125], v[82:85], a[8:11], v[122:125]
    ds_read_b128 v[82:85], v4 offset:768
    s_waitcnt lgkmcnt(9)
    v_mfma_f32_16x16x32_bf16 v[126:129], v[86:89], a[12:15], v[126:129]
    ds_read_b128 v[86:89], v11 offset:768
    s_waitcnt lgkmcnt(9)
    v_mfma_f32_16x16x32_bf16 v[122:125], v[90:93], a[16:19], v[122:125]
    ds_read_b128 v[90:93], v4 offset:896
    s_waitcnt lgkmcnt(9)
    v_mfma_f32_16x16x32_bf16 v[126:129], v[94:97], a[20:23], v[126:129]
    ds_read_b128 v[94:97], v11 offset:896
    s_waitcnt lgkmcnt(9)
    v_mfma_f32_16x16x32_bf16 v[122:125], v[98:101], a[24:27], v[122:125]
    ds_read_b128 v[98:101], v4 offset:1024
    s_waitcnt lgkmcnt(9)
    v_mfma_f32_16x16x32_bf16 v[126:129], v[102:105], a[28:31], v[126:129]
    ds_read_b128 v[102:105], v11 offset:1024
    s_waitcnt lgkmcnt(9)
    v_mfma_f32_16x16x32_bf16 v[122:125], v[106:109], a[32:35], v[122:125]
    ds_read_b128 v[106:109], v4 offset:1152
    s_waitcnt lgkmcnt(9)
    v_mfma_f32_16x16x32_bf16 v[126:129], v[110:113], a[36:39], v[126:129]
    ds_read_b128 v[110:113], v11 offset:1152
    s_waitcnt lgkmcnt(9)
    v_mfma_f32_16x16x32_bf16 v[122:125], v[74:77], a[40:43], v[122:125]
    s_waitcnt lgkmcnt(8)
    v_mfma_f32_16x16x32_bf16 v[126:129], v[78:81], a[44:47], v[126:129]
    s_waitcnt lgkmcnt(7)
    v_mfma_f32_16x16x32_bf16 v[122:125], v[82:85], a[48:51], v[122:125]
    s_waitcnt lgkmcnt(6)
    v_mfma_f32_16x16x32_bf16 v[126:129], v[86:89], a[52:55], v[126:129]
    s_waitcnt lgkmcnt(5)
    v_mfma_f32_16x16x32_bf16 v[122:125], v[90:93], a[56:59], v[122:125]
    s_waitcnt lgkmcnt(4)
    v_mfma_f32_16x16x32_bf16 v[126:129], v[94:97], a[60:63], v[126:129]
    s_waitcnt lgkmcnt(3)
    v_mfma_f32_16x16x32_bf16 v[122:125], v[98:101], a[64:67], v[122:125]
    s_waitcnt lgkmcnt(2)
    v_mfma_f32_16x16x32_bf16 v[126:129], v[102:105], a[68:71], v[126:129]
    s_waitcnt lgkmcnt(1)
    v_mfma_f32_16x16x32_bf16 v[122:125], v[106:109], a[72:75], v[122:125]
    s_waitcnt lgkmcnt(0)
    v_mfma_f32_16x16x32_bf16 v[126:129], v[110:113], a[76:79], v[126:129]
    s_nop 7
    v_pk_add_f32 v[122:123], v[122:123], v[126:127]
    v_pk_add_f32 v[124:125], v[124:125], v[128:129]
    v_cvt_pk_bf16_f32 v6, v122, v123
    v_cvt_pk_bf16_f32 v7, v124, v125
L_noxp_gl:
    s_mov_b32 s17, s70
    s_add_u32 s70, s60, 1
    s_mov_b32 s74, 0
.p2align 5
L_f_gl:
    ds_read_b32 v134, v49 offset:62464
    s_add_u32 s74, s74, 1
    s_cmp_gt_u32 s74, 4194304
    s_cbranch_scc1 L_chain_done
    s_waitcnt lgkmcnt(0)
    v_cmp_ne_u32 vcc, s75, v134
    s_cbranch_vccnz L_f_gl
    ds_read_b128 v[74:77], v18 offset:56320
    ds_read_b128 v[78:81], v18 offset:57344
    ds_read_b128 v[82:85], v18 offset:58368
    ds_read_b128 v[86:89], v18 offset:59392
    ds_read_b128 v[90:93], v18 offset:60416
    ds_read_b128 v[94:97], v18 offset:61440
    s_waitcnt lgkmcnt(5)
    v_mfma_f32_16x16x32_bf16 v[144:147], a[80:83], v[74:77], 0
    s_waitcnt lgkmcnt(4)
    v_mfma_f32_16x16x32_bf16 v[144:147], a[84:87], v[78:81], v[144:147]
    s_waitcnt lgkmcnt(3)
    v_mfma_f32_16x16x32_bf16 v[144:147], a[88:91], v[82:85], v[144:147]
    s_waitcnt lgkmcnt(2)
    v_mfma_f32_16x16x32_bf16 v[144:147], a[92:95], v[86:89], v[144:147]
    s_waitcnt lgkmcnt(1)
    v_mfma_f32_16x16x32_bf16 v[144:147], a[96:99], v[90:93], v[144:147]
    s_waitcnt lgkmcnt(0)
    v_mfma_f32_16x16x32_bf16 v[144:147], a[100:103], v[94:97], v[144:147]
    s_cmp_eq_u32 s60, 63
    s_cselect_b64 exec, 0, s[62:63]
    s_nop 5
    v_cvt_pk_bf16_f32 v130, v144, v145
    v_cvt_pk_bf16_f32 v131, v146, v147
    v_and_or_b32 v130, v130, -2, s38
    buffer_store_dwordx2 v[130:131], v33, s[44:47], s53 offen sc1
    s_sleep 2
    s_mov_b64 exec, s[12:13]
    buffer_store_dwordx2 v[74:75], v36, s[40:43], s17 offen offset:0
    buffer_store_dwordx2 v[76:77], v36, s[40:43], s17 offen offset:32
    buffer_store_dwordx2 v[78:79], v36, s[40:43], s17 offen offset:64
    buffer_store_dwordx2 v[80:81], v36, s[40:43], s17 offen offset:96
    buffer_store_dwordx2 v[82:83], v36, s[40:43], s17 offen offset:128
    buffer_store_dwordx2 v[84:85], v36, s[40:43], s17 offen offset:160
    s_mov_b64 exec, -1
    s_cmp_eq_u32 s60, 63
    s_cbranch_scc1 L_chain_done
    s_cmp_gt_u32 s60, 59
    s_cbranch_scc1 L_nodma_gl
    s_add_u32 s75, s72, 0
    s_mov_b32 m0, s75
    s_add_u32 s75, s71, 0
    buffer_load_dwordx4 v16, s[32:35], s75 offen lds
    s_add_u32 s75, s72, 5120
    s_mov_b32 m0, s75
    s_add_u32 s75, s71, 5120
    buffer_load_dwordx4 v21, s[32:35], s75 offen lds
    s_add_u32 s75, s72, 10240
    s_mov_b32 m0, s75
    s_add_u32 s75, s71, 10240
    buffer_load_dwordx4 v16, s[32:35], s75 offen lds
    s_add_u32 s75, s72, 15360
    s_mov_b32 m0, s75
    s_add_u32 s75, s71, 15360
    buffer_load_dwordx4 v21, s[32:35], s75 offen lds
    s_add_u32 s75, s72, 20480
    s_mov_b32 m0, s75
    s_add_u32 s75, s71, 20480
    buffer_load_dwordx4 v16, s[32:35], s75 offen lds
    s_add_u32 s75, s72, 25600
    s_mov_b32 m0, s75
    s_add_u32 s75, s71, 25600
    buffer_load_dwordx4 v21, s[32:35], s75 offen lds
    s_add_u32 s75, s72, 30720
    s_mov_b32 m0, s75
    s_add_u32 s75, s71, 30720
    buffer_load_dwordx4 v16, s[32:35], s75 offen lds
    s_add_u32 s75, s72, 35840
    s_mov_b32 m0, s75
    s_add_u32 s75, s71, 35840
    buffer_load_dwordx4 v21, s[32:35], s75 offen lds
    s_add_u32 s71, s71, 40960
    s_sub_u32 s72, s3, s72
L_nodma_gl:
    s_cmp_gt_u32 s60, 60
    s_cbranch_scc1 L_noxq_gl
    ds_read_b128 v[74:77], v4 offset:20480
    ds_read_b128 v[78:81], v11 offset:20480
    ds_read_b128 v[82:85], v4 offset:20608
    ds_read_b128 v[86:89], v11 offset:20608
    ds_read_b128 v[90:93], v4 offset:20736
    ds_read_b128 v[94:97], v11 offset:20736
    ds_read_b128 v[98:101], v4 offset:20864
    ds_read_b128 v[102:105], v11 offset:20864
    ds_read_b128 v[106:109], v4 offset:20992
    ds_read_b128 v[110:113], v11 offset:20992
    s_waitcnt lgkmcnt(9)
    v_mfma_f32_16x16x32_bf16 v[122:125], v[74:77], a[0:3], 0
    ds_read_b128 v[74:77], v4 offset:21120
    s_waitcnt lgkmcnt(9)
    v_mfma_f32_16x16x32_bf16 v[126:129], v[78:81], a[4:7], 0
    ds_read_b128 v[78:81], v11 offset:21120
    s_waitcnt lgkmcnt(9)
    v_mfma_f32_16x16x32_bf16 v[122:125], v[82:85], a[8:11], v[122:125]
    ds_read_b128 v[82:85], v4 offset:21248
    s_waitcnt lgkmcnt(9)
    v_mfma_f32_16x16x32_bf16 v[126:129], v[86:89], a[12:15], v[126:129]
    ds_read_b128 v[86:89], v11 offset:21248
    s_waitcnt lgkmcnt(9)
    v_mfma_f32_16x16x32_bf16 v[122:125], v[90:93], a[16:19], v[122:125]
    ds_read_b128 v[90:93], v4 offset:21376
    s_waitcnt lgkmcnt(9)
    v_mfma_f32_16x16x32_bf16 v[126:129], v[94:97], a[20:23], v[126:129]
    ds_read_b128 v[94:97], v11 offset:21376
    s_waitcnt lgkmcnt(9)
    v_mfma_f32_16x16x32_bf16 v[122:125], v[98:101], a[24:27], v[122:125]
    ds_read_b128 v[98:101], v4 offset:21504
    s_waitcnt lgkmcnt(9)
    v_mfma_f32_16x16x32_bf16 v[126:129], v[102:105], a[28:31], v[126:129]
    ds_read_b128 v[102:105], v11 offset:21504
    s_waitcnt lgkmcnt(9)
    v_mfma_f32_16x16x32_bf16 v[122:125], v[106:109], a[32:35], v[122:125]
    ds_read_b128 v[106:109], v4 offset:21632
    s_waitcnt lgkmcnt(9)
    v_mfma_f32_16x16x32_bf16 v[126:129], v[110:113], a[36:39], v[126:129]
    ds_read_b128 v[110:113], v11 offset:21632
    s_waitcnt lgkmcnt(9)
    v_mfma_f32_16x16x32_bf16 v[122:125], v[74:77], a[40:43], v[122:125]
    s_waitcnt lgkmcnt(8)
    v_mfma_f32_16x16x32_bf16 v[126:129], v[78:81], a[44:47], v[126:129]
    s_waitcnt lgkmcnt(7)
    v_mfma_f32_16x16x32_bf16 v[122:125], v[82:85], a[48:51], v[122:125]
    s_waitcnt lgkmcnt(6)
    v_mfma_f32_16x16x32_bf16 v[126:129], v[86:89], a[52:55], v[126:129]
    s_waitcnt lgkmcnt(5)
    v_mfma_f32_16x16x32_bf16 v[122:125], v[90:93], a[56:59], v[122:125]
    s_waitcnt lgkmcnt(4)
    v_mfma_f32_16x16x32_bf16 v[126:129], v[94:97], a[60:63], v[126:129]
    s_waitcnt lgkmcnt(3)
    v_mfma_f32_16x16x32_bf16 v[122:125], v[98:101], a[64:67], v[122:125]
    s_waitcnt lgkmcnt(2)
    v_mfma_f32_16x16x32_bf16 v[126:129], v[102:105], a[68:71], v[126:129]
    s_waitcnt lgkmcnt(1)
    v_mfma_f32_16x16x32_bf16 v[122:125], v[106:109], a[72:75], v[122:125]
    s_waitcnt lgkmcnt(0)
    v_mfma_f32_16x16x32_bf16 v[126:129], v[110:113], a[76:79], v[126:129]
    s_nop 7
    v_pk_add_f32 v[122:123], v[122:123], v[126:127]
    v_pk_add_f32 v[124:125], v[124:125], v[128:129]
    v_cvt_pk_bf16_f32 v8, v122, v123
    v_cvt_pk_bf16_f32 v9, v124, v125
    v_add_u32 v4, s9, v4
    v_add_u32 v11, s9, v11
    s_sub_u32 s9, 0, s9
L_noxq_gl:
    s_mov_b32 s74, 0
    buffer_load_dwordx4 v[114:117], v18, s[44:47], s52 offen sc1
    buffer_load_dwordx4 v[118:121], v18, s[44:47], s52 offen offset:1024 sc1
    s_sleep 8
.p2align 5
L_p2_gl:
    buffer_load_dwordx4 v[74:77], v18, s[44:47], s52 offen sc1
    buffer_load_dwordx4 v[78:81], v18, s[44:47], s52 offen offset:1024 sc1
    s_waitcnt vmcnt(2)
    v_bitop3_b32 v138, v114, s39, v116 bitop3:0x24
    v_bitop3_b32 v139, v118, s39, v120 bitop3:0x24
    v_bitop3_b32 v138, v138, 1, v139 bitop3:0x80
    v_cmp_eq_u32 vcc, 0, v138
    s_cbranch_vccnz L_p2b_gl
    v_mfma_f32_16x16x32_bf16 v[130:133], v[24:27], v[114:117], 0
    v_mfma_f32_16x16x32_bf16 v[130:133], v[24:27], v[118:121], v[130:133]
    s_add_u32 s52, s52, s37
    s_add_u32 s53, s53, s37
    s_sub_u32 s37, 0, s37
    s_nop 4
    v_add_f32_dpp v134, v130, v130 row_ror:4 row_mask:0xf bank_mask:0xf
    v_add_f32_dpp v135, v131, v131 row_ror:4 row_mask:0xf bank_mask:0xf
    v_add_f32_dpp v136, v132, v132 row_ror:4 row_mask:0xf bank_mask:0xf
    v_add_f32_dpp v137, v133, v133 row_ror:4 row_mask:0xf bank_mask:0xf
    v_add_f32_dpp v130, v134, v134 row_ror:8 row_mask:0xf bank_mask:0xf
    v_add_f32_dpp v131, v135, v135 row_ror:8 row_mask:0xf bank_mask:0xf
    v_add_f32_dpp v132, v136, v136 row_ror:8 row_mask:0xf bank_mask:0xf
    v_add_f32_dpp v133, v137, v137 row_ror:8 row_mask:0xf bank_mask:0xf
    s_mov_b64 exec, s[22:23]
    v_cvt_pk_bf16_f32 v130, v130, v131
    v_cvt_pk_bf16_f32 v131, v132, v133
    v_and_or_b32 v130, v130, -2, s68
    buffer_store_dwordx2 v[130:131], v41, s[44:47], s54 offen
    s_mov_b64 exec, -1
L_a3_gl:
    s_barrier
    s_mov_b64 exec, s[100:101]
    ds_write_b128 v35, v[148:151]
    s_mov_b64 exec, -1
    ds_write_b128 v28, v[50:53]
    ds_write_b128 v38, v[62:65]
    ds_write_b128 v29, v[54:57]
    ds_write_b128 v39, v[66:69]
    ds_write_b128 v30, v[58:61]
    ds_write_b128 v40, v[70:73]
    s_mov_b64 exec, -1
    s_mov_b32 s74, 0
.p2align 5
L_p3_gl:
    buffer_load_dwordx4 v[130:133], v17, s[44:47], s55 offen sc1
    buffer_load_dwordx4 v[134:137], v17, s[44:47], s56 offen sc1
    s_add_u32 s74, s74, 1
    s_cmp_gt_u32 s74, 4194304
    s_cbranch_scc1 L_chain_done
    s_waitcnt vmcnt(0)
    v_bitop3_b32 v138, v130, s69, v132 bitop3:0x24
    v_bitop3_b32 v139, v134, s69, v136 bitop3:0x24
    v_bitop3_b32 v138, v138, 1, v139 bitop3:0x80
    v_cmp_eq_u32 vcc, 0, v138
    s_cbranch_vccnz L_p3_gl
    ds_write_b64 v42, v[130:131] offset:0
    ds_write_b64 v42, v[132:133] offset:1296
    ds_write_b64 v43, v[134:135] offset:0
    ds_write_b64 v43, v[136:137] offset:1296
    s_add_u32 s60, s60, 1
    s_branch L_top_gl
.p2align 5
L_p1b_gl:
    buffer_load_dwordx4 v[130:133], v17, s[44:47], s57 offen sc1
    buffer_load_dwordx4 v[134:137], v17, s[44:47], s50 offen sc1
    s_add_u32 s74, s74, 1
    s_cmp_gt_u32 s74, 4194304
    s_cbranch_scc1 L_chain_done
    s_waitcnt vmcnt(2)
    v_bitop3_b32 v138, v140, s69, v142 bitop3:0x24
    v_bitop3_b32 v139, v144, s69, v146 bitop3:0x24
    v_bitop3_b32 v138, v138, 1, v139 bitop3:0x80
    v_cmp_eq_u32 vcc, 0, v138
    s_cbranch_vccnz L_p1_gl
    ds_write_b128 v46, v[140:143]
    ds_write_b128 v47, v[144:147]
    s_branch L_p1e_gl
.p2align 5
L_p2b_gl:
    buffer_load_dwordx4 v[114:117], v18, s[44:47], s52 offen sc1
    buffer_load_dwordx4 v[118:121], v18, s[44:47], s52 offen offset:1024 sc1
    s_add_u32 s74, s74, 1
    s_cmp_gt_u32 s74, 4194304
    s_cbranch_scc1 L_chain_done
    s_waitcnt vmcnt(2)
    v_bitop3_b32 v138, v74, s39, v76 bitop3:0x24
    v_bitop3_b32 v139, v78, s39, v80 bitop3:0x24
    v_bitop3_b32 v138, v138, 1, v139 bitop3:0x80
    v_cmp_eq_u32 vcc, 0, v138
    s_cbranch_vccnz L_p2_gl
    v_mfma_f32_16x16x32_bf16 v[130:133], v[24:27], v[74:77], 0
    v_mfma_f32_16x16x32_bf16 v[130:133], v[24:27], v[78:81], v[130:133]
    s_add_u32 s52, s52, s37
    s_add_u32 s53, s53, s37
    s_sub_u32 s37, 0, s37
    s_nop 4
    v_add_f32_dpp v134, v130, v130 row_ror:4 row_mask:0xf bank_mask:0xf
    v_add_f32_dpp v135, v131, v131 row_ror:4 row_mask:0xf bank_mask:0xf
    v_add_f32_dpp v136, v132, v132 row_ror:4 row_mask:0xf bank_mask:0xf
    v_add_f32_dpp v137, v133, v133 row_ror:4 row_mask:0xf bank_mask:0xf
    v_add_f32_dpp v130, v134, v134 row_ror:8 row_mask:0xf bank_mask:0xf
    v_add_f32_dpp v131, v135, v135 row_ror:8 row_mask:0xf bank_mask:0xf
    v_add_f32_dpp v132, v136, v136 row_ror:8 row_mask:0xf bank_mask:0xf
    v_add_f32_dpp v133, v137, v137 row_ror:8 row_mask:0xf bank_mask:0xf
    s_mov_b64 exec, s[22:23]
    v_cvt_pk_bf16_f32 v130, v130, v131
    v_cvt_pk_bf16_f32 v131, v132, v133
    v_and_or_b32 v130, v130, -2, s68
    buffer_store_dwordx2 v[130:131], v41, s[44:47], s54 offen
    s_mov_b64 exec, -1
    s_branch L_a3_gl
.p2align 5
L_top_cr:
    s_waitcnt lgkmcnt(0)
    s_barrier
    ds_read_b128 v[74:77], v5 offset:0
    ds_read_b128 v[78:81], v5 offset:128
    ds_read_b128 v[82:85], v5 offset:256
    ds_read_b128 v[86:89], v5 offset:384
    ds_read_b128 v[90:93], v5 offset:512
    ds_read_b128 v[94:97], v5 offset:640
    ds_read_b128 v[98:101], v5 offset:768
    ds_read_b128 v[102:105], v5 offset:896
    ds_read_b128 v[106:109], v5 offset:1024
    ds_read_b128 v[110:113], v5 offset:1152
    s_add_u32 s68, s60, 1
    s_and_b32 s68, s68, 1
    s_xor_b32 s69, s68, 1
    s_bfe_u32 s39, s60, 0x10001
    s_xor_b32 s38, s39, 1
    s_waitcnt lgkmcnt(9)
    v_mfma_f32_16x16x32_bf16 v[114:117], a[0:3], v[74:77], 0
    v_mfma_f32_16x16x32_bf16 v[118:121], a[4:7], v[74:77], 0
    s_waitcnt lgkmcnt(8)
    v_mfma_f32_16x16x32_bf16 v[114:117], a[8:11], v[78:81], v[114:117]
    v_mfma_f32_16x16x32_bf16 v[118:121], a[12:15], v[78:81], v[118:121]
    s_waitcnt lgkmcnt(7)
    v_mfma_f32_16x16x32_bf16 v[114:117], a[16:19], v[82:85], v[114:117]
    v_mfma_f32_16x16x32_bf16 v[118:121], a[20:23], v[82:85], v[118:121]
    s_waitcnt lgkmcnt(6)
    v_mfma_f32_16x16x32_bf16 v[114:117], a[24:27], v[86:89], v[114:117]
    v_mfma_f32_16x16x32_bf16 v[118:121], a[28:31], v[86:89], v[118:121]
    s_waitcnt lgkmcnt(5)
    v_mfma_f32_16x16x32_bf16 v[114:117], a[32:35], v[90:93], v[114:117]
    v_mfma_f32_16x16x32_bf16 v[118:121], a[36:39], v[90:93], v[118:121]
    s_waitcnt lgkmcnt(4)
    v_mfma_f32_16x16x32_bf16 v[114:117], a[40:43], v[94:97], v[114:117]
    v_mfma_f32_16x16x32_bf16 v[118:121], a[44:47], v[94:97], v[118:121]
    s_waitcnt lgkmcnt(3)
    v_mfma_f32_16x16x32_bf16 v[114:117], a[48:51], v[98:101], v[114:117]
    v_mfma_f32_16x16x32_bf16 v[118:121], a[52:55], v[98:101], v[118:121]
    s_waitcnt lgkmcnt(2)
    v_mfma_f32_16x16x32_bf16 v[114:117], a[56:59], v[102:105], v[114:117]
    v_mfma_f32_16x16x32_bf16 v[118:121], a[60:63], v[102:105], v[118:121]
    s_waitcnt lgkmcnt(1)
    v_mfma_f32_16x16x32_bf16 v[114:117], a[64:67], v[106:109], v[114:117]
    v_mfma_f32_16x16x32_bf16 v[118:121], a[68:71], v[106:109], v[118:121]
    s_waitcnt lgkmcnt(0)
    v_mfma_f32_16x16x32_bf16 v[114:117], a[72:75], v[110:113], v[114:117]
    v_mfma_f32_16x16x32_bf16 v[118:121], a[76:79], v[110:113], v[118:121]
    s_nop 7
    v_add_f32_dpp v114, v118, v114 row_ror:8 row_mask:0xf bank_mask:0xf
    v_add_f32_dpp v115, v119, v115 row_ror:8 row_mask:0xf bank_mask:0xf
    v_add_f32_dpp v116, v120, v116 row_ror:8 row_mask:0xf bank_mask:0xf
    v_add_f32_dpp v117, v121, v117 row_ror:8 row_mask:0xf bank_mask:0xf
    s_mov_b64 exec, s[62:63]
    v_cvt_pk_bf16_f32 v132, v114, v115
    v_cvt_pk_bf16_f32 v133, v116, v117
    v_and_or_b32 v132, v132, -2, s68
    buffer_store_dwordx2 v[132:133], v22, s[44:47], s51 offen sc1
    s_mov_b64 exec, -1
    ds_read_b128 v[74:77], v15 offset:21568
    ds_read_b128 v[78:81], v15 offset:21632
    ds_read_b128 v[82:85], v15 offset:21696
    ds_read_b128 v[86:89], v15 offset:21760
    ds_read_b128 v[90:93], v15 offset:21824
    ds_read_b128 v[94:97], v15 offset:21888
    ds_read_b128 v[98:101], v15 offset:27968
    ds_read_b128 v[102:105], v15 offset:28032
    ds_read_b128 v[106:109], v15 offset:28096
    ds_read_b128 v[110:113], v15 offset:28160
    ds_read_b128 v[50:53], v15 offset:28224
    ds_read_b128 v[54:57], v15 offset:28288
    s_add_u32 s75, s60, 2
    s_and_b32 s73, s75, 3
    s_mul_i32 s73, s73, 1179648
    s_add_u32 s73, s73, s14
    s_add_u32 s75, s60, 1
    s_and_b32 s61, s75, 3
    s_mul_i32 s61, s61, 1179648
    s_add_u32 s61, s61, s14
    s_mul_i32 s70, s60, 393216
    s_add_u32 s70, s70, s58
    v_mov_b32 v48, s75
    v_cndmask_b32 v114, 0, v32, s[76:77]
    v_cndmask_b32 v115, 0, v32, s[78:79]
    v_cndmask_b32 v116, 0, v32, s[80:81]
    v_cndmask_b32 v117, 0, v32, s[82:83]
    v_cndmask_b32 v118, 0, v32, s[84:85]
    v_cndmask_b32 v119, 0, v32, s[86:87]
    v_cndmask_b32 v120, 0, v32, s[88:89]
    v_cndmask_b32 v121, 0, v32, s[90:91]
    v_cndmask_b32 v122, 0, v32, s[92:93]
    v_cndmask_b32 v123, 0, v32, s[94:95]
    v_cndmask_b32 v124, 0, v32, s[96:97]
    v_cndmask_b32 v125, 0, v32, s[98:99]
    s_mul_i32 s75, s75, 3
    s_mov_b32 s74, 0
    buffer_load_dwordx4 v[130:133], v17, s[44:47], s57 offen sc1
    buffer_load_dwordx4 v[134:137], v17, s[44:47], s50 offen sc1
    s_sleep 4
.p2align 5
L_p1_cr:
    buffer_load_dwordx4 v[140:143], v17, s[44:47], s57 offen sc1
    buffer_load_dwordx4 v[144:147], v17, s[44:47], s50 offen sc1
    s_waitcnt vmcnt(2)
    v_bitop3_b32 v138, v130, s69, v132 bitop3:0x24
    v_bitop3_b32 v139, v134, s69, v136 bitop3:0x24
    v_bitop3_b32 v138, v138, 1, v139 bitop3:0x80
    v_cmp_eq_u32 vcc, 0, v138
    s_cbranch_vccnz L_p1b_cr
    ds_write_b128 v46, v[130:133]
    ds_write_b128 v47, v[134:137]
L_p1e_cr:
    s_waitcnt lgkmcnt(0)
    s_barrier
    ds_read_b128 v[62:65], v19 offset:10368
    ds_read_b128 v[58:61], v15 offset:15168
    ds_read_b128 v[70:73], v19 offset:10432
    ds_read_b128 v[66:69], v15 offset:15232
    ds_read_b128 v[126:129], v19 offset:10496
    ds_read_b128 v[148:151], v15 offset:15296
    s_waitcnt lgkmcnt(5)
    v_mfma_f32_16x16x32_bf16 v[118:121], v[74:77], v[62:65], v[118:121]
    v_mfma_f32_16x16x32_bf16 v[122:125], v[98:101], v[62:65], v[122:125]
    s_waitcnt lgkmcnt(4)
    v_mfma_f32_16x16x32_bf16 v[114:117], v[58:61], v[62:65], v[114:117]
    ds_read_b128 v[62:65], v19 offset:10560
    ds_read_b128 v[58:61], v15 offset:15360
    s_waitcnt lgkmcnt(5)
    v_mfma_f32_16x16x32_bf16 v[118:121], v[78:81], v[70:73], v[118:121]
    v_mfma_f32_16x16x32_bf16 v[122:125], v[102:105], v[70:73], v[122:125]
    s_waitcnt lgkmcnt(4)
    v_mfma_f32_16x16x32_bf16 v[114:117], v[66:69], v[70:73], v[114:117]
    ds_read_b128 v[70:73], v19 offset:10624
    ds_read_b128 v[66:69], v15 offset:15424
    s_waitcnt lgkmcnt(5)
    v_mfma_f32_16x16x32_bf16 v[118:121], v[82:85], v[126:129], v[118:121]
    v_mfma_f32_16x16x32_bf16 v[122:125], v[106:109], v[126:129], v[122:125]
    s_waitcnt lgkmcnt(4)
    v_mfma_f32_16x16x32_bf16 v[114:117], v[148:151], v[126:129], v[114:117]
    ds_read_b128 v[126:129], v19 offset:10688
    ds_read_b128 v[148:151], v15 offset:15488
    s_waitcnt lgkmcnt(5)
    v_mfma_f32_16x16x32_bf16 v[118:121], v[86:89], v[62:65], v[118:121]
    v_mfma_f32_16x16x32_bf16 v[122:125], v[110:113], v[62:65], v[122:125]
    s_waitcnt lgkmcnt(4)
    v_mfma_f32_16x16x32_bf16 v[114:117], v[58:61], v[62:65], v[114:117]
    s_waitcnt lgkmcnt(3)
    v_mfma_f32_16x16x32_bf16 v[118:121], v[90:93], v[70:73], v[118:121]
    v_mfma_f32_16x16x32_bf16 v[122:125], v[50:53], v[70:73], v[122:125]
    s_waitcnt lgkmcnt(2)
    v_mfma_f32_16x16x32_bf16 v[114:117], v[66:69], v[70:73], v[114:117]
    s_waitcnt lgkmcnt(1)
    v_mfma_f32_16x16x32_bf16 v[118:121], v[94:97], v[126:129], v[118:121]
    v_mfma_f32_16x16x32_bf16 v[122:125], v[54:57], v[126:129], v[122:125]
    s_waitcnt lgkmcnt(0)
    v_mfma_f32_16x16x32_bf16 v[114:117], v[148:151], v[126:129], v[114:117]
    s_waitcnt vmcnt(0)
    buffer_load_dwordx4 v[50:53], v12, s[28:31], s61 offen sc1
    buffer_load_dwordx4 v[62:65], v12, s[28:31], s61 offen offset:1536 sc1
    buffer_load_dwordx4 v[54:57], v13, s[28:31], s61 offen sc1
    buffer_load_dwordx4 v[66:69], v13, s[28:31], s61 offen offset:1536 sc1
    s_cmp_gt_u32 s60, 61
    s_cbranch_scc1 L_chain_nostcr
    buffer_store_dwordx2 v[6:7], v44, s[28:31], s73 offen sc1
    buffer_store_dwordx2 v[8:9], v44, s[28:31], s73 offen offset:768 sc1
L_chain_nostcr:
    ds_read_b64 v[74:75], v20 offset:34368
    ds_read_b64 v[76:77], v20 offset:34400
    ds_read_b64 v[78:79], v20 offset:34432
    ds_read_b64 v[80:81], v20 offset:36160
    ds_read_b64 v[82:83], v20 offset:36192
    ds_read_b64 v[84:85], v20 offset:36224
    ds_read_b64 v[86:87], v20 offset:37952
    ds_read_b64 v[88:89], v20 offset:37984
    ds_read_b64 v[90:91], v20 offset:38016
    ds_read_b64 v[92:93], v20 offset:39744
    ds_read_b64 v[94:95], v20 offset:39776
    ds_read_b64 v[96:97], v20 offset:39808
    v_max3_f32 v130, v114, v115, v116
    v_max3_f32 v130, v130, v117, v118
    v_max3_f32 v130, v130, v119, v120
    v_max3_f32 v130, v130, v121, v122
    v_max3_f32 v130, v130, v123, v124
    v_max_f32 v130, v130, v125
    v_mov_b32 v131, v130
    v_cvt_pk_bf16_f32 v132, v114, v115
    v_lshlrev_b32 v114, 16, v132
    v_and_b32 v115, 0xffff0000, v132
    v_permlane16_swap_b32 v130, v131
    v_cvt_pk_bf16_f32 v133, v116, v117
    v_lshlrev_b32 v116, 16, v133
    v_and_b32 v117, 0xffff0000, v133
    v_max_f32 v130, v130, v131
    v_cvt_pk_bf16_f32 v132, v118, v119
    v_lshlrev_b32 v118, 16, v132
    v_and_b32 v119, 0xffff0000, v132
    v_mov_b32 v131, v130
    v_cvt_pk_bf16_f32 v133, v120, v121
    v_lshlrev_b32 v120, 16, v133
    v_and_b32 v121, 0xffff0000, v133
    v_permlane32_swap_b32 v130, v131
    v_cvt_pk_bf16_f32 v132, v122, v123
    v_lshlrev_b32 v122, 16, v132
    v_and_b32 v123, 0xffff0000, v132
    v_max_f32 v130, v130, v131
    v_cvt_pk_bf16_f32 v133, v124, v125
    v_lshlrev_b32 v124, 16, v133
    v_and_b32 v125, 0xffff0000, v133
    v_mul_f32 v130, 0x3dd53b95, v130
    v_pk_mul_f32 v[114:115], v[114:115], s[10:11]
    v_pk_mul_f32 v[116:117], v[116:117], s[10:11]
    v_pk_mul_f32 v[118:119], v[118:119], s[10:11]
    v_pk_mul_f32 v[120:121], v[120:121], s[10:11]
    v_pk_mul_f32 v[122:123], v[122:123], s[10:11]
    v_pk_mul_f32 v[124:125], v[124:125], s[10:11]
    v_cvt_pk_bf16_f32 v132, v114, v115
    v_lshlrev_b32 v114, 16, v132
    v_and_b32 v115, 0xffff0000, v132
    v_cvt_pk_bf16_f32 v133, v116, v117
    v_lshlrev_b32 v116, 16, v133
    v_and_b32 v117, 0xffff0000, v133
    v_cvt_pk_bf16_f32 v132, v118, v119
    v_lshlrev_b32 v118, 16, v132
    v_and_b32 v119, 0xffff0000, v132
    v_cvt_pk_bf16_f32 v133, v120, v121
    v_lshlrev_b32 v120, 16, v133
    v_and_b32 v121, 0xffff0000, v133
    v_cvt_pk_bf16_f32 v132, v122, v123
    v_lshlrev_b32 v122, 16, v132
    v_and_b32 v123, 0xffff0000, v132
    v_cvt_pk_bf16_f32 v133, v124, v125
    v_lshlrev_b32 v124, 16, v133
    v_and_b32 v125, 0xffff0000, v133
    v_pk_fma_f32 v[114:115], v[114:115], s[8:9], v[130:131] op_sel_hi:[1,0,0] neg_lo:[0,0,1] neg_hi:[0,0,1]
    v_pk_fma_f32 v[116:117], v[116:117], s[8:9], v[130:131] op_sel_hi:[1,0,0] neg_lo:[0,0,1] neg_hi:[0,0,1]
    v_pk_fma_f32 v[118:119], v[118:119], s[8:9], v[130:131] op_sel_hi:[1,0,0] neg_lo:[0,0,1] neg_hi:[0,0,1]
    v_pk_fma_f32 v[120:121], v[120:121], s[8:9], v[130:131] op_sel_hi:[1,0,0] neg_lo:[0,0,1] neg_hi:[0,0,1]
    v_pk_fma_f32 v[122:123], v[122:123], s[8:9], v[130:131] op_sel_hi:[1,0,0] neg_lo:[0,0,1] neg_hi:[0,0,1]
    v_pk_fma_f32 v[124:125], v[124:125], s[8:9], v[130:131] op_sel_hi:[1,0,0] neg_lo:[0,0,1] neg_hi:[0,0,1]
    v_exp_f32 v114, v114
    v_exp_f32 v115, v115
    v_exp_f32 v116, v116
    v_exp_f32 v117, v117
    v_cvt_pk_bf16_f32 v138, v114, v115
    v_exp_f32 v118, v118
    v_exp_f32 v119, v119
    v_cvt_pk_bf16_f32 v139, v116, v117
    v_exp_f32 v120, v120
    v_exp_f32 v121, v121
    v_cvt_pk_bf16_f32 v140, v118, v119
    v_exp_f32 v122, v122
    v_exp_f32 v123, v123
    v_cvt_pk_bf16_f32 v141, v120, v121
    v_exp_f32 v124, v124
    v_exp_f32 v125, v125
    v_cvt_pk_bf16_f32 v142, v122, v123
    s_nop 0
    v_cvt_pk_bf16_f32 v143, v124, v125
    s_waitcnt lgkmcnt(0)
    v_mfma_f32_16x16x16_bf16 v[130:133], v[36:37], v[138:139], 0
    v_mfma_f32_16x16x32_bf16 v[98:101], v[74:77], v[138:141], 0
    v_mfma_f32_16x16x32_bf16 v[102:105], v[80:83], v[138:141], 0
    v_mfma_f32_16x16x16_bf16 v[130:133], v[36:37], v[140:141], v[130:133]
    v_mfma_f32_16x16x32_bf16 v[106:109], v[86:89], v[138:141], 0
    v_mfma_f32_16x16x32_bf16 v[110:113], v[92:95], v[138:141], 0
    v_mfma_f32_16x16x16_bf16 v[130:133], v[36:37], v[142:143], v[130:133]
    v_mfma_f32_16x16x16_bf16 v[98:101], v[78:79], v[142:143], v[98:101]
    v_mfma_f32_16x16x16_bf16 v[102:105], v[84:85], v[142:143], v[102:105]
    v_mfma_f32_16x16x16_bf16 v[106:109], v[90:91], v[142:143], v[106:109]
    v_mfma_f32_16x16x16_bf16 v[110:113], v[96:97], v[142:143], v[110:113]
    s_nop 0
    v_rcp_f32 v130, v130
    s_nop 2
    v_pk_mul_f32 v[98:99], v[98:99], v[130:131] op_sel_hi:[1,0]
    v_pk_mul_f32 v[100:101], v[100:101], v[130:131] op_sel_hi:[1,0]
    v_cvt_pk_bf16_f32 v114, v98, v99
    v_cvt_pk_bf16_f32 v115, v100, v101
    v_pk_mul_f32 v[102:103], v[102:103], v[130:131] op_sel_hi:[1,0]
    v_pk_mul_f32 v[104:105], v[104:105], v[130:131] op_sel_hi:[1,0]
    v_cvt_pk_bf16_f32 v116, v102, v103
    v_cvt_pk_bf16_f32 v117, v104, v105
    ds_write_b128 v45, v[114:117] offset:56320
    v_pk_mul_f32 v[106:107], v[106:107], v[130:131] op_sel_hi:[1,0]
    v_pk_mul_f32 v[108:109], v[108:109], v[130:131] op_sel_hi:[1,0]
    v_cvt_pk_bf16_f32 v118, v106, v107
    v_cvt_pk_bf16_f32 v119, v108, v109
    v_pk_mul_f32 v[110:111], v[110:111], v[130:131] op_sel_hi:[1,0]
    v_pk_mul_f32 v[112:113], v[112:113], v[130:131] op_sel_hi:[1,0]
    v_cvt_pk_bf16_f32 v120, v110, v111
    v_cvt_pk_bf16_f32 v121, v112, v113
    ds_write_b128 v45, v[118:121] offset:57344
    s_mov_b64 exec, 1
    ds_add_u32 v49, v31 offset:62464
    s_mov_b64 exec, -1
    s_mov_b32 s74, 0
L_f_cr:
    ds_read_b32 v134, v49 offset:62464
    ds_read_b128 v[74:77], v18 offset:56320
    ds_read_b128 v[78:81], v18 offset:57344
    ds_read_b128 v[82:85], v18 offset:58368
    ds_read_b128 v[86:89], v18 offset:59392
    ds_read_b128 v[90:93], v18 offset:60416
    ds_read_b128 v[94:97], v18 offset:61440
    s_add_u32 s74, s74, 1
    s_cmp_gt_u32 s74, 4194304
    s_cbranch_scc1 L_chain_done
    s_waitcnt lgkmcnt(6)
    v_cmp_ne_u32 vcc, s75, v134
    s_cbranch_vccnz L_f_cr
    s_waitcnt lgkmcnt(5)
    v_mfma_f32_16x16x32_bf16 v[144:147], a[80:83], v[74:77], 0
    s_waitcnt lgkmcnt(4)
    v_mfma_f32_16x16x32_bf16 v[144:147], a[84:87], v[78:81], v[144:147]
    s_waitcnt lgkmcnt(3)
    v_mfma_f32_16x16x32_bf16 v[144:147], a[88:91], v[82:85], v[144:147]
    s_waitcnt lgkmcnt(2)
    v_mfma_f32_16x16x32_bf16 v[144:147], a[92:95], v[86:89], v[144:147]
    s_waitcnt lgkmcnt(1)
    v_mfma_f32_16x16x32_bf16 v[144:147], a[96:99], v[90:93], v[144:147]
    s_waitcnt lgkmcnt(0)
    v_mfma_f32_16x16x32_bf16 v[144:147], a[100:103], v[94:97], v[144:147]
    s_cmp_eq_u32 s60, 63
    s_cbranch_scc1 L_chain_done
    s_mov_b64 exec, s[62:63]
    s_nop 4
    v_cvt_pk_bf16_f32 v130, v144, v145
    v_cvt_pk_bf16_f32 v131, v146, v147
    v_and_or_b32 v130, v130, -2, s38
    buffer_store_dwordx2 v[130:131], v33, s[44:47], s53 offen sc1
    s_mov_b64 exec, -1
    s_sleep 4
    s_cmp_gt_u32 s60, 60
    s_cbranch_scc1 L_noxp_cr
    ds_read_b128 v[74:77], v4 offset:0
    ds_read_b128 v[78:81], v4 offset:20480
    ds_read_b128 v[82:85], v11 offset:0
    ds_read_b128 v[86:89], v11 offset:20480
    ds_read_b128 v[90:93], v4 offset:128
    ds_read_b128 v[94:97], v4 offset:20608
    ds_read_b128 v[98:101], v11 offset:128
    ds_read_b128 v[102:105], v11 offset:20608
    ds_read_b128 v[106:109], v4 offset:256
    ds_read_b128 v[110:113], v4 offset:20736
    s_waitcnt lgkmcnt(9)
    v_mfma_f32_16x16x32_bf16 v[122:125], a[0:3], v[74:77], 0
    ds_read_b128 v[74:77], v11 offset:256
    s_waitcnt lgkmcnt(9)
    v_mfma_f32_16x16x32_bf16 v[126:129], a[0:3], v[78:81], 0
    ds_read_b128 v[78:81], v11 offset:20736
    s_waitcnt lgkmcnt(9)
    v_mfma_f32_16x16x32_bf16 v[122:125], a[4:7], v[82:85], v[122:125]
    ds_read_b128 v[82:85], v4 offset:384
    s_waitcnt lgkmcnt(9)
    v_mfma_f32_16x16x32_bf16 v[126:129], a[4:7], v[86:89], v[126:129]
    ds_read_b128 v[86:89], v4 offset:20864
    s_waitcnt lgkmcnt(9)
    v_mfma_f32_16x16x32_bf16 v[122:125], a[8:11], v[90:93], v[122:125]
    ds_read_b128 v[90:93], v11 offset:384
    s_waitcnt lgkmcnt(9)
    v_mfma_f32_16x16x32_bf16 v[126:129], a[8:11], v[94:97], v[126:129]
    ds_read_b128 v[94:97], v11 offset:20864
    s_waitcnt lgkmcnt(9)
    v_mfma_f32_16x16x32_bf16 v[122:125], a[12:15], v[98:101], v[122:125]
    ds_read_b128 v[98:101], v4 offset:512
    s_waitcnt lgkmcnt(9)
    v_mfma_f32_16x16x32_bf16 v[126:129], a[12:15], v[102:105], v[126:129]
    ds_read_b128 v[102:105], v4 offset:20992
    s_waitcnt lgkmcnt(9)
    v_mfma_f32_16x16x32_bf16 v[122:125], a[16:19], v[106:109], v[122:125]
    ds_read_b128 v[106:109], v11 offset:512
    s_waitcnt lgkmcnt(9)
    v_mfma_f32_16x16x32_bf16 v[126:129], a[16:19], v[110:113], v[126:129]
    ds_read_b128 v[110:113], v11 offset:20992
    s_waitcnt lgkmcnt(9)
    v_mfma_f32_16x16x32_bf16 v[122:125], a[20:23], v[74:77], v[122:125]
    ds_read_b128 v[74:77], v4 offset:640
    s_waitcnt lgkmcnt(9)
    v_mfma_f32_16x16x32_bf16 v[126:129], a[20:23], v[78:81], v[126:129]
    ds_read_b128 v[78:81], v4 offset:21120
    s_waitcnt lgkmcnt(9)
    v_mfma_f32_16x16x32_bf16 v[122:125], a[24:27], v[82:85], v[122:125]
    ds_read_b128 v[82:85], v11 offset:640
    s_waitcnt lgkmcnt(9)
    v_mfma_f32_16x16x32_bf16 v[126:129], a[24:27], v[86:89], v[126:129]
    ds_read_b128 v[86:89], v11 offset:21120
    s_waitcnt lgkmcnt(9)
    v_mfma_f32_16x16x32_bf16 v[122:125], a[28:31], v[90:93], v[122:125]
    ds_read_b128 v[90:93], v4 offset:768
    s_waitcnt lgkmcnt(9)
    v_mfma_f32_16x16x32_bf16 v[126:129], a[28:31], v[94:97], v[126:129]
    ds_read_b128 v[94:97], v4 offset:21248
    s_waitcnt lgkmcnt(9)
    v_mfma_f32_16x16x32_bf16 v[122:125], a[32:35], v[98:101], v[122:125]
    ds_read_b128 v[98:101], v11 offset:768
    s_cmp_gt_u32 s60, 59
    s_cbranch_scc1 L_nodma_cr
    s_add_u32 s75, s72, 0
    s_mov_b32 m0, s75
    s_add_u32 s75, s71, 0
    buffer_load_dwordx4 v16, s[32:35], s75 offen lds
    s_add_u32 s75, s72, 5120
    s_mov_b32 m0, s75
    s_add_u32 s75, s71, 5120
    buffer_load_dwordx4 v21, s[32:35], s75 offen lds
    s_add_u32 s75, s72, 10240
    s_mov_b32 m0, s75
    s_add_u32 s75, s71, 10240
    buffer_load_dwordx4 v16, s[32:35], s75 offen lds
    s_add_u32 s75, s72, 15360
    s_mov_b32 m0, s75
    s_add_u32 s75, s71, 15360
    buffer_load_dwordx4 v21, s[32:35], s75 offen lds
    s_add_u32 s75, s72, 20480
    s_mov_b32 m0, s75
    s_add_u32 s75, s71, 20480
    buffer_load_dwordx4 v16, s[32:35], s75 offen lds
    s_add_u32 s75, s72, 25600
    s_mov_b32 m0, s75
    s_add_u32 s75, s71, 25600
    buffer_load_dwordx4 v21, s[32:35], s75 offen lds
    s_add_u32 s75, s72, 30720
    s_mov_b32 m0, s75
    s_add_u32 s75, s71, 30720
    buffer_load_dwordx4 v16, s[32:35], s75 offen lds
    s_add_u32 s75, s72, 35840
    s_mov_b32 m0, s75
    s_add_u32 s75, s71, 35840
    buffer_load_dwordx4 v21, s[32:35], s75 offen lds
    s_add_u32 s71, s71, 40960
    s_sub_u32 s72, s3, s72
L_nodma_cr:
    s_waitcnt lgkmcnt(9)
    v_mfma_f32_16x16x32_bf16 v[126:129], a[32:35], v[102:105], v[126:129]
    ds_read_b128 v[102:105], v11 offset:21248
    s_waitcnt lgkmcnt(9)
    v_mfma_f32_16x16x32_bf16 v[122:125], a[36:39], v[106:109], v[122:125]
    ds_read_b128 v[106:109], v4 offset:896
    s_waitcnt lgkmcnt(9)
    v_mfma_f32_16x16x32_bf16 v[126:129], a[36:39], v[110:113], v[126:129]
    ds_read_b128 v[110:113], v4 offset:21376
    s_waitcnt lgkmcnt(9)
    v_mfma_f32_16x16x32_bf16 v[122:125], a[40:43], v[74:77], v[122:125]
    ds_read_b128 v[74:77], v11 offset:896
    s_waitcnt lgkmcnt(9)
    v_mfma_f32_16x16x32_bf16 v[126:129], a[40:43], v[78:81], v[126:129]
    ds_read_b128 v[78:81], v11 offset:21376
    s_waitcnt lgkmcnt(9)
    v_mfma_f32_16x16x32_bf16 v[122:125], a[44:47], v[82:85], v[122:125]
    ds_read_b128 v[82:85], v4 offset:1024
    s_waitcnt lgkmcnt(9)
    v_mfma_f32_16x16x32_bf16 v[126:129], a[44:47], v[86:89], v[126:129]
    ds_read_b128 v[86:89], v4 offset:21504
    s_waitcnt lgkmcnt(9)
    v_mfma_f32_16x16x32_bf16 v[122:125], a[48:51], v[90:93], v[122:125]
    ds_read_b128 v[90:93], v11 offset:1024
    s_waitcnt lgkmcnt(9)
    v_mfma_f32_16x16x32_bf16 v[126:129], a[48:51], v[94:97], v[126:129]
    ds_read_b128 v[94:97], v11 offset:21504
    s_waitcnt lgkmcnt(9)
    v_mfma_f32_16x16x32_bf16 v[122:125], a[52:55], v[98:101], v[122:125]
    ds_read_b128 v[98:101], v4 offset:1152
    s_waitcnt lgkmcnt(9)
    v_mfma_f32_16x16x32_bf16 v[126:129], a[52:55], v[102:105], v[126:129]
    ds_read_b128 v[102:105], v4 offset:21632
    s_waitcnt lgkmcnt(9)
    v_mfma_f32_16x16x32_bf16 v[122:125], a[56:59], v[106:109], v[122:125]
    ds_read_b128 v[106:109], v11 offset:1152
    s_waitcnt lgkmcnt(9)
    v_mfma_f32_16x16x32_bf16 v[126:129], a[56:59], v[110:113], v[126:129]
    ds_read_b128 v[110:113], v11 offset:21632
    s_waitcnt lgkmcnt(9)
    v_mfma_f32_16x16x32_bf16 v[122:125], a[60:63], v[74:77], v[122:125]
    s_waitcnt lgkmcnt(8)
    v_mfma_f32_16x16x32_bf16 v[126:129], a[60:63], v[78:81], v[126:129]
    s_waitcnt lgkmcnt(7)
    v_mfma_f32_16x16x32_bf16 v[122:125], a[64:67], v[82:85], v[122:125]
    s_waitcnt lgkmcnt(6)
    v_mfma_f32_16x16x32_bf16 v[126:129], a[64:67], v[86:89], v[126:129]
    s_waitcnt lgkmcnt(5)
    v_mfma_f32_16x16x32_bf16 v[122:125], a[68:71], v[90:93], v[122:125]
    s_waitcnt lgkmcnt(4)
    v_mfma_f32_16x16x32_bf16 v[126:129], a[68:71], v[94:97], v[126:129]
    s_waitcnt lgkmcnt(3)
    v_mfma_f32_16x16x32_bf16 v[122:125], a[72:75], v[98:101], v[122:125]
    s_waitcnt lgkmcnt(2)
    v_mfma_f32_16x16x32_bf16 v[126:129], a[72:75], v[102:105], v[126:129]
    s_waitcnt lgkmcnt(1)
    v_mfma_f32_16x16x32_bf16 v[122:125], a[76:79], v[106:109], v[122:125]
    s_waitcnt lgkmcnt(0)
    v_mfma_f32_16x16x32_bf16 v[126:129], a[76:79], v[110:113], v[126:129]
    s_nop 7
    v_cvt_pk_bf16_f32 v6, v122, v123
    v_cvt_pk_bf16_f32 v7, v124, v125
    v_cvt_pk_bf16_f32 v8, v126, v127
    v_cvt_pk_bf16_f32 v9, v128, v129
    v_add_u32 v4, s9, v4
    v_add_u32 v11, s9, v11
    s_sub_u32 s9, 0, s9
L_noxp_cr:
    s_mov_b32 s74, 0
    buffer_load_dwordx4 v[114:117], v18, s[44:47], s52 offen sc1
    buffer_load_dwordx4 v[118:121], v18, s[44:47], s52 offen offset:1024 sc1
    s_sleep 8
.p2align 5
L_p2_cr:
    buffer_load_dwordx4 v[74:77], v18, s[44:47], s52 offen sc1
    buffer_load_dwordx4 v[78:81], v18, s[44:47], s52 offen offset:1024 sc1
    s_waitcnt vmcnt(2)
    v_bitop3_b32 v138, v114, s39, v116 bitop3:0x24
    v_bitop3_b32 v139, v118, s39, v120 bitop3:0x24
    v_bitop3_b32 v138, v138, 1, v139 bitop3:0x80
    v_cmp_eq_u32 vcc, 0, v138
    s_cbranch_vccnz L_p2b_cr
    v_mfma_f32_16x16x32_bf16 v[130:133], v[24:27], v[114:117], 0
    v_mfma_f32_16x16x32_bf16 v[130:133], v[24:27], v[118:121], v[130:133]
    s_add_u32 s52, s52, s37
    s_add_u32 s53, s53, s37
    s_sub_u32 s37, 0, s37
    s_nop 4
    v_add_f32_dpp v134, v130, v130 row_ror:4 row_mask:0xf bank_mask:0xf
    v_add_f32_dpp v135, v131, v131 row_ror:4 row_mask:0xf bank_mask:0xf
    v_add_f32_dpp v136, v132, v132 row_ror:4 row_mask:0xf bank_mask:0xf
    v_add_f32_dpp v137, v133, v133 row_ror:4 row_mask:0xf bank_mask:0xf
    v_add_f32_dpp v130, v134, v134 row_ror:8 row_mask:0xf bank_mask:0xf
    v_add_f32_dpp v131, v135, v135 row_ror:8 row_mask:0xf bank_mask:0xf
    v_add_f32_dpp v132, v136, v136 row_ror:8 row_mask:0xf bank_mask:0xf
    v_add_f32_dpp v133, v137, v137 row_ror:8 row_mask:0xf bank_mask:0xf
    s_mov_b64 exec, s[22:23]
    v_cvt_pk_bf16_f32 v130, v130, v131
    v_cvt_pk_bf16_f32 v131, v132, v133
    v_and_or_b32 v130, v130, -2, s68
    buffer_store_dwordx2 v[130:131], v41, s[44:47], s54 offen sc1
    s_mov_b64 exec, -1
L_a3_cr:
    s_barrier
    ds_write_b128 v28, v[50:53]
    ds_write_b128 v38, v[62:65]
    ds_write_b128 v29, v[54:57]
    ds_write_b128 v39, v[66:69]
    s_mov_b32 s74, 0
.p2align 5
L_p3_cr:
    buffer_load_dwordx4 v[130:133], v17, s[44:47], s55 offen sc1
    buffer_load_dwordx4 v[134:137], v17, s[44:47], s56 offen sc1
    s_add_u32 s74, s74, 1
    s_cmp_gt_u32 s74, 4194304
    s_cbranch_scc1 L_chain_done
    s_waitcnt vmcnt(0)
    v_bitop3_b32 v138, v130, s69, v132 bitop3:0x24
    v_bitop3_b32 v139, v134, s69, v136 bitop3:0x24
    v_bitop3_b32 v138, v138, 1, v139 bitop3:0x80
    v_cmp_eq_u32 vcc, 0, v138
    s_cbranch_vccnz L_p3_cr
    ds_write_b64 v42, v[130:131] offset:0
    ds_write_b64 v42, v[132:133] offset:1296
    ds_write_b64 v43, v[134:135] offset:0
    ds_write_b64 v43, v[136:137] offset:1296
    s_add_u32 s60, s60, 1
    s_branch L_top_cr
.p2align 5
L_p1b_cr:
    buffer_load_dwordx4 v[130:133], v17, s[44:47], s57 offen sc1
    buffer_load_dwordx4 v[134:137], v17, s[44:47], s50 offen sc1
    s_add_u32 s74, s74, 1
    s_cmp_gt_u32 s74, 4194304
    s_cbranch_scc1 L_chain_done
    s_waitcnt vmcnt(2)
    v_bitop3_b32 v138, v140, s69, v142 bitop3:0x24
    v_bitop3_b32 v139, v144, s69, v146 bitop3:0x24
    v_bitop3_b32 v138, v138, 1, v139 bitop3:0x80
    v_cmp_eq_u32 vcc, 0, v138
    s_cbranch_vccnz L_p1_cr
    ds_write_b128 v46, v[140:143]
    ds_write_b128 v47, v[144:147]
    s_branch L_p1e_cr
.p2align 5
L_p2b_cr:
    buffer_load_dwordx4 v[114:117], v18, s[44:47], s52 offen sc1
    buffer_load_dwordx4 v[118:121], v18, s[44:47], s52 offen offset:1024 sc1
    s_add_u32 s74, s74, 1
    s_cmp_gt_u32 s74, 4194304
    s_cbranch_scc1 L_chain_done
    s_waitcnt vmcnt(2)
    v_bitop3_b32 v138, v74, s39, v76 bitop3:0x24
    v_bitop3_b32 v139, v78, s39, v80 bitop3:0x24
    v_bitop3_b32 v138, v138, 1, v139 bitop3:0x80
    v_cmp_eq_u32 vcc, 0, v138
    s_cbranch_vccnz L_p2_cr
    v_mfma_f32_16x16x32_bf16 v[130:133], v[24:27], v[74:77], 0
    v_mfma_f32_16x16x32_bf16 v[130:133], v[24:27], v[78:81], v[130:133]
    s_add_u32 s52, s52, s37
    s_add_u32 s53, s53, s37
    s_sub_u32 s37, 0, s37
    s_nop 4
    v_add_f32_dpp v134, v130, v130 row_ror:4 row_mask:0xf bank_mask:0xf
    v_add_f32_dpp v135, v131, v131 row_ror:4 row_mask:0xf bank_mask:0xf
    v_add_f32_dpp v136, v132, v132 row_ror:4 row_mask:0xf bank_mask:0xf
    v_add_f32_dpp v137, v133, v133 row_ror:4 row_mask:0xf bank_mask:0xf
    v_add_f32_dpp v130, v134, v134 row_ror:8 row_mask:0xf bank_mask:0xf
    v_add_f32_dpp v131, v135, v135 row_ror:8 row_mask:0xf bank_mask:0xf
    v_add_f32_dpp v132, v136, v136 row_ror:8 row_mask:0xf bank_mask:0xf
    v_add_f32_dpp v133, v137, v137 row_ror:8 row_mask:0xf bank_mask:0xf
    s_mov_b64 exec, s[22:23]
    v_cvt_pk_bf16_f32 v130, v130, v131
    v_cvt_pk_bf16_f32 v131, v132, v133
    v_and_or_b32 v130, v130, -2, s68
    buffer_store_dwordx2 v[130:131], v41, s[44:47], s54 offen sc1
    s_mov_b64 exec, -1
    s_branch L_a3_cr
.p2align 5
L_top_hr:
    s_waitcnt lgkmcnt(0)
    s_barrier
    ds_read_b128 v[74:77], v5 offset:0
    ds_read_b128 v[78:81], v5 offset:128
    ds_read_b128 v[82:85], v5 offset:256
    ds_read_b128 v[86:89], v5 offset:384
    ds_read_b128 v[90:93], v5 offset:512
    ds_read_b128 v[94:97], v5 offset:640
    ds_read_b128 v[98:101], v5 offset:768
    ds_read_b128 v[102:105], v5 offset:896
    ds_read_b128 v[106:109], v5 offset:1024
    ds_read_b128 v[110:113], v5 offset:1152
    s_add_u32 s68, s60, 1
    s_and_b32 s68, s68, 1
    s_xor_b32 s69, s68, 1
    s_bfe_u32 s39, s60, 0x10001
    s_xor_b32 s38, s39, 1
    s_waitcnt lgkmcnt(9)
    v_mfma_f32_16x16x32_bf16 v[114:117], v[74:77], a[0:3], 0
    v_mfma_f32_16x16x32_bf16 v[118:121], v[74:77], a[4:7], 0
    s_waitcnt lgkmcnt(8)
    v_mfma_f32_16x16x32_bf16 v[114:117], v[78:81], a[8:11], v[114:117]
    v_mfma_f32_16x16x32_bf16 v[118:121], v[78:81], a[12:15], v[118:121]
    s_waitcnt lgkmcnt(7)
    v_mfma_f32_16x16x32_bf16 v[114:117], v[82:85], a[16:19], v[114:117]
    v_mfma_f32_16x16x32_bf16 v[118:121], v[82:85], a[20:23], v[118:121]
    s_waitcnt lgkmcnt(6)
    v_mfma_f32_16x16x32_bf16 v[114:117], v[86:89], a[24:27], v[114:117]
    v_mfma_f32_16x16x32_bf16 v[118:121], v[86:89], a[28:31], v[118:121]
    s_waitcnt lgkmcnt(5)
    v_mfma_f32_16x16x32_bf16 v[114:117], v[90:93], a[32:35], v[114:117]
    v_mfma_f32_16x16x32_bf16 v[118:121], v[90:93], a[36:39], v[118:121]
    s_waitcnt lgkmcnt(4)
    v_mfma_f32_16x16x32_bf16 v[114:117], v[94:97], a[40:43], v[114:117]
    v_mfma_f32_16x16x32_bf16 v[118:121], v[94:97], a[44:47], v[118:121]
    s_waitcnt lgkmcnt(3)
    v_mfma_f32_16x16x32_bf16 v[114:117], v[98:101], a[48:51], v[114:117]
    v_mfma_f32_16x16x32_bf16 v[118:121], v[98:101], a[52:55], v[118:121]
    s_waitcnt lgkmcnt(2)
    v_mfma_f32_16x16x32_bf16 v[114:117], v[102:105], a[56:59], v[114:117]
    v_mfma_f32_16x16x32_bf16 v[118:121], v[102:105], a[60:63], v[118:121]
    s_waitcnt lgkmcnt(1)
    v_mfma_f32_16x16x32_bf16 v[114:117], v[106:109], a[64:67], v[114:117]
    v_mfma_f32_16x16x32_bf16 v[118:121], v[106:109], a[68:71], v[118:121]
    s_waitcnt lgkmcnt(0)
    v_mfma_f32_16x16x32_bf16 v[114:117], v[110:113], a[72:75], v[114:117]
    v_mfma_f32_16x16x32_bf16 v[118:121], v[110:113], a[76:79], v[118:121]
    s_nop 7
    v_permlane32_swap_b32 v118, v122
    v_permlane32_swap_b32 v119, v123
    v_permlane32_swap_b32 v120, v124
    v_permlane32_swap_b32 v121, v125
    s_nop 1
    v_add_f32 v114, v114, v122
    v_add_f32 v115, v115, v123
    v_add_f32 v116, v116, v124
    v_add_f32 v117, v117, v125
    s_mov_b64 exec, s[66:67]
    v_cvt_pk_bf16_f32 v132, v114, v115
    v_cvt_pk_bf16_f32 v133, v116, v117
    v_and_or_b32 v132, v132, -2, s68
    buffer_store_dwordx2 v[132:133], v23, s[44:47], s51 offen sc1
    s_mov_b64 exec, -1
    s_add_u32 s75, s60, 2
    s_and_b32 s73, s75, 3
    s_mul_i32 s73, s73, 1179648
    s_add_u32 s73, s73, s14
    s_add_u32 s75, s60, 1
    s_and_b32 s61, s75, 3
    s_mul_i32 s61, s61, 1179648
    s_add_u32 s61, s61, s14
    s_mul_i32 s70, s60, 393216
    s_add_u32 s70, s70, s58
    s_mul_i32 s75, s75, 3
    s_mov_b32 s74, 0
    buffer_load_dwordx4 v[130:133], v17, s[44:47], s57 offen sc1
    buffer_load_dwordx4 v[134:137], v17, s[44:47], s50 offen sc1
    s_sleep 4
.p2align 5
L_p1_hr:
    buffer_load_dwordx4 v[140:143], v17, s[44:47], s57 offen sc1
    buffer_load_dwordx4 v[144:147], v17, s[44:47], s50 offen sc1
    s_waitcnt vmcnt(2)
    v_bitop3_b32 v138, v130, s69, v132 bitop3:0x24
    v_bitop3_b32 v139, v134, s69, v136 bitop3:0x24
    v_bitop3_b32 v138, v138, 1, v139 bitop3:0x80
    v_cmp_eq_u32 vcc, 0, v138
    s_cbranch_vccnz L_p1b_hr
    ds_write_b128 v46, v[130:133]
    ds_write_b128 v47, v[134:137]
L_p1e_hr:
    s_waitcnt lgkmcnt(0)
    s_barrier
    s_waitcnt vmcnt(0)
    buffer_load_dwordx4 v[50:53], v12, s[28:31], s61 offen sc1
    buffer_load_dwordx4 v[62:65], v12, s[28:31], s61 offen offset:1536 sc1
    buffer_load_dwordx4 v[54:57], v13, s[28:31], s61 offen sc1
    buffer_load_dwordx4 v[66:69], v13, s[28:31], s61 offen offset:1536 sc1
    buffer_load_dwordx4 v[58:61], v14, s[28:31], s61 offen sc1
    buffer_load_dwordx4 v[70:73], v14, s[28:31], s61 offen offset:1536 sc1
    s_mov_b64 exec, s[100:101]
    buffer_load_dwordx4 v[148:151], v34, s[28:31], s61 offen sc1
    s_mov_b64 exec, -1
    s_cmp_gt_u32 s60, 61
    s_cbranch_scc1 L_chain_nosthr
    s_add_u32 s17, s73, s16
    s_mov_b64 exec, s[18:19]
    buffer_store_dwordx2 v[6:7], v44, s[28:31], s73 offen sc1
    buffer_store_dwordx2 v[8:9], v44, s[28:31], s17 offen sc1
    s_mov_b64 exec, -1
L_chain_nosthr:
    s_cmp_gt_u32 s60, 60
    s_cbranch_scc1 L_noxp_hr
    ds_read_b128 v[74:77], v4 offset:0
    ds_read_b128 v[78:81], v11 offset:0
    ds_read_b128 v[82:85], v4 offset:128
    ds_read_b128 v[86:89], v11 offset:128
    ds_read_b128 v[90:93], v4 offset:256
    ds_read_b128 v[94:97], v11 offset:256
    ds_read_b128 v[98:101], v4 offset:384
    ds_read_b128 v[102:105], v11 offset:384
    ds_read_b128 v[106:109], v4 offset:512
    ds_read_b128 v[110:113], v11 offset:512
    s_waitcnt lgkmcnt(9)
    v_mfma_f32_16x16x32_bf16 v[122:125], v[74:77], a[0:3], 0
    ds_read_b128 v[74:77], v4 offset:640
    s_waitcnt lgkmcnt(9)
    v_mfma_f32_16x16x32_bf16 v[126:129], v[78:81], a[4:7], 0
    ds_read_b128 v[78:81], v11 offset:640
    s_waitcnt lgkmcnt(9)
    v_mfma_f32_16x16x32_bf16 v[122:125], v[82:85], a[8:11], v[122:125]
    ds_read_b128 v[82:85], v4 offset:768
    s_waitcnt lgkmcnt(9)
    v_mfma_f32_16x16x32_bf16 v[126:129], v[86:89], a[12:15], v[126:129]
    ds_read_b128 v[86:89], v11 offset:768
    s_waitcnt lgkmcnt(9)
    v_mfma_f32_16x16x32_bf16 v[122:125], v[90:93], a[16:19], v[122:125]
    ds_read_b128 v[90:93], v4 offset:896
    s_waitcnt lgkmcnt(9)
    v_mfma_f32_16x16x32_bf16 v[126:129], v[94:97], a[20:23], v[126:129]
    ds_read_b128 v[94:97], v11 offset:896
    s_waitcnt lgkmcnt(9)
    v_mfma_f32_16x16x32_bf16 v[122:125], v[98:101], a[24:27], v[122:125]
    ds_read_b128 v[98:101], v4 offset:1024
    s_waitcnt lgkmcnt(9)
    v_mfma_f32_16x16x32_bf16 v[126:129], v[102:105], a[28:31], v[126:129]
    ds_read_b128 v[102:105], v11 offset:1024
    s_waitcnt lgkmcnt(9)
    v_mfma_f32_16x16x32_bf16 v[122:125], v[106:109], a[32:35], v[122:125]
    ds_read_b128 v[106:109], v4 offset:1152
    s_waitcnt lgkmcnt(9)
    v_mfma_f32_16x16x32_bf16 v[126:129], v[110:113], a[36:39], v[126:129]
    ds_read_b128 v[110:113], v11 offset:1152
    s_waitcnt lgkmcnt(9)
    v_mfma_f32_16x16x32_bf16 v[122:125], v[74:77], a[40:43], v[122:125]
    s_waitcnt lgkmcnt(8)
    v_mfma_f32_16x16x32_bf16 v[126:129], v[78:81], a[44:47], v[126:129]
    s_waitcnt lgkmcnt(7)
    v_mfma_f32_16x16x32_bf16 v[122:125], v[82:85], a[48:51], v[122:125]
    s_waitcnt lgkmcnt(6)
    v_mfma_f32_16x16x32_bf16 v[126:129], v[86:89], a[52:55], v[126:129]
    s_waitcnt lgkmcnt(5)
    v_mfma_f32_16x16x32_bf16 v[122:125], v[90:93], a[56:59], v[122:125]
    s_waitcnt lgkmcnt(4)
    v_mfma_f32_16x16x32_bf16 v[126:129], v[94:97], a[60:63], v[126:129]
    s_waitcnt lgkmcnt(3)
    v_mfma_f32_16x16x32_bf16 v[122:125], v[98:101], a[64:67], v[122:125]
    s_waitcnt lgkmcnt(2)
    v_mfma_f32_16x16x32_bf16 v[126:129], v[102:105], a[68:71], v[126:129]
    s_waitcnt lgkmcnt(1)
    v_mfma_f32_16x16x32_bf16 v[122:125], v[106:109], a[72:75], v[122:125]
    s_waitcnt lgkmcnt(0)
    v_mfma_f32_16x16x32_bf16 v[126:129], v[110:113], a[76:79], v[126:129]
    s_nop 7
    v_pk_add_f32 v[122:123], v[122:123], v[126:127]
    v_pk_add_f32 v[124:125], v[124:125], v[128:129]
    v_cvt_pk_bf16_f32 v6, v122, v123
    v_cvt_pk_bf16_f32 v7, v124, v125
L_noxp_hr:
    s_mov_b32 s17, s70
    s_add_u32 s70, s60, 1
    s_mov_b32 s74, 0
.p2align 5
L_f_hr:
    ds_read_b32 v134, v49 offset:62464
    s_add_u32 s74, s74, 1
    s_cmp_gt_u32 s74, 4194304
    s_cbranch_scc1 L_chain_done
    s_waitcnt lgkmcnt(0)
    v_cmp_ne_u32 vcc, s75, v134
    s_cbranch_vccnz L_f_hr
    ds_read_b128 v[74:77], v18 offset:56320
    ds_read_b128 v[78:81], v18 offset:57344
    ds_read_b128 v[82:85], v18 offset:58368
    ds_read_b128 v[86:89], v18 offset:59392
    ds_read_b128 v[90:93], v18 offset:60416
    ds_read_b128 v[94:97], v18 offset:61440
    s_waitcnt lgkmcnt(5)
    v_mfma_f32_16x16x32_bf16 v[144:147], a[80:83], v[74:77], 0
    s_waitcnt lgkmcnt(4)
    v_mfma_f32_16x16x32_bf16 v[144:147], a[84:87], v[78:81], v[144:147]
    s_waitcnt lgkmcnt(3)
    v_mfma_f32_16x16x32_bf16 v[144:147], a[88:91], v[82:85], v[144:147]
    s_waitcnt lgkmcnt(2)
    v_mfma_f32_16x16x32_bf16 v[144:147], a[92:95], v[86:89], v[144:147]
    s_waitcnt lgkmcnt(1)
    v_mfma_f32_16x16x32_bf16 v[144:147], a[96:99], v[90:93], v[144:147]
    s_waitcnt lgkmcnt(0)
    v_mfma_f32_16x16x32_bf16 v[144:147], a[100:103], v[94:97], v[144:147]
    s_cmp_eq_u32 s60, 63
    s_cselect_b64 exec, 0, s[62:63]
    s_nop 5
    v_cvt_pk_bf16_f32 v130, v144, v145
    v_cvt_pk_bf16_f32 v131, v146, v147
    v_and_or_b32 v130, v130, -2, s38
    buffer_store_dwordx2 v[130:131], v33, s[44:47], s53 offen sc1
    s_sleep 2
    s_mov_b64 exec, s[12:13]
    buffer_store_dwordx2 v[86:87], v36, s[40:43], s17 offen offset:192
    buffer_store_dwordx2 v[88:89], v36, s[40:43], s17 offen offset:224
    buffer_store_dwordx2 v[90:91], v36, s[40:43], s17 offen offset:256
    buffer_store_dwordx2 v[92:93], v36, s[40:43], s17 offen offset:288
    buffer_store_dwordx2 v[94:95], v36, s[40:43], s17 offen offset:320
    buffer_store_dwordx2 v[96:97], v36, s[40:43], s17 offen offset:352
    s_mov_b64 exec, -1
    s_cmp_eq_u32 s60, 63
    s_cbranch_scc1 L_chain_done
    s_cmp_gt_u32 s60, 59
    s_cbranch_scc1 L_nodma_hr
    s_add_u32 s75, s72, 0
    s_mov_b32 m0, s75
    s_add_u32 s75, s71, 0
    buffer_load_dwordx4 v16, s[32:35], s75 offen lds
    s_add_u32 s75, s72, 5120
    s_mov_b32 m0, s75
    s_add_u32 s75, s71, 5120
    buffer_load_dwordx4 v21, s[32:35], s75 offen lds
    s_add_u32 s75, s72, 10240
    s_mov_b32 m0, s75
    s_add_u32 s75, s71, 10240
    buffer_load_dwordx4 v16, s[32:35], s75 offen lds
    s_add_u32 s75, s72, 15360
    s_mov_b32 m0, s75
    s_add_u32 s75, s71, 15360
    buffer_load_dwordx4 v21, s[32:35], s75 offen lds
    s_add_u32 s75, s72, 20480
    s_mov_b32 m0, s75
    s_add_u32 s75, s71, 20480
    buffer_load_dwordx4 v16, s[32:35], s75 offen lds
    s_add_u32 s75, s72, 25600
    s_mov_b32 m0, s75
    s_add_u32 s75, s71, 25600
    buffer_load_dwordx4 v21, s[32:35], s75 offen lds
    s_add_u32 s75, s72, 30720
    s_mov_b32 m0, s75
    s_add_u32 s75, s71, 30720
    buffer_load_dwordx4 v16, s[32:35], s75 offen lds
    s_add_u32 s75, s72, 35840
    s_mov_b32 m0, s75
    s_add_u32 s75, s71, 35840
    buffer_load_dwordx4 v21, s[32:35], s75 offen lds
    s_add_u32 s71, s71, 40960
    s_sub_u32 s72, s3, s72
L_nodma_hr:
    s_cmp_gt_u32 s60, 60
    s_cbranch_scc1 L_noxq_hr
    ds_read_b128 v[74:77], v4 offset:20480
    ds_read_b128 v[78:81], v11 offset:20480
    ds_read_b128 v[82:85], v4 offset:20608
    ds_read_b128 v[86:89], v11 offset:20608
    ds_read_b128 v[90:93], v4 offset:20736
    ds_read_b128 v[94:97], v11 offset:20736
    ds_read_b128 v[98:101], v4 offset:20864
    ds_read_b128 v[102:105], v11 offset:20864
    ds_read_b128 v[106:109], v4 offset:20992
    ds_read_b128 v[110:113], v11 offset:20992
    s_waitcnt lgkmcnt(9)
    v_mfma_f32_16x16x32_bf16 v[122:125], v[74:77], a[0:3], 0
    ds_read_b128 v[74:77], v4 offset:21120
    s_waitcnt lgkmcnt(9)
    v_mfma_f32_16x16x32_bf16 v[126:129], v[78:81], a[4:7], 0
    ds_read_b128 v[78:81], v11 offset:21120
    s_waitcnt lgkmcnt(9)
    v_mfma_f32_16x16x32_bf16 v[122:125], v[82:85], a[8:11], v[122:125]
    ds_read_b128 v[82:85], v4 offset:21248
    s_waitcnt lgkmcnt(9)
    v_mfma_f32_16x16x32_bf16 v[126:129], v[86:89], a[12:15], v[126:129]
    ds_read_b128 v[86:89], v11 offset:21248
    s_waitcnt lgkmcnt(9)
    v_mfma_f32_16x16x32_bf16 v[122:125], v[90:93], a[16:19], v[122:125]
    ds_read_b128 v[90:93], v4 offset:21376
    s_waitcnt lgkmcnt(9)
    v_mfma_f32_16x16x32_bf16 v[126:129], v[94:97], a[20:23], v[126:129]
    ds_read_b128 v[94:97], v11 offset:21376
    s_waitcnt lgkmcnt(9)
    v_mfma_f32_16x16x32_bf16 v[122:125], v[98:101], a[24:27], v[122:125]
    ds_read_b128 v[98:101], v4 offset:21504
    s_waitcnt lgkmcnt(9)
    v_mfma_f32_16x16x32_bf16 v[126:129], v[102:105], a[28:31], v[126:129]
    ds_read_b128 v[102:105], v11 offset:21504
    s_waitcnt lgkmcnt(9)
    v_mfma_f32_16x16x32_bf16 v[122:125], v[106:109], a[32:35], v[122:125]
    ds_read_b128 v[106:109], v4 offset:21632
    s_waitcnt lgkmcnt(9)
    v_mfma_f32_16x16x32_bf16 v[126:129], v[110:113], a[36:39], v[126:129]
    ds_read_b128 v[110:113], v11 offset:21632
    s_waitcnt lgkmcnt(9)
    v_mfma_f32_16x16x32_bf16 v[122:125], v[74:77], a[40:43], v[122:125]
    s_waitcnt lgkmcnt(8)
    v_mfma_f32_16x16x32_bf16 v[126:129], v[78:81], a[44:47], v[126:129]
    s_waitcnt lgkmcnt(7)
    v_mfma_f32_16x16x32_bf16 v[122:125], v[82:85], a[48:51], v[122:125]
    s_waitcnt lgkmcnt(6)
    v_mfma_f32_16x16x32_bf16 v[126:129], v[86:89], a[52:55], v[126:129]
    s_waitcnt lgkmcnt(5)
    v_mfma_f32_16x16x32_bf16 v[122:125], v[90:93], a[56:59], v[122:125]
    s_waitcnt lgkmcnt(4)
    v_mfma_f32_16x16x32_bf16 v[126:129], v[94:97], a[60:63], v[126:129]
    s_waitcnt lgkmcnt(3)
    v_mfma_f32_16x16x32_bf16 v[122:125], v[98:101], a[64:67], v[122:125]
    s_waitcnt lgkmcnt(2)
    v_mfma_f32_16x16x32_bf16 v[126:129], v[102:105], a[68:71], v[126:129]
    s_waitcnt lgkmcnt(1)
    v_mfma_f32_16x16x32_bf16 v[122:125], v[106:109], a[72:75], v[122:125]
    s_waitcnt lgkmcnt(0)
    v_mfma_f32_16x16x32_bf16 v[126:129], v[110:113], a[76:79], v[126:129]
    s_nop 7
    v_pk_add_f32 v[122:123], v[122:123], v[126:127]
    v_pk_add_f32 v[124:125], v[124:125], v[128:129]
    v_cvt_pk_bf16_f32 v8, v122, v123
    v_cvt_pk_bf16_f32 v9, v124, v125
    v_add_u32 v4, s9, v4
    v_add_u32 v11, s9, v11
    s_sub_u32 s9, 0, s9
L_noxq_hr:
    s_mov_b32 s74, 0
    buffer_load_dwordx4 v[114:117], v18, s[44:47], s52 offen sc1
    buffer_load_dwordx4 v[118:121], v18, s[44:47], s52 offen offset:1024 sc1
    s_sleep 8
.p2align 5
L_p2_hr:
    buffer_load_dwordx4 v[74:77], v18, s[44:47], s52 offen sc1
    buffer_load_dwordx4 v[78:81], v18, s[44:47], s52 offen offset:1024 sc1
    s_waitcnt vmcnt(2)
    v_bitop3_b32 v138, v114, s39, v116 bitop3:0x24
    v_bitop3_b32 v139, v118, s39, v120 bitop3:0x24
    v_bitop3_b32 v138, v138, 1, v139 bitop3:0x80
    v_cmp_eq_u32 vcc, 0, v138
    s_cbranch_vccnz L_p2b_hr
    v_mfma_f32_16x16x32_bf16 v[130:133], v[24:27], v[114:117], 0
    v_mfma_f32_16x16x32_bf16 v[130:133], v[24:27], v[118:121], v[130:133]
    s_add_u32 s52, s52, s37
    s_add_u32 s53, s53, s37
    s_sub_u32 s37, 0, s37
    s_nop 4
    v_add_f32_dpp v134, v130, v130 row_ror:4 row_mask:0xf bank_mask:0xf
    v_add_f32_dpp v135, v131, v131 row_ror:4 row_mask:0xf bank_mask:0xf
    v_add_f32_dpp v136, v132, v132 row_ror:4 row_mask:0xf bank_mask:0xf
    v_add_f32_dpp v137, v133, v133 row_ror:4 row_mask:0xf bank_mask:0xf
    v_add_f32_dpp v130, v134, v134 row_ror:8 row_mask:0xf bank_mask:0xf
    v_add_f32_dpp v131, v135, v135 row_ror:8 row_mask:0xf bank_mask:0xf
    v_add_f32_dpp v132, v136, v136 row_ror:8 row_mask:0xf bank_mask:0xf
    v_add_f32_dpp v133, v137, v137 row_ror:8 row_mask:0xf bank_mask:0xf
    s_mov_b64 exec, s[22:23]
    v_cvt_pk_bf16_f32 v130, v130, v131
    v_cvt_pk_bf16_f32 v131, v132, v133
    v_and_or_b32 v130, v130, -2, s68
    buffer_store_dwordx2 v[130:131], v41, s[44:47], s54 offen sc1
    s_mov_b64 exec, -1
L_a3_hr:
    s_barrier
    s_mov_b64 exec, s[100:101]
    ds_write_b128 v35, v[148:151]
    s_mov_b64 exec, -1
    ds_write_b128 v28, v[50:53]
    ds_write_b128 v38, v[62:65]
    ds_write_b128 v29, v[54:57]
    ds_write_b128 v39, v[66:69]
    ds_write_b128 v30, v[58:61]
    ds_write_b128 v40, v[70:73]
    s_mov_b64 exec, -1
    s_mov_b32 s74, 0
.p2align 5
L_p3_hr:
    buffer_load_dwordx4 v[130:133], v17, s[44:47], s55 offen sc1
    buffer_load_dwordx4 v[134:137], v17, s[44:47], s56 offen sc1
    s_add_u32 s74, s74, 1
    s_cmp_gt_u32 s74, 4194304
    s_cbranch_scc1 L_chain_done
    s_waitcnt vmcnt(0)
    v_bitop3_b32 v138, v130, s69, v132 bitop3:0x24
    v_bitop3_b32 v139, v134, s69, v136 bitop3:0x24
    v_bitop3_b32 v138, v138, 1, v139 bitop3:0x80
    v_cmp_eq_u32 vcc, 0, v138
    s_cbranch_vccnz L_p3_hr
    ds_write_b64 v42, v[130:131] offset:0
    ds_write_b64 v42, v[132:133] offset:1296
    ds_write_b64 v43, v[134:135] offset:0
    ds_write_b64 v43, v[136:137] offset:1296
    s_add_u32 s60, s60, 1
    s_branch L_top_hr
.p2align 5
L_p1b_hr:
    buffer_load_dwordx4 v[130:133], v17, s[44:47], s57 offen sc1
    buffer_load_dwordx4 v[134:137], v17, s[44:47], s50 offen sc1
    s_add_u32 s74, s74, 1
    s_cmp_gt_u32 s74, 4194304
    s_cbranch_scc1 L_chain_done
    s_waitcnt vmcnt(2)
    v_bitop3_b32 v138, v140, s69, v142 bitop3:0x24
    v_bitop3_b32 v139, v144, s69, v146 bitop3:0x24
    v_bitop3_b32 v138, v138, 1, v139 bitop3:0x80
    v_cmp_eq_u32 vcc, 0, v138
    s_cbranch_vccnz L_p1_hr
    ds_write_b128 v46, v[140:143]
    ds_write_b128 v47, v[144:147]
    s_branch L_p1e_hr
.p2align 5
L_p2b_hr:
    buffer_load_dwordx4 v[114:117], v18, s[44:47], s52 offen sc1
    buffer_load_dwordx4 v[118:121], v18, s[44:47], s52 offen offset:1024 sc1
    s_add_u32 s74, s74, 1
    s_cmp_gt_u32 s74, 4194304
    s_cbranch_scc1 L_chain_done
    s_waitcnt vmcnt(2)
    v_bitop3_b32 v138, v74, s39, v76 bitop3:0x24
    v_bitop3_b32 v139, v78, s39, v80 bitop3:0x24
    v_bitop3_b32 v138, v138, 1, v139 bitop3:0x80
    v_cmp_eq_u32 vcc, 0, v138
    s_cbranch_vccnz L_p2_hr
    v_mfma_f32_16x16x32_bf16 v[130:133], v[24:27], v[74:77], 0
    v_mfma_f32_16x16x32_bf16 v[130:133], v[24:27], v[78:81], v[130:133]
    s_add_u32 s52, s52, s37
    s_add_u32 s53, s53, s37
    s_sub_u32 s37, 0, s37
    s_nop 4
    v_add_f32_dpp v134, v130, v130 row_ror:4 row_mask:0xf bank_mask:0xf
    v_add_f32_dpp v135, v131, v131 row_ror:4 row_mask:0xf bank_mask:0xf
    v_add_f32_dpp v136, v132, v132 row_ror:4 row_mask:0xf bank_mask:0xf
    v_add_f32_dpp v137, v133, v133 row_ror:4 row_mask:0xf bank_mask:0xf
    v_add_f32_dpp v130, v134, v134 row_ror:8 row_mask:0xf bank_mask:0xf
    v_add_f32_dpp v131, v135, v135 row_ror:8 row_mask:0xf bank_mask:0xf
    v_add_f32_dpp v132, v136, v136 row_ror:8 row_mask:0xf bank_mask:0xf
    v_add_f32_dpp v133, v137, v137 row_ror:8 row_mask:0xf bank_mask:0xf
    s_mov_b64 exec, s[22:23]
    v_cvt_pk_bf16_f32 v130, v130, v131
    v_cvt_pk_bf16_f32 v131, v132, v133
    v_and_or_b32 v130, v130, -2, s68
    buffer_store_dwordx2 v[130:131], v41, s[44:47], s54 offen sc1
    s_mov_b64 exec, -1
    s_branch L_a3_hr
.p2align 5
L_top_gr:
    s_waitcnt lgkmcnt(0)
    s_barrier
    ds_read_b128 v[74:77], v5 offset:0
    ds_read_b128 v[78:81], v5 offset:128
    ds_read_b128 v[82:85], v5 offset:256
    ds_read_b128 v[86:89], v5 offset:384
    ds_read_b128 v[90:93], v5 offset:512
    ds_read_b128 v[94:97], v5 offset:640
    ds_read_b128 v[98:101], v5 offset:768
    ds_read_b128 v[102:105], v5 offset:896
    ds_read_b128 v[106:109], v5 offset:1024
    ds_read_b128 v[110:113], v5 offset:1152
    s_add_u32 s68, s60, 1
    s_and_b32 s68, s68, 1
    s_xor_b32 s69, s68, 1
    s_bfe_u32 s39, s60, 0x10001
    s_xor_b32 s38, s39, 1
    s_waitcnt lgkmcnt(9)
    v_mfma_f32_16x16x32_bf16 v[114:117], v[74:77], a[0:3], 0
    s_waitcnt lgkmcnt(8)
    v_mfma_f32_16x16x32_bf16 v[118:121], v[78:81], a[8:11], 0
    s_waitcnt lgkmcnt(7)
    v_mfma_f32_16x16x32_bf16 v[114:117], v[82:85], a[16:19], v[114:117]
    s_waitcnt lgkmcnt(6)
    v_mfma_f32_16x16x32_bf16 v[118:121], v[86:89], a[24:27], v[118:121]
    s_waitcnt lgkmcnt(5)
    v_mfma_f32_16x16x32_bf16 v[114:117], v[90:93], a[32:35], v[114:117]
    s_waitcnt lgkmcnt(4)
    v_mfma_f32_16x16x32_bf16 v[118:121], v[94:97], a[40:43], v[118:121]
    s_waitcnt lgkmcnt(3)
    v_mfma_f32_16x16x32_bf16 v[114:117], v[98:101], a[48:51], v[114:117]
    s_waitcnt lgkmcnt(2)
    v_mfma_f32_16x16x32_bf16 v[118:121], v[102:105], a[56:59], v[118:121]
    s_waitcnt lgkmcnt(1)
    v_mfma_f32_16x16x32_bf16 v[114:117], v[106:109], a[64:67], v[114:117]
    s_waitcnt lgkmcnt(0)
    v_mfma_f32_16x16x32_bf16 v[118:121], v[110:113], a[72:75], v[118:121]
    s_nop 7
    v_pk_add_f32 v[114:115], v[114:115], v[118:119]
    v_pk_add_f32 v[116:117], v[116:117], v[120:121]
    s_nop 0
    v_mov_b32 v118, v114
    v_mov_b32 v119, v115
    v_mov_b32 v120, v116
    v_mov_b32 v121, v117
    v_permlane32_swap_b32 v118, v122
    v_permlane32_swap_b32 v119, v123
    v_permlane32_swap_b32 v120, v124
    v_permlane32_swap_b32 v121, v125
    v_add_f32_dpp v114, v122, v114 row_ror:8 row_mask:0xf bank_mask:0xf
    v_add_f32_dpp v115, v123, v115 row_ror:8 row_mask:0xf bank_mask:0xf
    v_add_f32_dpp v116, v124, v116 row_ror:8 row_mask:0xf bank_mask:0xf
    v_add_f32_dpp v117, v125, v117 row_ror:8 row_mask:0xf bank_mask:0xf
    s_mov_b64 exec, s[66:67]
    v_cvt_pk_bf16_f32 v132, v114, v115
    v_cvt_pk_bf16_f32 v133, v116, v117
    v_and_or_b32 v132, v132, -2, s68
    buffer_store_dwordx2 v[132:133], v23, s[44:47], s51 offen sc1
    s_mov_b64 exec, -1
    s_add_u32 s75, s60, 2
    s_and_b32 s73, s75, 3
    s_mul_i32 s73, s73, 1179648
    s_add_u32 s73, s73, s14
    s_add_u32 s75, s60, 1
    s_and_b32 s61, s75, 3
    s_mul_i32 s61, s61, 1179648
    s_add_u32 s61, s61, s14
    s_mul_i32 s70, s60, 393216
    s_add_u32 s70, s70, s58
    s_mul_i32 s75, s75, 3
    s_mov_b32 s74, 0
    buffer_load_dwordx4 v[130:133], v17, s[44:47], s57 offen sc1
    buffer_load_dwordx4 v[134:137], v17, s[44:47], s50 offen sc1
    s_sleep 4
.p2align 5
L_p1_gr:
    buffer_load_dwordx4 v[140:143], v17, s[44:47], s57 offen sc1
    buffer_load_dwordx4 v[144:147], v17, s[44:47], s50 offen sc1
    s_waitcnt vmcnt(2)
    v_bitop3_b32 v138, v130, s69, v132 bitop3:0x24
    v_bitop3_b32 v139, v134, s69, v136 bitop3:0x24
    v_bitop3_b32 v138, v138, 1, v139 bitop3:0x80
    v_cmp_eq_u32 vcc, 0, v138
    s_cbranch_vccnz L_p1b_gr
    ds_write_b128 v46, v[130:133]
    ds_write_b128 v47, v[134:137]
L_p1e_gr:
    s_waitcnt lgkmcnt(0)
    s_barrier
    s_waitcnt vmcnt(0)
    buffer_load_dwordx4 v[50:53], v12, s[28:31], s61 offen sc1
    buffer_load_dwordx4 v[62:65], v12, s[28:31], s61 offen offset:1536 sc1
    buffer_load_dwordx4 v[54:57], v13, s[28:31], s61 offen sc1
    buffer_load_dwordx4 v[66:69], v13, s[28:31], s61 offen offset:1536 sc1
    buffer_load_dwordx4 v[58:61], v14, s[28:31], s61 offen sc1
    buffer_load_dwordx4 v[70:73], v14, s[28:31], s61 offen offset:1536 sc1
    s_mov_b64 exec, s[100:101]
    buffer_load_dwordx4 v[148:151], v34, s[28:31], s61 offen sc1
    s_mov_b64 exec, -1
    s_cmp_gt_u32 s60, 61
    s_cbranch_scc1 L_chain_nostgr
    s_add_u32 s17, s73, s16
    s_mov_b64 exec, s[18:19]
    buffer_store_dwordx2 v[6:7], v44, s[28:31], s73 offen sc1
    buffer_store_dwordx2 v[8:9], v44, s[28:31], s17 offen sc1
    s_mov_b64 exec, -1
L_chain_nostgr:
    s_cmp_gt_u32 s60, 60
    s_cbranch_scc1 L_noxp_gr
    ds_read_b128 v[74:77], v4 offset:0
    ds_read_b128 v[78:81], v11 offset:0
    ds_read_b128 v[82:85], v4 offset:128
    ds_read_b128 v[86:89], v11 offset:128
    ds_read_b128 v[90:93], v4 offset:256
    ds_read_b128 v[94:97], v11 offset:256
    ds_read_b128 v[98:101], v4 offset:384
    ds_read_b128 v[102:105], v11 offset:384
    ds_read_b128 v[106:109], v4 offset:512
    ds_read_b128 v[110:113], v11 offset:512
    s_waitcnt lgkmcnt(9)
    v_mfma_f32_16x16x32_bf16 v[122:125], v[74:77], a[0:3], 0
    ds_read_b128 v[74:77], v4 offset:640
    s_waitcnt lgkmcnt(9)
    v_mfma_f32_16x16x32_bf16 v[126:129], v[78:81], a[4:7], 0
    ds_read_b128 v[78:81], v11 offset:640
    s_waitcnt lgkmcnt(9)
    v_mfma_f32_16x16x32_bf16 v[122:125], v[82:85], a[8:11], v[122:125]
    ds_read_b128 v[82:85], v4 offset:768
    s_waitcnt lgkmcnt(9)
    v_mfma_f32_16x16x32_bf16 v[126:129], v[86:89], a[12:15], v[126:129]
    ds_read_b128 v[86:89], v11 offset:768
    s_waitcnt lgkmcnt(9)
    v_mfma_f32_16x16x32_bf16 v[122:125], v[90:93], a[16:19], v[122:125]
    ds_read_b128 v[90:93], v4 offset:896
    s_waitcnt lgkmcnt(9)
    v_mfma_f32_16x16x32_bf16 v[126:129], v[94:97], a[20:23], v[126:129]
    ds_read_b128 v[94:97], v11 offset:896
    s_waitcnt lgkmcnt(9)
    v_mfma_f32_16x16x32_bf16 v[122:125], v[98:101], a[24:27], v[122:125]
    ds_read_b128 v[98:101], v4 offset:1024
    s_waitcnt lgkmcnt(9)
    v_mfma_f32_16x16x32_bf16 v[126:129], v[102:105], a[28:31], v[126:129]
    ds_read_b128 v[102:105], v11 offset:1024
    s_waitcnt lgkmcnt(9)
    v_mfma_f32_16x16x32_bf16 v[122:125], v[106:109], a[32:35], v[122:125]
    ds_read_b128 v[106:109], v4 offset:1152
    s_waitcnt lgkmcnt(9)
    v_mfma_f32_16x16x32_bf16 v[126:129], v[110:113], a[36:39], v[126:129]
    ds_read_b128 v[110:113], v11 offset:1152
    s_waitcnt lgkmcnt(9)
    v_mfma_f32_16x16x32_bf16 v[122:125], v[74:77], a[40:43], v[122:125]
    s_waitcnt lgkmcnt(8)
    v_mfma_f32_16x16x32_bf16 v[126:129], v[78:81], a[44:47], v[126:129]
    s_waitcnt lgkmcnt(7)
    v_mfma_f32_16x16x32_bf16 v[122:125], v[82:85], a[48:51], v[122:125]
    s_waitcnt lgkmcnt(6)
    v_mfma_f32_16x16x32_bf16 v[126:129], v[86:89], a[52:55], v[126:129]
    s_waitcnt lgkmcnt(5)
    v_mfma_f32_16x16x32_bf16 v[122:125], v[90:93], a[56:59], v[122:125]
    s_waitcnt lgkmcnt(4)
    v_mfma_f32_16x16x32_bf16 v[126:129], v[94:97], a[60:63], v[126:129]
    s_waitcnt lgkmcnt(3)
    v_mfma_f32_16x16x32_bf16 v[122:125], v[98:101], a[64:67], v[122:125]
    s_waitcnt lgkmcnt(2)
    v_mfma_f32_16x16x32_bf16 v[126:129], v[102:105], a[68:71], v[126:129]
    s_waitcnt lgkmcnt(1)
    v_mfma_f32_16x16x32_bf16 v[122:125], v[106:109], a[72:75], v[122:125]
    s_waitcnt lgkmcnt(0)
    v_mfma_f32_16x16x32_bf16 v[126:129], v[110:113], a[76:79], v[126:129]
    s_nop 7
    v_pk_add_f32 v[122:123], v[122:123], v[126:127]
    v_pk_add_f32 v[124:125], v[124:125], v[128:129]
    v_cvt_pk_bf16_f32 v6, v122, v123
    v_cvt_pk_bf16_f32 v7, v124, v125
L_noxp_gr:
    s_mov_b32 s17, s70
    s_add_u32 s70, s60, 1
    s_mov_b32 s74, 0
.p2align 5
L_f_gr:
    ds_read_b32 v134, v49 offset:62464
    s_add_u32 s74, s74, 1
    s_cmp_gt_u32 s74, 4194304
    s_cbranch_scc1 L_chain_done
    s_waitcnt lgkmcnt(0)
    v_cmp_ne_u32 vcc, s75, v134
    s_cbranch_vccnz L_f_gr
    ds_read_b128 v[74:77], v18 offset:56320
    ds_read_b128 v[78:81], v18 offset:57344
    ds_read_b128 v[82:85], v18 offset:58368
    ds_read_b128 v[86:89], v18 offset:59392
    ds_read_b128 v[90:93], v18 offset:60416
    ds_read_b128 v[94:97], v18 offset:61440
    s_waitcnt lgkmcnt(5)
    v_mfma_f32_16x16x32_bf16 v[144:147], a[80:83], v[74:77], 0
    s_waitcnt lgkmcnt(4)
    v_mfma_f32_16x16x32_bf16 v[144:147], a[84:87], v[78:81], v[144:147]
    s_waitcnt lgkmcnt(3)
    v_mfma_f32_16x16x32_bf16 v[144:147], a[88:91], v[82:85], v[144:147]
    s_waitcnt lgkmcnt(2)
    v_mfma_f32_16x16x32_bf16 v[144:147], a[92:95], v[86:89], v[144:147]
    s_waitcnt lgkmcnt(1)
    v_mfma_f32_16x16x32_bf16 v[144:147], a[96:99], v[90:93], v[144:147]
    s_waitcnt lgkmcnt(0)
    v_mfma_f32_16x16x32_bf16 v[144:147], a[100:103], v[94:97], v[144:147]
    s_cmp_eq_u32 s60, 63
    s_cselect_b64 exec, 0, s[62:63]
    s_nop 5
    v_cvt_pk_bf16_f32 v130, v144, v145
    v_cvt_pk_bf16_f32 v131, v146, v147
    v_and_or_b32 v130, v130, -2, s38
    buffer_store_dwordx2 v[130:131], v33, s[44:47], s53 offen sc1
    s_sleep 2
    s_mov_b64 exec, s[12:13]
    buffer_store_dwordx2 v[74:75], v36, s[40:43], s17 offen offset:0
    buffer_store_dwordx2 v[76:77], v36, s[40:43], s17 offen offset:32
    buffer_store_dwordx2 v[78:79], v36, s[40:43], s17 offen offset:64
    buffer_store_dwordx2 v[80:81], v36, s[40:43], s17 offen offset:96
    buffer_store_dwordx2 v[82:83], v36, s[40:43], s17 offen offset:128
    buffer_store_dwordx2 v[84:85], v36, s[40:43], s17 offen offset:160
    s_mov_b64 exec, -1
    s_cmp_eq_u32 s60, 63
    s_cbranch_scc1 L_chain_done
    s_cmp_gt_u32 s60, 59
    s_cbranch_scc1 L_nodma_gr
    s_add_u32 s75, s72, 0
    s_mov_b32 m0, s75
    s_add_u32 s75, s71, 0
    buffer_load_dwordx4 v16, s[32:35], s75 offen lds
    s_add_u32 s75, s72, 5120
    s_mov_b32 m0, s75
    s_add_u32 s75, s71, 5120
    buffer_load_dwordx4 v21, s[32:35], s75 offen lds
    s_add_u32 s75, s72, 10240
    s_mov_b32 m0, s75
    s_add_u32 s75, s71, 10240
    buffer_load_dwordx4 v16, s[32:35], s75 offen lds
    s_add_u32 s75, s72, 15360
    s_mov_b32 m0, s75
    s_add_u32 s75, s71, 15360
    buffer_load_dwordx4 v21, s[32:35], s75 offen lds
    s_add_u32 s75, s72, 20480
    s_mov_b32 m0, s75
    s_add_u32 s75, s71, 20480
    buffer_load_dwordx4 v16, s[32:35], s75 offen lds
    s_add_u32 s75, s72, 25600
    s_mov_b32 m0, s75
    s_add_u32 s75, s71, 25600
    buffer_load_dwordx4 v21, s[32:35], s75 offen lds
    s_add_u32 s75, s72, 30720
    s_mov_b32 m0, s75
    s_add_u32 s75, s71, 30720
    buffer_load_dwordx4 v16, s[32:35], s75 offen lds
    s_add_u32 s75, s72, 35840
    s_mov_b32 m0, s75
    s_add_u32 s75, s71, 35840
    buffer_load_dwordx4 v21, s[32:35], s75 offen lds
    s_add_u32 s71, s71, 40960
    s_sub_u32 s72, s3, s72
L_nodma_gr:
    s_cmp_gt_u32 s60, 60
    s_cbranch_scc1 L_noxq_gr
    ds_read_b128 v[74:77], v4 offset:20480
    ds_read_b128 v[78:81], v11 offset:20480
    ds_read_b128 v[82:85], v4 offset:20608
    ds_read_b128 v[86:89], v11 offset:20608
    ds_read_b128 v[90:93], v4 offset:20736
    ds_read_b128 v[94:97], v11 offset:20736
    ds_read_b128 v[98:101], v4 offset:20864
    ds_read_b128 v[102:105], v11 offset:20864
    ds_read_b128 v[106:109], v4 offset:20992
    ds_read_b128 v[110:113], v11 offset:20992
    s_waitcnt lgkmcnt(9)
    v_mfma_f32_16x16x32_bf16 v[122:125], v[74:77], a[0:3], 0
    ds_read_b128 v[74:77], v4 offset:21120
    s_waitcnt lgkmcnt(9)
    v_mfma_f32_16x16x32_bf16 v[126:129], v[78:81], a[4:7], 0
    ds_read_b128 v[78:81], v11 offset:21120
    s_waitcnt lgkmcnt(9)
    v_mfma_f32_16x16x32_bf16 v[122:125], v[82:85], a[8:11], v[122:125]
    ds_read_b128 v[82:85], v4 offset:21248
    s_waitcnt lgkmcnt(9)
    v_mfma_f32_16x16x32_bf16 v[126:129], v[86:89], a[12:15], v[126:129]
    ds_read_b128 v[86:89], v11 offset:21248
    s_waitcnt lgkmcnt(9)
    v_mfma_f32_16x16x32_bf16 v[122:125], v[90:93], a[16:19], v[122:125]
    ds_read_b128 v[90:93], v4 offset:21376
    s_waitcnt lgkmcnt(9)
    v_mfma_f32_16x16x32_bf16 v[126:129], v[94:97], a[20:23], v[126:129]
    ds_read_b128 v[94:97], v11 offset:21376
    s_waitcnt lgkmcnt(9)
    v_mfma_f32_16x16x32_bf16 v[122:125], v[98:101], a[24:27], v[122:125]
    ds_read_b128 v[98:101], v4 offset:21504
    s_waitcnt lgkmcnt(9)
    v_mfma_f32_16x16x32_bf16 v[126:129], v[102:105], a[28:31], v[126:129]
    ds_read_b128 v[102:105], v11 offset:21504
    s_waitcnt lgkmcnt(9)
    v_mfma_f32_16x16x32_bf16 v[122:125], v[106:109], a[32:35], v[122:125]
    ds_read_b128 v[106:109], v4 offset:21632
    s_waitcnt lgkmcnt(9)
    v_mfma_f32_16x16x32_bf16 v[126:129], v[110:113], a[36:39], v[126:129]
    ds_read_b128 v[110:113], v11 offset:21632
    s_waitcnt lgkmcnt(9)
    v_mfma_f32_16x16x32_bf16 v[122:125], v[74:77], a[40:43], v[122:125]
    s_waitcnt lgkmcnt(8)
    v_mfma_f32_16x16x32_bf16 v[126:129], v[78:81], a[44:47], v[126:129]
    s_waitcnt lgkmcnt(7)
    v_mfma_f32_16x16x32_bf16 v[122:125], v[82:85], a[48:51], v[122:125]
    s_waitcnt lgkmcnt(6)
    v_mfma_f32_16x16x32_bf16 v[126:129], v[86:89], a[52:55], v[126:129]
    s_waitcnt lgkmcnt(5)
    v_mfma_f32_16x16x32_bf16 v[122:125], v[90:93], a[56:59], v[122:125]
    s_waitcnt lgkmcnt(4)
    v_mfma_f32_16x16x32_bf16 v[126:129], v[94:97], a[60:63], v[126:129]
    s_waitcnt lgkmcnt(3)
    v_mfma_f32_16x16x32_bf16 v[122:125], v[98:101], a[64:67], v[122:125]
    s_waitcnt lgkmcnt(2)
    v_mfma_f32_16x16x32_bf16 v[126:129], v[102:105], a[68:71], v[126:129]
    s_waitcnt lgkmcnt(1)
    v_mfma_f32_16x16x32_bf16 v[122:125], v[106:109], a[72:75], v[122:125]
    s_waitcnt lgkmcnt(0)
    v_mfma_f32_16x16x32_bf16 v[126:129], v[110:113], a[76:79], v[126:129]
    s_nop 7
    v_pk_add_f32 v[122:123], v[122:123], v[126:127]
    v_pk_add_f32 v[124:125], v[124:125], v[128:129]
    v_cvt_pk_bf16_f32 v8, v122, v123
    v_cvt_pk_bf16_f32 v9, v124, v125
    v_add_u32 v4, s9, v4
    v_add_u32 v11, s9, v11
    s_sub_u32 s9, 0, s9
L_noxq_gr:
    s_mov_b32 s74, 0
    buffer_load_dwordx4 v[114:117], v18, s[44:47], s52 offen sc1
    buffer_load_dwordx4 v[118:121], v18, s[44:47], s52 offen offset:1024 sc1
    s_sleep 8
.p2align 5
L_p2_gr:
    buffer_load_dwordx4 v[74:77], v18, s[44:47], s52 offen sc1
    buffer_load_dwordx4 v[78:81], v18, s[44:47], s52 offen offset:1024 sc1
    s_waitcnt vmcnt(2)
    v_bitop3_b32 v138, v114, s39, v116 bitop3:0x24
    v_bitop3_b32 v139, v118, s39, v120 bitop3:0x24
    v_bitop3_b32 v138, v138, 1, v139 bitop3:0x80
    v_cmp_eq_u32 vcc, 0, v138
    s_cbranch_vccnz L_p2b_gr
    v_mfma_f32_16x16x32_bf16 v[130:133], v[24:27], v[114:117], 0
    v_mfma_f32_16x16x32_bf16 v[130:133], v[24:27], v[118:121], v[130:133]
    s_add_u32 s52, s52, s37
    s_add_u32 s53, s53, s37
    s_sub_u32 s37, 0, s37
    s_nop 4
    v_add_f32_dpp v134, v130, v130 row_ror:4 row_mask:0xf bank_mask:0xf
    v_add_f32_dpp v135, v131, v131 row_ror:4 row_mask:0xf bank_mask:0xf
    v_add_f32_dpp v136, v132, v132 row_ror:4 row_mask:0xf bank_mask:0xf
    v_add_f32_dpp v137, v133, v133 row_ror:4 row_mask:0xf bank_mask:0xf
    v_add_f32_dpp v130, v134, v134 row_ror:8 row_mask:0xf bank_mask:0xf
    v_add_f32_dpp v131, v135, v135 row_ror:8 row_mask:0xf bank_mask:0xf
    v_add_f32_dpp v132, v136, v136 row_ror:8 row_mask:0xf bank_mask:0xf
    v_add_f32_dpp v133, v137, v137 row_ror:8 row_mask:0xf bank_mask:0xf
    s_mov_b64 exec, s[22:23]
    v_cvt_pk_bf16_f32 v130, v130, v131
    v_cvt_pk_bf16_f32 v131, v132, v133
    v_and_or_b32 v130, v130, -2, s68
    buffer_store_dwordx2 v[130:131], v41, s[44:47], s54 offen sc1
    s_mov_b64 exec, -1
L_a3_gr:
    s_barrier
    s_mov_b64 exec, s[100:101]
    ds_write_b128 v35, v[148:151]
    s_mov_b64 exec, -1
    ds_write_b128 v28, v[50:53]
    ds_write_b128 v38, v[62:65]
    ds_write_b128 v29, v[54:57]
    ds_write_b128 v39, v[66:69]
    ds_write_b128 v30, v[58:61]
    ds_write_b128 v40, v[70:73]
    s_mov_b64 exec, -1
    s_mov_b32 s74, 0
.p2align 5
L_p3_gr:
    buffer_load_dwordx4 v[130:133], v17, s[44:47], s55 offen sc1
    buffer_load_dwordx4 v[134:137], v17, s[44:47], s56 offen sc1
    s_add_u32 s74, s74, 1
    s_cmp_gt_u32 s74, 4194304
    s_cbranch_scc1 L_chain_done
    s_waitcnt vmcnt(0)
    v_bitop3_b32 v138, v130, s69, v132 bitop3:0x24
    v_bitop3_b32 v139, v134, s69, v136 bitop3:0x24
    v_bitop3_b32 v138, v138, 1, v139 bitop3:0x80
    v_cmp_eq_u32 vcc, 0, v138
    s_cbranch_vccnz L_p3_gr
    ds_write_b64 v42, v[130:131] offset:0
    ds_write_b64 v42, v[132:133] offset:1296
    ds_write_b64 v43, v[134:135] offset:0
    ds_write_b64 v43, v[136:137] offset:1296
    s_add_u32 s60, s60, 1
    s_branch L_top_gr
.p2align 5
L_p1b_gr:
    buffer_load_dwordx4 v[130:133], v17, s[44:47], s57 offen sc1
    buffer_load_dwordx4 v[134:137], v17, s[44:47], s50 offen sc1
    s_add_u32 s74, s74, 1
    s_cmp_gt_u32 s74, 4194304
    s_cbranch_scc1 L_chain_done
    s_waitcnt vmcnt(2)
    v_bitop3_b32 v138, v140, s69, v142 bitop3:0x24
    v_bitop3_b32 v139, v144, s69, v146 bitop3:0x24
    v_bitop3_b32 v138, v138, 1, v139 bitop3:0x80
    v_cmp_eq_u32 vcc, 0, v138
    s_cbranch_vccnz L_p1_gr
    ds_write_b128 v46, v[140:143]
    ds_write_b128 v47, v[144:147]
    s_branch L_p1e_gr
.p2align 5
L_p2b_gr:
    buffer_load_dwordx4 v[114:117], v18, s[44:47], s52 offen sc1
    buffer_load_dwordx4 v[118:121], v18, s[44:47], s52 offen offset:1024 sc1
    s_add_u32 s74, s74, 1
    s_cmp_gt_u32 s74, 4194304
    s_cbranch_scc1 L_chain_done
    s_waitcnt vmcnt(2)
    v_bitop3_b32 v138, v74, s39, v76 bitop3:0x24
    v_bitop3_b32 v139, v78, s39, v80 bitop3:0x24
    v_bitop3_b32 v138, v138, 1, v139 bitop3:0x80
    v_cmp_eq_u32 vcc, 0, v138
    s_cbranch_vccnz L_p2_gr
    v_mfma_f32_16x16x32_bf16 v[130:133], v[24:27], v[74:77], 0
    v_mfma_f32_16x16x32_bf16 v[130:133], v[24:27], v[78:81], v[130:133]
    s_add_u32 s52, s52, s37
    s_add_u32 s53, s53, s37
    s_sub_u32 s37, 0, s37
    s_nop 4
    v_add_f32_dpp v134, v130, v130 row_ror:4 row_mask:0xf bank_mask:0xf
    v_add_f32_dpp v135, v131, v131 row_ror:4 row_mask:0xf bank_mask:0xf
    v_add_f32_dpp v136, v132, v132 row_ror:4 row_mask:0xf bank_mask:0xf
    v_add_f32_dpp v137, v133, v133 row_ror:4 row_mask:0xf bank_mask:0xf
    v_add_f32_dpp v130, v134, v134 row_ror:8 row_mask:0xf bank_mask:0xf
    v_add_f32_dpp v131, v135, v135 row_ror:8 row_mask:0xf bank_mask:0xf
    v_add_f32_dpp v132, v136, v136 row_ror:8 row_mask:0xf bank_mask:0xf
    v_add_f32_dpp v133, v137, v137 row_ror:8 row_mask:0xf bank_mask:0xf
    s_mov_b64 exec, s[22:23]
    v_cvt_pk_bf16_f32 v130, v130, v131
    v_cvt_pk_bf16_f32 v131, v132, v133
    v_and_or_b32 v130, v130, -2, s68
    buffer_store_dwordx2 v[130:131], v41, s[44:47], s54 offen sc1
    s_mov_b64 exec, -1
    s_branch L_a3_gr
L_chain_done:
    s_mov_b64 exec, -1
L_chain_end:
    s_endpgm
L_wt6:
    s_load_dwordx2 s[40:41], s[0:1], 64
    s_load_dwordx2 s[42:43], s[0:1], 72
    s_load_dwordx2 s[44:45], s[0:1], 80
    v_and_b32 v1, 63, v0
    v_lshlrev_b32 v2, 2, v1
    s_mov_b32 s30, 0x05040100
    s_mov_b32 s31, 0x07060302
    s_waitcnt lgkmcnt(0)
    s_mov_b32 s8, s40
    s_mov_b32 s9, s41
    s_and_b32 s9, s9, 0xffff
    s_mov_b32 s10, 0x1e0000
    s_mov_b32 s11, 0x20000
    s_add_u32 s48, s4, 0x2200000
    s_addc_u32 s49, s5, 0
    s_and_b32 s49, s49, 0xffff
    s_mov_b32 s50, 0x3c0000
    s_mov_b32 s51, 0x20000
    v_lshlrev_b32 v3, 1, v1
    v_lshrrev_b32 v6, 3, v3
    v_lshlrev_b32 v6, 4, v6
    v_and_b32 v3, 7, v3
    v_add_u32 v3, v3, v6
    v_mul_u32_u24 v3, 1280, v3
    s_mov_b32 s20, s2
    s_mov_b32 s23, 0x15555556
    s_mul_hi_u32 s21, s20, s23
    s_mul_i32 s23, s21, 12
    s_sub_u32 s22, s20, s23
    s_mul_i32 s24, s21, 49152
    s_lshl_b32 s25, s22, 8
    s_add_u32 s60, s24, s25
    s_mul_i32 s25, s22, 327680
    s_lshl_b32 s26, s21, 5
    s_add_u32 s32, s25, s26
    s_add_u32 s20, s2, 256
    s_cmp_ge_u32 s20, 480
    s_cselect_b32 s20, s2, s20
    s_mov_b32 s23, 0x15555556
    s_mul_hi_u32 s21, s20, s23
    s_mul_i32 s23, s21, 12
    s_sub_u32 s22, s20, s23
    s_mul_i32 s24, s21, 49152
    s_lshl_b32 s25, s22, 8
    s_add_u32 s61, s24, s25
    s_mul_i32 s25, s22, 327680
    s_lshl_b32 s26, s21, 5
    s_add_u32 s33, s25, s26
    s_mov_b32 s12, s42
    s_mov_b32 s13, s43
    s_and_b32 s13, s13, 0xffff
    s_mov_b32 s14, 0x1e0000
    s_mov_b32 s15, 0x20000
    s_add_u32 s52, s4, 0x2200000
    s_addc_u32 s53, s5, 0
    s_and_b32 s53, s53, 0xffff
    s_mov_b32 s54, 0x3c0000
    s_mov_b32 s55, 0x20000
    v_lshlrev_b32 v4, 1, v1
    v_lshrrev_b32 v6, 3, v4
    v_lshlrev_b32 v6, 4, v6
    v_and_b32 v4, 7, v4
    v_add_u32 v4, v4, v6
    v_add_u32 v4, 8, v4
    v_mul_u32_u24 v4, 1280, v4
    s_mov_b32 s20, s2
    s_mov_b32 s23, 0x15555556
    s_mul_hi_u32 s21, s20, s23
    s_mul_i32 s23, s21, 12
    s_sub_u32 s22, s20, s23
    s_mul_i32 s24, s21, 49152
    s_lshl_b32 s25, s22, 8
    s_add_u32 s62, s24, s25
    s_mul_i32 s25, s22, 327680
    s_lshl_b32 s26, s21, 5
    s_add_u32 s34, s25, s26
    s_add_u32 s20, s2, 256
    s_cmp_ge_u32 s20, 480
    s_cselect_b32 s20, s2, s20
    s_mov_b32 s23, 0x15555556
    s_mul_hi_u32 s21, s20, s23
    s_mul_i32 s23, s21, 12
    s_sub_u32 s22, s20, s23
    s_mul_i32 s24, s21, 49152
    s_lshl_b32 s25, s22, 8
    s_add_u32 s63, s24, s25
    s_mul_i32 s25, s22, 327680
    s_lshl_b32 s26, s21, 5
    s_add_u32 s35, s25, s26
    s_mov_b32 s16, s44
    s_mov_b32 s17, s45
    s_and_b32 s17, s17, 0xffff
    s_mov_b32 s18, 0x1e0000
    s_mov_b32 s19, 0x20000
    s_add_u32 s56, s4, 0x2600000
    s_addc_u32 s57, s5, 0
    s_and_b32 s57, s57, 0xffff
    s_mov_b32 s58, 0x1e0000
    s_mov_b32 s59, 0x20000
    v_lshlrev_b32 v5, 1, v1
    v_mul_u32_u24 v5, 3072, v5
    s_mov_b32 s20, s2
    s_mov_b32 s23, 0x33333334
    s_mul_hi_u32 s21, s20, s23
    s_mul_i32 s23, s21, 5
    s_sub_u32 s22, s20, s23
    s_mul_i32 s24, s21, 20480
    s_lshl_b32 s25, s22, 8
    s_add_u32 s64, s24, s25
    s_mul_i32 s25, s22, 393216
    s_lshl_b32 s26, s21, 5
    s_add_u32 s36, s25, s26
    s_add_u32 s20, s2, 256
    s_cmp_ge_u32 s20, 480
    s_cselect_b32 s20, s2, s20
    s_mov_b32 s23, 0x33333334
    s_mul_hi_u32 s21, s20, s23
    s_mul_i32 s23, s21, 5
    s_sub_u32 s22, s20, s23
    s_mul_i32 s24, s21, 20480
    s_lshl_b32 s25, s22, 8
    s_add_u32 s65, s24, s25
    s_mul_i32 s25, s22, 393216
    s_lshl_b32 s26, s21, 5
    s_add_u32 s37, s25, s26
    s_mov_b32 s38, 1
L_wt6_stg:
    s_barrier
    s_sub_u32 s38, s38, 1
    s_cmp_lg_u32 s38, 0
    s_cbranch_scc1 L_wt6_stg
    buffer_load_dword v8, v2, s[8:11], s60 offen
    s_add_u32 s60, s60, 3072
    buffer_load_dword v9, v2, s[8:11], s60 offen
    s_add_u32 s60, s60, 3072
    buffer_load_dword v10, v2, s[8:11], s60 offen
    s_add_u32 s60, s60, 3072
    buffer_load_dword v11, v2, s[8:11], s60 offen
    s_add_u32 s60, s60, 3072
    buffer_load_dword v12, v2, s[8:11], s60 offen
    s_add_u32 s60, s60, 3072
    buffer_load_dword v13, v2, s[8:11], s60 offen
    s_add_u32 s60, s60, 3072
    buffer_load_dword v14, v2, s[8:11], s60 offen
    s_add_u32 s60, s60, 3072
    buffer_load_dword v15, v2, s[8:11], s60 offen
    s_add_u32 s60, s60, 3072
    buffer_load_dword v16, v2, s[8:11], s60 offen
    s_add_u32 s60, s60, 3072
    buffer_load_dword v17, v2, s[8:11], s60 offen
    s_add_u32 s60, s60, 3072
    buffer_load_dword v18, v2, s[8:11], s60 offen
    s_add_u32 s60, s60, 3072
    buffer_load_dword v19, v2, s[8:11], s60 offen
    s_add_u32 s60, s60, 3072
    buffer_load_dword v20, v2, s[8:11], s60 offen
    s_add_u32 s60, s60, 3072
    buffer_load_dword v21, v2, s[8:11], s60 offen
    s_add_u32 s60, s60, 3072
    buffer_load_dword v22, v2, s[8:11], s60 offen
    s_add_u32 s60, s60, 3072
    buffer_load_dword v23, v2, s[8:11], s60 offen
    buffer_load_dword v24, v2, s[8:11], s61 offen
    s_add_u32 s61, s61, 3072
    buffer_load_dword v25, v2, s[8:11], s61 offen
    s_add_u32 s61, s61, 3072
    buffer_load_dword v26, v2, s[8:11], s61 offen
    s_add_u32 s61, s61, 3072
    buffer_load_dword v27, v2, s[8:11], s61 offen
    s_add_u32 s61, s61, 3072
    buffer_load_dword v28, v2, s[8:11], s61 offen
    s_add_u32 s61, s61, 3072
    buffer_load_dword v29, v2, s[8:11], s61 offen
    s_add_u32 s61, s61, 3072
    buffer_load_dword v30, v2, s[8:11], s61 offen
    s_add_u32 s61, s61, 3072
    buffer_load_dword v31, v2, s[8:11], s61 offen
    s_add_u32 s61, s61, 3072
    buffer_load_dword v32, v2, s[8:11], s61 offen
    s_add_u32 s61, s61, 3072
    buffer_load_dword v33, v2, s[8:11], s61 offen
    s_add_u32 s61, s61, 3072
    buffer_load_dword v34, v2, s[8:11], s61 offen
    s_add_u32 s61, s61, 3072
    buffer_load_dword v35, v2, s[8:11], s61 offen
    s_add_u32 s61, s61, 3072
    buffer_load_dword v36, v2, s[8:11], s61 offen
    s_add_u32 s61, s61, 3072
    buffer_load_dword v37, v2, s[8:11], s61 offen
    s_add_u32 s61, s61, 3072
    buffer_load_dword v38, v2, s[8:11], s61 offen
    s_add_u32 s61, s61, 3072
    buffer_load_dword v39, v2, s[8:11], s61 offen
    buffer_load_dword v40, v2, s[12:15], s62 offen
    s_add_u32 s62, s62, 3072
    buffer_load_dword v41, v2, s[12:15], s62 offen
    s_add_u32 s62, s62, 3072
    buffer_load_dword v42, v2, s[12:15], s62 offen
    s_add_u32 s62, s62, 3072
    buffer_load_dword v43, v2, s[12:15], s62 offen
    s_add_u32 s62, s62, 3072
    buffer_load_dword v44, v2, s[12:15], s62 offen
    s_add_u32 s62, s62, 3072
    buffer_load_dword v45, v2, s[12:15], s62 offen
    s_add_u32 s62, s62, 3072
    buffer_load_dword v46, v2, s[12:15], s62 offen
    s_add_u32 s62, s62, 3072
    buffer_load_dword v47, v2, s[12:15], s62 offen
    s_add_u32 s62, s62, 3072
    buffer_load_dword v48, v2, s[12:15], s62 offen
    s_add_u32 s62, s62, 3072
    buffer_load_dword v49, v2, s[12:15], s62 offen
    s_add_u32 s62, s62, 3072
    buffer_load_dword v50, v2, s[12:15], s62 offen
    s_add_u32 s62, s62, 3072
    buffer_load_dword v51, v2, s[12:15], s62 offen
    s_add_u32 s62, s62, 3072
    buffer_load_dword v52, v2, s[12:15], s62 offen
    s_add_u32 s62, s62, 3072
    buffer_load_dword v53, v2, s[12:15], s62 offen
    s_add_u32 s62, s62, 3072
    buffer_load_dword v54, v2, s[12:15], s62 offen
    s_add_u32 s62, s62, 3072
    buffer_load_dword v55, v2, s[12:15], s62 offen
    s_barrier
    s_barrier
    buffer_load_dword v56, v2, s[12:15], s63 offen
    s_add_u32 s63, s63, 3072
    buffer_load_dword v57, v2, s[12:15], s63 offen
    s_add_u32 s63, s63, 3072
    buffer_load_dword v58, v2, s[12:15], s63 offen
    s_add_u32 s63, s63, 3072
    buffer_load_dword v59, v2, s[12:15], s63 offen
    s_add_u32 s63, s63, 3072
    buffer_load_dword v60, v2, s[12:15], s63 offen
    s_add_u32 s63, s63, 3072
    buffer_load_dword v61, v2, s[12:15], s63 offen
    s_add_u32 s63, s63, 3072
    buffer_load_dword v62, v2, s[12:15], s63 offen
    s_add_u32 s63, s63, 3072
    buffer_load_dword v63, v2, s[12:15], s63 offen
    s_add_u32 s63, s63, 3072
    buffer_load_dword v64, v2, s[12:15], s63 offen
    s_add_u32 s63, s63, 3072
    buffer_load_dword v65, v2, s[12:15], s63 offen
    s_add_u32 s63, s63, 3072
    buffer_load_dword v66, v2, s[12:15], s63 offen
    s_add_u32 s63, s63, 3072
    buffer_load_dword v67, v2, s[12:15], s63 offen
    s_add_u32 s63, s63, 3072
    buffer_load_dword v68, v2, s[12:15], s63 offen
    s_add_u32 s63, s63, 3072
    buffer_load_dword v69, v2, s[12:15], s63 offen
    s_add_u32 s63, s63, 3072
    buffer_load_dword v70, v2, s[12:15], s63 offen
    s_add_u32 s63, s63, 3072
    buffer_load_dword v71, v2, s[12:15], s63 offen
    buffer_load_dword v72, v2, s[16:19], s64 offen
    s_add_u32 s64, s64, 1280
    buffer_load_dword v73, v2, s[16:19], s64 offen
    s_add_u32 s64, s64, 1280
    buffer_load_dword v74, v2, s[16:19], s64 offen
    s_add_u32 s64, s64, 1280
    buffer_load_dword v75, v2, s[16:19], s64 offen
    s_add_u32 s64, s64, 1280
    buffer_load_dword v76, v2, s[16:19], s64 offen
    s_add_u32 s64, s64, 1280
    buffer_load_dword v77, v2, s[16:19], s64 offen
    s_add_u32 s64, s64, 1280
    buffer_load_dword v78, v2, s[16:19], s64 offen
    s_add_u32 s64, s64, 1280
    buffer_load_dword v79, v2, s[16:19], s64 offen
    s_add_u32 s64, s64, 1280
    buffer_load_dword v80, v2, s[16:19], s64 offen
    s_add_u32 s64, s64, 1280
    buffer_load_dword v81, v2, s[16:19], s64 offen
    s_add_u32 s64, s64, 1280
    buffer_load_dword v82, v2, s[16:19], s64 offen
    s_add_u32 s64, s64, 1280
    buffer_load_dword v83, v2, s[16:19], s64 offen
    s_add_u32 s64, s64, 1280
    buffer_load_dword v84, v2, s[16:19], s64 offen
    s_add_u32 s64, s64, 1280
    buffer_load_dword v85, v2, s[16:19], s64 offen
    s_add_u32 s64, s64, 1280
    buffer_load_dword v86, v2, s[16:19], s64 offen
    s_add_u32 s64, s64, 1280
    buffer_load_dword v87, v2, s[16:19], s64 offen
    buffer_load_dword v88, v2, s[16:19], s65 offen
    s_add_u32 s65, s65, 1280
    buffer_load_dword v89, v2, s[16:19], s65 offen
    s_add_u32 s65, s65, 1280
    buffer_load_dword v90, v2, s[16:19], s65 offen
    s_add_u32 s65, s65, 1280
    buffer_load_dword v91, v2, s[16:19], s65 offen
    s_add_u32 s65, s65, 1280
    buffer_load_dword v92, v2, s[16:19], s65 offen
    s_add_u32 s65, s65, 1280
    buffer_load_dword v93, v2, s[16:19], s65 offen
    s_add_u32 s65, s65, 1280
    buffer_load_dword v94, v2, s[16:19], s65 offen
    s_add_u32 s65, s65, 1280
    buffer_load_dword v95, v2, s[16:19], s65 offen
    s_add_u32 s65, s65, 1280
    buffer_load_dword v96, v2, s[16:19], s65 offen
    s_add_u32 s65, s65, 1280
    buffer_load_dword v97, v2, s[16:19], s65 offen
    s_add_u32 s65, s65, 1280
    buffer_load_dword v98, v2, s[16:19], s65 offen
    s_add_u32 s65, s65, 1280
    buffer_load_dword v99, v2, s[16:19], s65 offen
    s_add_u32 s65, s65, 1280
    buffer_load_dword v100, v2, s[16:19], s65 offen
    s_add_u32 s65, s65, 1280
    buffer_load_dword v101, v2, s[16:19], s65 offen
    s_add_u32 s65, s65, 1280
    buffer_load_dword v102, v2, s[16:19], s65 offen
    s_add_u32 s65, s65, 1280
    buffer_load_dword v103, v2, s[16:19], s65 offen
    s_barrier
    s_barrier
    s_waitcnt vmcnt(0)
    v_perm_b32 v104, v9, v8, s30
    v_perm_b32 v112, v9, v8, s31
    v_perm_b32 v105, v11, v10, s30
    v_perm_b32 v113, v11, v10, s31
    v_perm_b32 v106, v13, v12, s30
    v_perm_b32 v114, v13, v12, s31
    v_perm_b32 v107, v15, v14, s30
    v_perm_b32 v115, v15, v14, s31
    v_perm_b32 v108, v17, v16, s30
    v_perm_b32 v116, v17, v16, s31
    v_perm_b32 v109, v19, v18, s30
    v_perm_b32 v117, v19, v18, s31
    v_perm_b32 v110, v21, v20, s30
    v_perm_b32 v118, v21, v20, s31
    v_perm_b32 v111, v23, v22, s30
    v_perm_b32 v119, v23, v22, s31
    buffer_store_dwordx4 v[104:107], v3, s[48:51], s32 offen offset:0
    buffer_store_dwordx4 v[108:111], v3, s[48:51], s32 offen offset:16
    buffer_store_dwordx4 v[112:115], v3, s[48:51], s32 offen offset:1280
    buffer_store_dwordx4 v[116:119], v3, s[48:51], s32 offen offset:1296
    s_nop 1
    v_perm_b32 v120, v25, v24, s30
    v_perm_b32 v128, v25, v24, s31
    v_perm_b32 v121, v27, v26, s30
    v_perm_b32 v129, v27, v26, s31
    v_perm_b32 v122, v29, v28, s30
    v_perm_b32 v130, v29, v28, s31
    v_perm_b32 v123, v31, v30, s30
    v_perm_b32 v131, v31, v30, s31
    v_perm_b32 v124, v33, v32, s30
    v_perm_b32 v132, v33, v32, s31
    v_perm_b32 v125, v35, v34, s30
    v_perm_b32 v133, v35, v34, s31
    v_perm_b32 v126, v37, v36, s30
    v_perm_b32 v134, v37, v36, s31
    v_perm_b32 v127, v39, v38, s30
    v_perm_b32 v135, v39, v38, s31
    buffer_store_dwordx4 v[120:123], v3, s[48:51], s33 offen offset:0
    buffer_store_dwordx4 v[124:127], v3, s[48:51], s33 offen offset:16
    buffer_store_dwordx4 v[128:131], v3, s[48:51], s33 offen offset:1280
    buffer_store_dwordx4 v[132:135], v3, s[48:51], s33 offen offset:1296
    s_nop 1
    s_barrier
    v_perm_b32 v104, v41, v40, s30
    v_perm_b32 v112, v41, v40, s31
    v_perm_b32 v105, v43, v42, s30
    v_perm_b32 v113, v43, v42, s31
    v_perm_b32 v106, v45, v44, s30
    v_perm_b32 v114, v45, v44, s31
    v_perm_b32 v107, v47, v46, s30
    v_perm_b32 v115, v47, v46, s31
    v_perm_b32 v108, v49, v48, s30
    v_perm_b32 v116, v49, v48, s31
    v_perm_b32 v109, v51, v50, s30
    v_perm_b32 v117, v51, v50, s31
    v_perm_b32 v110, v53, v52, s30
    v_perm_b32 v118, v53, v52, s31
    v_perm_b32 v111, v55, v54, s30
    v_perm_b32 v119, v55, v54, s31
    buffer_store_dwordx4 v[104:107], v4, s[52:55], s34 offen offset:0
    buffer_store_dwordx4 v[108:111], v4, s[52:55], s34 offen offset:16
    buffer_store_dwordx4 v[112:115], v4, s[52:55], s34 offen offset:1280
    buffer_store_dwordx4 v[116:119], v4, s[52:55], s34 offen offset:1296
    s_nop 1
    v_perm_b32 v120, v57, v56, s30
    v_perm_b32 v128, v57, v56, s31
    v_perm_b32 v121, v59, v58, s30
    v_perm_b32 v129, v59, v58, s31
    v_perm_b32 v122, v61, v60, s30
    v_perm_b32 v130, v61, v60, s31
    v_perm_b32 v123, v63, v62, s30
    v_perm_b32 v131, v63, v62, s31
    v_perm_b32 v124, v65, v64, s30
    v_perm_b32 v132, v65, v64, s31
    v_perm_b32 v125, v67, v66, s30
    v_perm_b32 v133, v67, v66, s31
    v_perm_b32 v126, v69, v68, s30
    v_perm_b32 v134, v69, v68, s31
    v_perm_b32 v127, v71, v70, s30
    v_perm_b32 v135, v71, v70, s31
    buffer_store_dwordx4 v[120:123], v4, s[52:55], s35 offen offset:0
    buffer_store_dwordx4 v[124:127], v4, s[52:55], s35 offen offset:16
    buffer_store_dwordx4 v[128:131], v4, s[52:55], s35 offen offset:1280
    buffer_store_dwordx4 v[132:135], v4, s[52:55], s35 offen offset:1296
    s_nop 1
    s_barrier
    v_perm_b32 v104, v73, v72, s30
    v_perm_b32 v112, v73, v72, s31
    v_perm_b32 v105, v75, v74, s30
    v_perm_b32 v113, v75, v74, s31
    v_perm_b32 v106, v77, v76, s30
    v_perm_b32 v114, v77, v76, s31
    v_perm_b32 v107, v79, v78, s30
    v_perm_b32 v115, v79, v78, s31
    v_perm_b32 v108, v81, v80, s30
    v_perm_b32 v116, v81, v80, s31
    v_perm_b32 v109, v83, v82, s30
    v_perm_b32 v117, v83, v82, s31
    v_perm_b32 v110, v85, v84, s30
    v_perm_b32 v118, v85, v84, s31
    v_perm_b32 v111, v87, v86, s30
    v_perm_b32 v119, v87, v86, s31
    buffer_store_dwordx4 v[104:107], v5, s[56:59], s36 offen offset:0
    buffer_store_dwordx4 v[108:111], v5, s[56:59], s36 offen offset:16
    buffer_store_dwordx4 v[112:115], v5, s[56:59], s36 offen offset:3072
    buffer_store_dwordx4 v[116:119], v5, s[56:59], s36 offen offset:3088
    s_nop 1
    v_perm_b32 v120, v89, v88, s30
    v_perm_b32 v128, v89, v88, s31
    v_perm_b32 v121, v91, v90, s30
    v_perm_b32 v129, v91, v90, s31
    v_perm_b32 v122, v93, v92, s30
    v_perm_b32 v130, v93, v92, s31
    v_perm_b32 v123, v95, v94, s30
    v_perm_b32 v131, v95, v94, s31
    v_perm_b32 v124, v97, v96, s30
    v_perm_b32 v132, v97, v96, s31
    v_perm_b32 v125, v99, v98, s30
    v_perm_b32 v133, v99, v98, s31
    v_perm_b32 v126, v101, v100, s30
    v_perm_b32 v134, v101, v100, s31
    v_perm_b32 v127, v103, v102, s30
    v_perm_b32 v135, v103, v102, s31
    buffer_store_dwordx4 v[120:123], v5, s[56:59], s37 offen offset:0
    buffer_store_dwordx4 v[124:127], v5, s[56:59], s37 offen offset:16
    buffer_store_dwordx4 v[128:131], v5, s[56:59], s37 offen offset:3072
    buffer_store_dwordx4 v[132:135], v5, s[56:59], s37 offen offset:3088
    s_nop 1
    s_endpgm
.globl wo_kernel
.p2align 8
.type wo_kernel,@function
wo_kernel:
    s_cmp_ge_u32 s2, 240
    s_cbranch_scc1 L_ffn1_entry
    s_load_dwordx2 s[4:5], s[0:1], 104
    s_load_dwordx2 s[6:7], s[0:1], 0
    s_load_dwordx2 s[28:29], s[0:1], 88
    s_and_b32 s38, s2, 7
    s_lshr_b32 s39, s2, 3
    s_mov_b32 s22, 0x2aaaaaab
    s_mul_hi_u32 s20, s39, s22
    s_mul_i32 s22, s20, 6
    s_sub_u32 s21, s39, s22
    s_mul_i32 s38, s38, 6
    s_add_u32 s39, s38, s21
    s_lshr_b32 s38, s39, 4
    s_and_b32 s21, s39, 15
    s_mul_i32 s22, s21, 128
    s_mul_i32 s23, s20, 128
    s_waitcnt lgkmcnt(0)
    s_add_u32 s8, s4, 0x7c00000
    s_addc_u32 s9, s5, 0
    s_and_b32 s9, s9, 0xffff
    s_mov_b32 s10, 0x1800000
    s_mov_b32 s11, 0x20000
    s_add_u32 s12, s4, 0x1a00000
    s_addc_u32 s13, s5, 0
    s_and_b32 s13, s13, 0xffff
    s_mov_b32 s14, 0x780000
    s_mov_b32 s15, 0x20000
    v_lshrrev_b32 v1, 3, v0
    v_and_b32 v10, 7, v0
    v_and_b32 v11, 7, v1
    v_xor_b32 v10, v10, v11
    v_lshlrev_b32 v10, 4, v10
    s_mov_b32 s24, 12288
    s_mov_b32 s25, 12288
    v_add_u32 v2, s22, v1
    v_mul_lo_u32 v2, v2, s24
    v_add_u32 v2, v2, v10
    v_add_u32 v3, s22, v1
    v_add_u32 v3, 32, v3
    v_mul_lo_u32 v3, v3, s24
    v_add_u32 v3, v3, v10
    v_add_u32 v4, s22, v1
    v_add_u32 v4, 64, v4
    v_mul_lo_u32 v4, v4, s24
    v_add_u32 v4, v4, v10
    v_add_u32 v5, s22, v1
    v_add_u32 v5, 96, v5
    v_mul_lo_u32 v5, v5, s24
    v_add_u32 v5, v5, v10
    v_add_u32 v6, s23, v1
    v_mul_lo_u32 v6, v6, s25
    v_add_u32 v6, v6, v10
    v_add_u32 v7, s23, v1
    v_add_u32 v7, 32, v7
    v_mul_lo_u32 v7, v7, s25
    v_add_u32 v7, v7, v10
    v_add_u32 v8, s23, v1
    v_add_u32 v8, 64, v8
    v_mul_lo_u32 v8, v8, s25
    v_add_u32 v8, v8, v10
    v_add_u32 v9, s23, v1
    v_add_u32 v9, 96, v9
    v_mul_lo_u32 v9, v9, s25
    v_add_u32 v9, v9, v10
    v_mul_u32_u24 v1, 144, v1
    v_add_u32 v10, v10, v1
    v_lshrrev_b32 v1, 6, v0
    v_and_b32 v11, 1, v1
    v_lshrrev_b32 v12, 1, v1
    v_mul_u32_u24 v11, 64, v11
    v_mul_u32_u24 v12, 64, v12
    v_and_b32 v1, 31, v0
    v_add_u32 v11, v11, v1
    v_add_u32 v12, v12, v1
    v_mul_u32_u24 v11, 144, v11
    v_mul_u32_u24 v12, 144, v12
    v_bfe_u32 v1, v0, 5, 1
    v_lshlrev_b32 v1, 4, v1
    v_add_u32 v11, v11, v1
    v_add_u32 v12, v12, v1
    v_add_u32 v12, 18432, v12
    v_add_u32 v13, 36864, v10
    v_add_u32 v14, 36864, v11
    v_add_u32 v15, 36864, v12
    v_lshrrev_b32 v1, 6, v0
    s_nop 0
    v_readfirstlane_b32 s30, v1
    s_lshl_b32 s30, s30, 10
    v_and_b32 v16, 1, v1
    v_lshrrev_b32 v20, 1, v1
    v_mul_u32_u24 v16, 64, v16
    v_mul_u32_u24 v20, 64, v20
    v_and_b32 v1, 31, v0
    v_add_u32 v16, v16, v1
    v_add_u32 v20, v20, v1
    v_lshlrev_b32 v16, 7, v16
    v_lshlrev_b32 v20, 7, v20
    v_bfe_u32 v10, v0, 5, 1
    v_and_b32 v1, 7, v0
    v_xor_b32 v1, v1, v10
    v_lshlrev_b32 v1, 4, v1
    v_add_u32 v16, v16, v1
    v_add_u32 v20, v20, v1
    v_xor_b32 v17, 32, v16
    v_xor_b32 v21, 32, v20
    v_xor_b32 v18, 64, v16
    v_xor_b32 v22, 64, v20
    v_xor_b32 v19, 96, v16
    v_xor_b32 v23, 96, v20
    v_add_u32 v20, 65536, v20
    v_add_u32 v21, 65536, v21
    v_add_u32 v22, 65536, v22
    v_add_u32 v23, 65536, v23
    v_mov_b32 v56, 0
    v_mov_b32 v57, 0
    v_mov_b32 v58, 0
    v_mov_b32 v59, 0
    v_mov_b32 v60, 0
    v_mov_b32 v61, 0
    v_mov_b32 v62, 0
    v_mov_b32 v63, 0
    v_mov_b32 v64, 0
    v_mov_b32 v65, 0
    v_mov_b32 v66, 0
    v_mov_b32 v67, 0
    v_mov_b32 v68, 0
    v_mov_b32 v69, 0
    v_mov_b32 v70, 0
    v_mov_b32 v71, 0
    v_mov_b32 v72, 0
    v_mov_b32 v73, 0
    v_mov_b32 v74, 0
    v_mov_b32 v75, 0
    v_mov_b32 v76, 0
    v_mov_b32 v77, 0
    v_mov_b32 v78, 0
    v_mov_b32 v79, 0
    v_mov_b32 v80, 0
    v_mov_b32 v81, 0
    v_mov_b32 v82, 0
    v_mov_b32 v83, 0
    v_mov_b32 v84, 0
    v_mov_b32 v85, 0
    v_mov_b32 v86, 0
    v_mov_b32 v87, 0
    v_mov_b32 v88, 0
    v_mov_b32 v89, 0
    v_mov_b32 v90, 0
    v_mov_b32 v91, 0
    v_mov_b32 v92, 0
    v_mov_b32 v93, 0
    v_mov_b32 v94, 0
    v_mov_b32 v95, 0
    v_mov_b32 v96, 0
    v_mov_b32 v97, 0
    v_mov_b32 v98, 0
    v_mov_b32 v99, 0
    v_mov_b32 v100, 0
    v_mov_b32 v101, 0
    v_mov_b32 v102, 0
    v_mov_b32 v103, 0
    v_mov_b32 v104, 0
    v_mov_b32 v105, 0
    v_mov_b32 v106, 0
    v_mov_b32 v107, 0
    v_mov_b32 v108, 0
    v_mov_b32 v109, 0
    v_mov_b32 v110, 0
    v_mov_b32 v111, 0
    v_mov_b32 v112, 0
    v_mov_b32 v113, 0
    v_mov_b32 v114, 0
    v_mov_b32 v115, 0
    v_mov_b32 v116, 0
    v_mov_b32 v117, 0
    v_mov_b32 v118, 0
    v_mov_b32 v119, 0
    s_mul_i32 s26, s38, 4096
    s_add_u32 m0, s30, 0
    s_nop 0
    buffer_load_dwordx4 v2, s[8:11], s26 offen lds
    s_add_u32 m0, s30, 4096
    s_nop 0
    buffer_load_dwordx4 v3, s[8:11], s26 offen lds
    s_add_u32 m0, s30, 8192
    s_nop 0
    buffer_load_dwordx4 v4, s[8:11], s26 offen lds
    s_add_u32 m0, s30, 12288
    s_nop 0
    buffer_load_dwordx4 v5, s[8:11], s26 offen lds
    s_add_u32 m0, s30, 65536
    s_nop 0
    buffer_load_dwordx4 v6, s[12:15], s26 offen lds
    s_add_u32 m0, s30, 69632
    s_nop 0
    buffer_load_dwordx4 v7, s[12:15], s26 offen lds
    s_add_u32 m0, s30, 73728
    s_nop 0
    buffer_load_dwordx4 v8, s[12:15], s26 offen lds
    s_add_u32 m0, s30, 77824
    s_nop 0
    buffer_load_dwordx4 v9, s[12:15], s26 offen lds
    s_add_u32 s26, s26, 128
    s_add_u32 m0, s30, 16384
    s_nop 0
    buffer_load_dwordx4 v2, s[8:11], s26 offen lds
    s_add_u32 m0, s30, 20480
    s_nop 0
    buffer_load_dwordx4 v3, s[8:11], s26 offen lds
    s_add_u32 m0, s30, 24576
    s_nop 0
    buffer_load_dwordx4 v4, s[8:11], s26 offen lds
    s_add_u32 m0, s30, 28672
    s_nop 0
    buffer_load_dwordx4 v5, s[8:11], s26 offen lds
    s_add_u32 m0, s30, 81920
    s_nop 0
    buffer_load_dwordx4 v6, s[12:15], s26 offen lds
    s_add_u32 m0, s30, 86016
    s_nop 0
    buffer_load_dwordx4 v7, s[12:15], s26 offen lds
    s_add_u32 m0, s30, 90112
    s_nop 0
    buffer_load_dwordx4 v8, s[12:15], s26 offen lds
    s_add_u32 m0, s30, 94208
    s_nop 0
    buffer_load_dwordx4 v9, s[12:15], s26 offen lds
    s_add_u32 s26, s26, 128
    s_add_u32 m0, s30, 32768
    s_nop 0
    buffer_load_dwordx4 v2, s[8:11], s26 offen lds
    s_add_u32 m0, s30, 36864
    s_nop 0
    buffer_load_dwordx4 v3, s[8:11], s26 offen lds
    s_add_u32 m0, s30, 40960
    s_nop 0
    buffer_load_dwordx4 v4, s[8:11], s26 offen lds
    s_add_u32 m0, s30, 45056
    s_nop 0
    buffer_load_dwordx4 v5, s[8:11], s26 offen lds
    s_add_u32 m0, s30, 98304
    s_nop 0
    buffer_load_dwordx4 v6, s[12:15], s26 offen lds
    s_add_u32 m0, s30, 102400
    s_nop 0
    buffer_load_dwordx4 v7, s[12:15], s26 offen lds
    s_add_u32 m0, s30, 106496
    s_nop 0
    buffer_load_dwordx4 v8, s[12:15], s26 offen lds
    s_add_u32 m0, s30, 110592
    s_nop 0
    buffer_load_dwordx4 v9, s[12:15], s26 offen lds
    s_add_u32 s26, s26, 128
    s_waitcnt vmcnt(16)
    s_barrier
    ds_read_b128 v[24:27], v16 offset:0
    ds_read_b128 v[28:31], v16 offset:4096
    ds_read_b128 v[32:35], v20 offset:0
    ds_read_b128 v[36:39], v20 offset:4096
    s_mov_b32 s27, 0
L_wo_kernel_loopm:
    ds_read_b128 v[40:43], v17 offset:0
    ds_read_b128 v[44:47], v17 offset:4096
    ds_read_b128 v[48:51], v21 offset:0
    ds_read_b128 v[52:55], v21 offset:4096
    s_waitcnt lgkmcnt(4)
    v_mfma_f32_32x32x16_bf16 v[56:71], v[32:35], v[24:27], v[56:71]
    v_mfma_f32_32x32x16_bf16 v[72:87], v[32:35], v[28:31], v[72:87]
    v_mfma_f32_32x32x16_bf16 v[88:103], v[36:39], v[24:27], v[88:103]
    v_mfma_f32_32x32x16_bf16 v[104:119], v[36:39], v[28:31], v[104:119]
    ds_read_b128 v[24:27], v18 offset:0
    ds_read_b128 v[28:31], v18 offset:4096
    ds_read_b128 v[32:35], v22 offset:0
    ds_read_b128 v[36:39], v22 offset:4096
    s_waitcnt lgkmcnt(4)
    v_mfma_f32_32x32x16_bf16 v[56:71], v[48:51], v[40:43], v[56:71]
    v_mfma_f32_32x32x16_bf16 v[72:87], v[48:51], v[44:47], v[72:87]
    v_mfma_f32_32x32x16_bf16 v[88:103], v[52:55], v[40:43], v[88:103]
    v_mfma_f32_32x32x16_bf16 v[104:119], v[52:55], v[44:47], v[104:119]
    ds_read_b128 v[40:43], v19 offset:0
    ds_read_b128 v[44:47], v19 offset:4096
    ds_read_b128 v[48:51], v23 offset:0
    ds_read_b128 v[52:55], v23 offset:4096
    s_waitcnt lgkmcnt(4)
    v_mfma_f32_32x32x16_bf16 v[56:71], v[32:35], v[24:27], v[56:71]
    v_mfma_f32_32x32x16_bf16 v[72:87], v[32:35], v[28:31], v[72:87]
    v_mfma_f32_32x32x16_bf16 v[88:103], v[36:39], v[24:27], v[88:103]
    v_mfma_f32_32x32x16_bf16 v[104:119], v[36:39], v[28:31], v[104:119]
    s_waitcnt vmcnt(8)
    s_barrier
    ds_read_b128 v[24:27], v16 offset:16384
    ds_read_b128 v[28:31], v16 offset:20480
    ds_read_b128 v[32:35], v20 offset:16384
    ds_read_b128 v[36:39], v20 offset:20480
    s_add_u32 m0, s30, 49152
    s_nop 0
    buffer_load_dwordx4 v2, s[8:11], s26 offen lds
    s_add_u32 m0, s30, 53248
    s_nop 0
    buffer_load_dwordx4 v3, s[8:11], s26 offen lds
    s_add_u32 m0, s30, 57344
    s_nop 0
    buffer_load_dwordx4 v4, s[8:11], s26 offen lds
    s_add_u32 m0, s30, 61440
    s_nop 0
    buffer_load_dwordx4 v5, s[8:11], s26 offen lds
    s_add_u32 m0, s30, 114688
    s_nop 0
    buffer_load_dwordx4 v6, s[12:15], s26 offen lds
    s_add_u32 m0, s30, 118784
    s_nop 0
    buffer_load_dwordx4 v7, s[12:15], s26 offen lds
    s_add_u32 m0, s30, 122880
    s_nop 0
    buffer_load_dwordx4 v8, s[12:15], s26 offen lds
    s_add_u32 m0, s30, 126976
    s_nop 0
    buffer_load_dwordx4 v9, s[12:15], s26 offen lds
    s_add_u32 s26, s26, 128
    s_waitcnt lgkmcnt(4)
    v_mfma_f32_32x32x16_bf16 v[56:71], v[48:51], v[40:43], v[56:71]
    v_mfma_f32_32x32x16_bf16 v[72:87], v[48:51], v[44:47], v[72:87]
    v_mfma_f32_32x32x16_bf16 v[88:103], v[52:55], v[40:43], v[88:103]
    v_mfma_f32_32x32x16_bf16 v[104:119], v[52:55], v[44:47], v[104:119]
    ds_read_b128 v[40:43], v17 offset:16384
    ds_read_b128 v[44:47], v17 offset:20480
    ds_read_b128 v[48:51], v21 offset:16384
    ds_read_b128 v[52:55], v21 offset:20480
    s_waitcnt lgkmcnt(4)
    v_mfma_f32_32x32x16_bf16 v[56:71], v[32:35], v[24:27], v[56:71]
    v_mfma_f32_32x32x16_bf16 v[72:87], v[32:35], v[28:31], v[72:87]
    v_mfma_f32_32x32x16_bf16 v[88:103], v[36:39], v[24:27], v[88:103]
    v_mfma_f32_32x32x16_bf16 v[104:119], v[36:39], v[28:31], v[104:119]
    ds_read_b128 v[24:27], v18 offset:16384
    ds_read_b128 v[28:31], v18 offset:20480
    ds_read_b128 v[32:35], v22 offset:16384
    ds_read_b128 v[36:39], v22 offset:20480
    s_waitcnt lgkmcnt(4)
    v_mfma_f32_32x32x16_bf16 v[56:71], v[48:51], v[40:43], v[56:71]
    v_mfma_f32_32x32x16_bf16 v[72:87], v[48:51], v[44:47], v[72:87]
    v_mfma_f32_32x32x16_bf16 v[88:103], v[52:55], v[40:43], v[88:103]
    v_mfma_f32_32x32x16_bf16 v[104:119], v[52:55], v[44:47], v[104:119]
    ds_read_b128 v[40:43], v19 offset:16384
    ds_read_b128 v[44:47], v19 offset:20480
    ds_read_b128 v[48:51], v23 offset:16384
    ds_read_b128 v[52:55], v23 offset:20480
    s_waitcnt lgkmcnt(4)
    v_mfma_f32_32x32x16_bf16 v[56:71], v[32:35], v[24:27], v[56:71]
    v_mfma_f32_32x32x16_bf16 v[72:87], v[32:35], v[28:31], v[72:87]
    v_mfma_f32_32x32x16_bf16 v[88:103], v[36:39], v[24:27], v[88:103]
    v_mfma_f32_32x32x16_bf16 v[104:119], v[36:39], v[28:31], v[104:119]
    s_waitcnt vmcnt(8)
    s_barrier
    ds_read_b128 v[24:27], v16 offset:32768
    ds_read_b128 v[28:31], v16 offset:36864
    ds_read_b128 v[32:35], v20 offset:32768
    ds_read_b128 v[36:39], v20 offset:36864
    s_add_u32 m0, s30, 0
    s_nop 0
    buffer_load_dwordx4 v2, s[8:11], s26 offen lds
    s_add_u32 m0, s30, 4096
    s_nop 0
    buffer_load_dwordx4 v3, s[8:11], s26 offen lds
    s_add_u32 m0, s30, 8192
    s_nop 0
    buffer_load_dwordx4 v4, s[8:11], s26 offen lds
    s_add_u32 m0, s30, 12288
    s_nop 0
    buffer_load_dwordx4 v5, s[8:11], s26 offen lds
    s_add_u32 m0, s30, 65536
    s_nop 0
    buffer_load_dwordx4 v6, s[12:15], s26 offen lds
    s_add_u32 m0, s30, 69632
    s_nop 0
    buffer_load_dwordx4 v7, s[12:15], s26 offen lds
    s_add_u32 m0, s30, 73728
    s_nop 0
    buffer_load_dwordx4 v8, s[12:15], s26 offen lds
    s_add_u32 m0, s30, 77824
    s_nop 0
    buffer_load_dwordx4 v9, s[12:15], s26 offen lds
    s_add_u32 s26, s26, 128
    s_waitcnt lgkmcnt(4)
    v_mfma_f32_32x32x16_bf16 v[56:71], v[48:51], v[40:43], v[56:71]
    v_mfma_f32_32x32x16_bf16 v[72:87], v[48:51], v[44:47], v[72:87]
    v_mfma_f32_32x32x16_bf16 v[88:103], v[52:55], v[40:43], v[88:103]
    v_mfma_f32_32x32x16_bf16 v[104:119], v[52:55], v[44:47], v[104:119]
    ds_read_b128 v[40:43], v17 offset:32768
    ds_read_b128 v[44:47], v17 offset:36864
    ds_read_b128 v[48:51], v21 offset:32768
    ds_read_b128 v[52:55], v21 offset:36864
    s_waitcnt lgkmcnt(4)
    v_mfma_f32_32x32x16_bf16 v[56:71], v[32:35], v[24:27], v[56:71]
    v_mfma_f32_32x32x16_bf16 v[72:87], v[32:35], v[28:31], v[72:87]
    v_mfma_f32_32x32x16_bf16 v[88:103], v[36:39], v[24:27], v[88:103]
    v_mfma_f32_32x32x16_bf16 v[104:119], v[36:39], v[28:31], v[104:119]
    ds_read_b128 v[24:27], v18 offset:32768
    ds_read_b128 v[28:31], v18 offset:36864
    ds_read_b128 v[32:35], v22 offset:32768
    ds_read_b128 v[36:39], v22 offset:36864
    s_waitcnt lgkmcnt(4)
    v_mfma_f32_32x32x16_bf16 v[56:71], v[48:51], v[40:43], v[56:71]
    v_mfma_f32_32x32x16_bf16 v[72:87], v[48:51], v[44:47], v[72:87]
    v_mfma_f32_32x32x16_bf16 v[88:103], v[52:55], v[40:43], v[88:103]
    v_mfma_f32_32x32x16_bf16 v[104:119], v[52:55], v[44:47], v[104:119]
    ds_read_b128 v[40:43], v19 offset:32768
    ds_read_b128 v[44:47], v19 offset:36864
    ds_read_b128 v[48:51], v23 offset:32768
    ds_read_b128 v[52:55], v23 offset:36864
    s_waitcnt lgkmcnt(4)
    v_mfma_f32_32x32x16_bf16 v[56:71], v[32:35], v[24:27], v[56:71]
    v_mfma_f32_32x32x16_bf16 v[72:87], v[32:35], v[28:31], v[72:87]
    v_mfma_f32_32x32x16_bf16 v[88:103], v[36:39], v[24:27], v[88:103]
    v_mfma_f32_32x32x16_bf16 v[104:119], v[36:39], v[28:31], v[104:119]
    s_waitcnt vmcnt(8)
    s_barrier
    ds_read_b128 v[24:27], v16 offset:49152
    ds_read_b128 v[28:31], v16 offset:53248
    ds_read_b128 v[32:35], v20 offset:49152
    ds_read_b128 v[36:39], v20 offset:53248
    s_add_u32 m0, s30, 16384
    s_nop 0
    buffer_load_dwordx4 v2, s[8:11], s26 offen lds
    s_add_u32 m0, s30, 20480
    s_nop 0
    buffer_load_dwordx4 v3, s[8:11], s26 offen lds
    s_add_u32 m0, s30, 24576
    s_nop 0
    buffer_load_dwordx4 v4, s[8:11], s26 offen lds
    s_add_u32 m0, s30, 28672
    s_nop 0
    buffer_load_dwordx4 v5, s[8:11], s26 offen lds
    s_add_u32 m0, s30, 81920
    s_nop 0
    buffer_load_dwordx4 v6, s[12:15], s26 offen lds
    s_add_u32 m0, s30, 86016
    s_nop 0
    buffer_load_dwordx4 v7, s[12:15], s26 offen lds
    s_add_u32 m0, s30, 90112
    s_nop 0
    buffer_load_dwordx4 v8, s[12:15], s26 offen lds
    s_add_u32 m0, s30, 94208
    s_nop 0
    buffer_load_dwordx4 v9, s[12:15], s26 offen lds
    s_add_u32 s26, s26, 128
    s_waitcnt lgkmcnt(4)
    v_mfma_f32_32x32x16_bf16 v[56:71], v[48:51], v[40:43], v[56:71]
    v_mfma_f32_32x32x16_bf16 v[72:87], v[48:51], v[44:47], v[72:87]
    v_mfma_f32_32x32x16_bf16 v[88:103], v[52:55], v[40:43], v[88:103]
    v_mfma_f32_32x32x16_bf16 v[104:119], v[52:55], v[44:47], v[104:119]
    ds_read_b128 v[40:43], v17 offset:49152
    ds_read_b128 v[44:47], v17 offset:53248
    ds_read_b128 v[48:51], v21 offset:49152
    ds_read_b128 v[52:55], v21 offset:53248
    s_waitcnt lgkmcnt(4)
    v_mfma_f32_32x32x16_bf16 v[56:71], v[32:35], v[24:27], v[56:71]
    v_mfma_f32_32x32x16_bf16 v[72:87], v[32:35], v[28:31], v[72:87]
    v_mfma_f32_32x32x16_bf16 v[88:103], v[36:39], v[24:27], v[88:103]
    v_mfma_f32_32x32x16_bf16 v[104:119], v[36:39], v[28:31], v[104:119]
    ds_read_b128 v[24:27], v18 offset:49152
    ds_read_b128 v[28:31], v18 offset:53248
    ds_read_b128 v[32:35], v22 offset:49152
    ds_read_b128 v[36:39], v22 offset:53248
    s_waitcnt lgkmcnt(4)
    v_mfma_f32_32x32x16_bf16 v[56:71], v[48:51], v[40:43], v[56:71]
    v_mfma_f32_32x32x16_bf16 v[72:87], v[48:51], v[44:47], v[72:87]
    v_mfma_f32_32x32x16_bf16 v[88:103], v[52:55], v[40:43], v[88:103]
    v_mfma_f32_32x32x16_bf16 v[104:119], v[52:55], v[44:47], v[104:119]
    ds_read_b128 v[40:43], v19 offset:49152
    ds_read_b128 v[44:47], v19 offset:53248
    ds_read_b128 v[48:51], v23 offset:49152
    ds_read_b128 v[52:55], v23 offset:53248
    s_waitcnt lgkmcnt(4)
    v_mfma_f32_32x32x16_bf16 v[56:71], v[32:35], v[24:27], v[56:71]
    v_mfma_f32_32x32x16_bf16 v[72:87], v[32:35], v[28:31], v[72:87]
    v_mfma_f32_32x32x16_bf16 v[88:103], v[36:39], v[24:27], v[88:103]
    v_mfma_f32_32x32x16_bf16 v[104:119], v[36:39], v[28:31], v[104:119]
    s_waitcnt vmcnt(8)
    s_barrier
    ds_read_b128 v[24:27], v16 offset:0
    ds_read_b128 v[28:31], v16 offset:4096
    ds_read_b128 v[32:35], v20 offset:0
    ds_read_b128 v[36:39], v20 offset:4096
    s_add_u32 m0, s30, 32768
    s_nop 0
    buffer_load_dwordx4 v2, s[8:11], s26 offen lds
    s_add_u32 m0, s30, 36864
    s_nop 0
    buffer_load_dwordx4 v3, s[8:11], s26 offen lds
    s_add_u32 m0, s30, 40960
    s_nop 0
    buffer_load_dwordx4 v4, s[8:11], s26 offen lds
    s_add_u32 m0, s30, 45056
    s_nop 0
    buffer_load_dwordx4 v5, s[8:11], s26 offen lds
    s_add_u32 m0, s30, 98304
    s_nop 0
    buffer_load_dwordx4 v6, s[12:15], s26 offen lds
    s_add_u32 m0, s30, 102400
    s_nop 0
    buffer_load_dwordx4 v7, s[12:15], s26 offen lds
    s_add_u32 m0, s30, 106496
    s_nop 0
    buffer_load_dwordx4 v8, s[12:15], s26 offen lds
    s_add_u32 m0, s30, 110592
    s_nop 0
    buffer_load_dwordx4 v9, s[12:15], s26 offen lds
    s_add_u32 s26, s26, 128
    s_waitcnt lgkmcnt(4)
    v_mfma_f32_32x32x16_bf16 v[56:71], v[48:51], v[40:43], v[56:71]
    v_mfma_f32_32x32x16_bf16 v[72:87], v[48:51], v[44:47], v[72:87]
    v_mfma_f32_32x32x16_bf16 v[88:103], v[52:55], v[40:43], v[88:103]
    v_mfma_f32_32x32x16_bf16 v[104:119], v[52:55], v[44:47], v[104:119]
    s_add_u32 s27, s27, 1
    s_cmp_lt_u32 s27, 7
    s_cbranch_scc1 L_wo_kernel_loopm
    ds_read_b128 v[40:43], v17 offset:0
    ds_read_b128 v[44:47], v17 offset:4096
    ds_read_b128 v[48:51], v21 offset:0
    ds_read_b128 v[52:55], v21 offset:4096
    s_waitcnt lgkmcnt(4)
    v_mfma_f32_32x32x16_bf16 v[56:71], v[32:35], v[24:27], v[56:71]
    v_mfma_f32_32x32x16_bf16 v[72:87], v[32:35], v[28:31], v[72:87]
    v_mfma_f32_32x32x16_bf16 v[88:103], v[36:39], v[24:27], v[88:103]
    v_mfma_f32_32x32x16_bf16 v[104:119], v[36:39], v[28:31], v[104:119]
    ds_read_b128 v[24:27], v18 offset:0
    ds_read_b128 v[28:31], v18 offset:4096
    ds_read_b128 v[32:35], v22 offset:0
    ds_read_b128 v[36:39], v22 offset:4096
    s_waitcnt lgkmcnt(4)
    v_mfma_f32_32x32x16_bf16 v[56:71], v[48:51], v[40:43], v[56:71]
    v_mfma_f32_32x32x16_bf16 v[72:87], v[48:51], v[44:47], v[72:87]
    v_mfma_f32_32x32x16_bf16 v[88:103], v[52:55], v[40:43], v[88:103]
    v_mfma_f32_32x32x16_bf16 v[104:119], v[52:55], v[44:47], v[104:119]
    ds_read_b128 v[40:43], v19 offset:0
    ds_read_b128 v[44:47], v19 offset:4096
    ds_read_b128 v[48:51], v23 offset:0
    ds_read_b128 v[52:55], v23 offset:4096
    s_waitcnt lgkmcnt(4)
    v_mfma_f32_32x32x16_bf16 v[56:71], v[32:35], v[24:27], v[56:71]
    v_mfma_f32_32x32x16_bf16 v[72:87], v[32:35], v[28:31], v[72:87]
    v_mfma_f32_32x32x16_bf16 v[88:103], v[36:39], v[24:27], v[88:103]
    v_mfma_f32_32x32x16_bf16 v[104:119], v[36:39], v[28:31], v[104:119]
    s_waitcnt vmcnt(8)
    s_barrier
    ds_read_b128 v[24:27], v16 offset:16384
    ds_read_b128 v[28:31], v16 offset:20480
    ds_read_b128 v[32:35], v20 offset:16384
    ds_read_b128 v[36:39], v20 offset:20480
    s_add_u32 m0, s30, 49152
    s_nop 0
    buffer_load_dwordx4 v2, s[8:11], s26 offen lds
    s_add_u32 m0, s30, 53248
    s_nop 0
    buffer_load_dwordx4 v3, s[8:11], s26 offen lds
    s_add_u32 m0, s30, 57344
    s_nop 0
    buffer_load_dwordx4 v4, s[8:11], s26 offen lds
    s_add_u32 m0, s30, 61440
    s_nop 0
    buffer_load_dwordx4 v5, s[8:11], s26 offen lds
    s_add_u32 m0, s30, 114688
    s_nop 0
    buffer_load_dwordx4 v6, s[12:15], s26 offen lds
    s_add_u32 m0, s30, 118784
    s_nop 0
    buffer_load_dwordx4 v7, s[12:15], s26 offen lds
    s_add_u32 m0, s30, 122880
    s_nop 0
    buffer_load_dwordx4 v8, s[12:15], s26 offen lds
    s_add_u32 m0, s30, 126976
    s_nop 0
    buffer_load_dwordx4 v9, s[12:15], s26 offen lds
    s_add_u32 s26, s26, 128
    s_waitcnt lgkmcnt(4)
    v_mfma_f32_32x32x16_bf16 v[56:71], v[48:51], v[40:43], v[56:71]
    v_mfma_f32_32x32x16_bf16 v[72:87], v[48:51], v[44:47], v[72:87]
    v_mfma_f32_32x32x16_bf16 v[88:103], v[52:55], v[40:43], v[88:103]
    v_mfma_f32_32x32x16_bf16 v[104:119], v[52:55], v[44:47], v[104:119]
    ds_read_b128 v[40:43], v17 offset:16384
    ds_read_b128 v[44:47], v17 offset:20480
    ds_read_b128 v[48:51], v21 offset:16384
    ds_read_b128 v[52:55], v21 offset:20480
    s_waitcnt lgkmcnt(4)
    v_mfma_f32_32x32x16_bf16 v[56:71], v[32:35], v[24:27], v[56:71]
    v_mfma_f32_32x32x16_bf16 v[72:87], v[32:35], v[28:31], v[72:87]
    v_mfma_f32_32x32x16_bf16 v[88:103], v[36:39], v[24:27], v[88:103]
    v_mfma_f32_32x32x16_bf16 v[104:119], v[36:39], v[28:31], v[104:119]
    ds_read_b128 v[24:27], v18 offset:16384
    ds_read_b128 v[28:31], v18 offset:20480
    ds_read_b128 v[32:35], v22 offset:16384
    ds_read_b128 v[36:39], v22 offset:20480
    s_waitcnt lgkmcnt(4)
    v_mfma_f32_32x32x16_bf16 v[56:71], v[48:51], v[40:43], v[56:71]
    v_mfma_f32_32x32x16_bf16 v[72:87], v[48:51], v[44:47], v[72:87]
    v_mfma_f32_32x32x16_bf16 v[88:103], v[52:55], v[40:43], v[88:103]
    v_mfma_f32_32x32x16_bf16 v[104:119], v[52:55], v[44:47], v[104:119]
    ds_read_b128 v[40:43], v19 offset:16384
    ds_read_b128 v[44:47], v19 offset:20480
    ds_read_b128 v[48:51], v23 offset:16384
    ds_read_b128 v[52:55], v23 offset:20480
    s_waitcnt lgkmcnt(4)
    v_mfma_f32_32x32x16_bf16 v[56:71], v[32:35], v[24:27], v[56:71]
    v_mfma_f32_32x32x16_bf16 v[72:87], v[32:35], v[28:31], v[72:87]
    v_mfma_f32_32x32x16_bf16 v[88:103], v[36:39], v[24:27], v[88:103]
    v_mfma_f32_32x32x16_bf16 v[104:119], v[36:39], v[28:31], v[104:119]
    s_waitcnt vmcnt(8)
    s_barrier
    ds_read_b128 v[24:27], v16 offset:32768
    ds_read_b128 v[28:31], v16 offset:36864
    ds_read_b128 v[32:35], v20 offset:32768
    ds_read_b128 v[36:39], v20 offset:36864
    s_waitcnt lgkmcnt(4)
    v_mfma_f32_32x32x16_bf16 v[56:71], v[48:51], v[40:43], v[56:71]
    v_mfma_f32_32x32x16_bf16 v[72:87], v[48:51], v[44:47], v[72:87]
    v_mfma_f32_32x32x16_bf16 v[88:103], v[52:55], v[40:43], v[88:103]
    v_mfma_f32_32x32x16_bf16 v[104:119], v[52:55], v[44:47], v[104:119]
    ds_read_b128 v[40:43], v17 offset:32768
    ds_read_b128 v[44:47], v17 offset:36864
    ds_read_b128 v[48:51], v21 offset:32768
    ds_read_b128 v[52:55], v21 offset:36864
    s_waitcnt lgkmcnt(4)
    v_mfma_f32_32x32x16_bf16 v[56:71], v[32:35], v[24:27], v[56:71]
    v_mfma_f32_32x32x16_bf16 v[72:87], v[32:35], v[28:31], v[72:87]
    v_mfma_f32_32x32x16_bf16 v[88:103], v[36:39], v[24:27], v[88:103]
    v_mfma_f32_32x32x16_bf16 v[104:119], v[36:39], v[28:31], v[104:119]
    ds_read_b128 v[24:27], v18 offset:32768
    ds_read_b128 v[28:31], v18 offset:36864
    ds_read_b128 v[32:35], v22 offset:32768
    ds_read_b128 v[36:39], v22 offset:36864
    s_waitcnt lgkmcnt(4)
    v_mfma_f32_32x32x16_bf16 v[56:71], v[48:51], v[40:43], v[56:71]
    v_mfma_f32_32x32x16_bf16 v[72:87], v[48:51], v[44:47], v[72:87]
    v_mfma_f32_32x32x16_bf16 v[88:103], v[52:55], v[40:43], v[88:103]
    v_mfma_f32_32x32x16_bf16 v[104:119], v[52:55], v[44:47], v[104:119]
    ds_read_b128 v[40:43], v19 offset:32768
    ds_read_b128 v[44:47], v19 offset:36864
    ds_read_b128 v[48:51], v23 offset:32768
    ds_read_b128 v[52:55], v23 offset:36864
    s_waitcnt lgkmcnt(4)
    v_mfma_f32_32x32x16_bf16 v[56:71], v[32:35], v[24:27], v[56:71]
    v_mfma_f32_32x32x16_bf16 v[72:87], v[32:35], v[28:31], v[72:87]
    v_mfma_f32_32x32x16_bf16 v[88:103], v[36:39], v[24:27], v[88:103]
    v_mfma_f32_32x32x16_bf16 v[104:119], v[36:39], v[28:31], v[104:119]
    s_waitcnt vmcnt(0)
    s_barrier
    ds_read_b128 v[24:27], v16 offset:49152
    ds_read_b128 v[28:31], v16 offset:53248
    ds_read_b128 v[32:35], v20 offset:49152
    ds_read_b128 v[36:39], v20 offset:53248
    s_waitcnt lgkmcnt(4)
    v_mfma_f32_32x32x16_bf16 v[56:71], v[48:51], v[40:43], v[56:71]
    v_mfma_f32_32x32x16_bf16 v[72:87], v[48:51], v[44:47], v[72:87]
    v_mfma_f32_32x32x16_bf16 v[88:103], v[52:55], v[40:43], v[88:103]
    v_mfma_f32_32x32x16_bf16 v[104:119], v[52:55], v[44:47], v[104:119]
    ds_read_b128 v[40:43], v17 offset:49152
    ds_read_b128 v[44:47], v17 offset:53248
    ds_read_b128 v[48:51], v21 offset:49152
    ds_read_b128 v[52:55], v21 offset:53248
    s_waitcnt lgkmcnt(4)
    v_mfma_f32_32x32x16_bf16 v[56:71], v[32:35], v[24:27], v[56:71]
    v_mfma_f32_32x32x16_bf16 v[72:87], v[32:35], v[28:31], v[72:87]
    v_mfma_f32_32x32x16_bf16 v[88:103], v[36:39], v[24:27], v[88:103]
    v_mfma_f32_32x32x16_bf16 v[104:119], v[36:39], v[28:31], v[104:119]
    ds_read_b128 v[24:27], v18 offset:49152
    ds_read_b128 v[28:31], v18 offset:53248
    ds_read_b128 v[32:35], v22 offset:49152
    ds_read_b128 v[36:39], v22 offset:53248
    s_waitcnt lgkmcnt(4)
    v_mfma_f32_32x32x16_bf16 v[56:71], v[48:51], v[40:43], v[56:71]
    v_mfma_f32_32x32x16_bf16 v[72:87], v[48:51], v[44:47], v[72:87]
    v_mfma_f32_32x32x16_bf16 v[88:103], v[52:55], v[40:43], v[88:103]
    v_mfma_f32_32x32x16_bf16 v[104:119], v[52:55], v[44:47], v[104:119]
    ds_read_b128 v[40:43], v19 offset:49152
    ds_read_b128 v[44:47], v19 offset:53248
    ds_read_b128 v[48:51], v23 offset:49152
    ds_read_b128 v[52:55], v23 offset:53248
    s_waitcnt lgkmcnt(4)
    v_mfma_f32_32x32x16_bf16 v[56:71], v[32:35], v[24:27], v[56:71]
    v_mfma_f32_32x32x16_bf16 v[72:87], v[32:35], v[28:31], v[72:87]
    v_mfma_f32_32x32x16_bf16 v[88:103], v[36:39], v[24:27], v[88:103]
    v_mfma_f32_32x32x16_bf16 v[104:119], v[36:39], v[28:31], v[104:119]
    s_waitcnt lgkmcnt(0)
    v_mfma_f32_32x32x16_bf16 v[56:71], v[48:51], v[40:43], v[56:71]
    v_mfma_f32_32x32x16_bf16 v[72:87], v[48:51], v[44:47], v[72:87]
    v_mfma_f32_32x32x16_bf16 v[88:103], v[52:55], v[40:43], v[88:103]
    v_mfma_f32_32x32x16_bf16 v[104:119], v[52:55], v[44:47], v[104:119]
    s_nop 15
    s_nop 3
    s_add_u32 s16, s4, 0xa800000
    s_addc_u32 s17, s5, 0
    s_and_b32 s17, s17, 0xffff
    s_mov_b32 s18, 0xf00000
    s_mov_b32 s19, 0x20000
    v_lshrrev_b32 v1, 6, v0
    v_and_b32 v2, 1, v1
    v_lshrrev_b32 v3, 1, v1
    v_mul_u32_u24 v2, 64, v2
    v_mul_u32_u24 v3, 64, v3
    v_and_b32 v1, 31, v0
    v_bfe_u32 v4, v0, 5, 1
    v_lshlrev_b32 v4, 2, v4
    s_lshr_b32 s31, s30, 10
    s_mul_i32 s31, s31, 17408
    v_mul_u32_u24 v5, 272, v1
    v_lshl_add_u32 v5, v4, 2, v5
    v_add_u32 v5, s31, v5
    v_and_b32 v6, 15, v0
    v_bfe_u32 v7, v0, 4, 2
    v_mul_u32_u24 v8, 272, v7
    v_lshl_add_u32 v8, v6, 4, v8
    v_add_u32 v8, s31, v8
    v_add_u32 v7, v7, v2
    v_add_u32 v7, s22, v7
    v_add_u32 v3, s23, v3
    s_mov_b32 s24, 2560
    v_mul_lo_u32 v7, v7, s24
    v_lshl_add_u32 v7, v3, 2, v7
    v_lshl_add_u32 v7, v6, 4, v7
    s_mul_i32 s39, s38, 5242880
    s_barrier
    ds_write_b128 v5, v[56:59] offset:0
    ds_write_b128 v5, v[60:63] offset:32
    ds_write_b128 v5, v[64:67] offset:64
    ds_write_b128 v5, v[68:71] offset:96
    ds_write_b128 v5, v[88:91] offset:128
    ds_write_b128 v5, v[92:95] offset:160
    ds_write_b128 v5, v[96:99] offset:192
    ds_write_b128 v5, v[100:103] offset:224
    ds_write_b128 v5, v[72:75] offset:8704
    ds_write_b128 v5, v[76:79] offset:8736
    ds_write_b128 v5, v[80:83] offset:8768
    ds_write_b128 v5, v[84:87] offset:8800
    ds_write_b128 v5, v[104:107] offset:8832
    ds_write_b128 v5, v[108:111] offset:8864
    ds_write_b128 v5, v[112:115] offset:8896
    ds_write_b128 v5, v[116:119] offset:8928
    s_waitcnt lgkmcnt(0)
    ds_read_b128 v[56:59], v8 offset:0
    ds_read_b128 v[60:63], v8 offset:1088
    ds_read_b128 v[64:67], v8 offset:2176
    ds_read_b128 v[68:71], v8 offset:3264
    ds_read_b128 v[72:75], v8 offset:4352
    ds_read_b128 v[76:79], v8 offset:5440
    ds_read_b128 v[80:83], v8 offset:6528
    ds_read_b128 v[84:87], v8 offset:7616
    ds_read_b128 v[88:91], v8 offset:8704
    ds_read_b128 v[92:95], v8 offset:9792
    ds_read_b128 v[96:99], v8 offset:10880
    ds_read_b128 v[100:103], v8 offset:11968
    ds_read_b128 v[104:107], v8 offset:13056
    ds_read_b128 v[108:111], v8 offset:14144
    ds_read_b128 v[112:115], v8 offset:15232
    ds_read_b128 v[116:119], v8 offset:16320
    s_add_u32 s25, s39, 0
    s_waitcnt lgkmcnt(15)
    buffer_store_dwordx4 v[56:59], v7, s[16:19], s25 offen sc1
    s_add_u32 s25, s39, 10240
    s_waitcnt lgkmcnt(14)
    buffer_store_dwordx4 v[60:63], v7, s[16:19], s25 offen sc1
    s_add_u32 s25, s39, 20480
    s_waitcnt lgkmcnt(13)
    buffer_store_dwordx4 v[64:67], v7, s[16:19], s25 offen sc1
    s_add_u32 s25, s39, 30720
    s_waitcnt lgkmcnt(12)
    buffer_store_dwordx4 v[68:71], v7, s[16:19], s25 offen sc1
    s_add_u32 s25, s39, 40960
    s_waitcnt lgkmcnt(11)
    buffer_store_dwordx4 v[72:75], v7, s[16:19], s25 offen sc1
    s_add_u32 s25, s39, 51200
    s_waitcnt lgkmcnt(10)
    buffer_store_dwordx4 v[76:79], v7, s[16:19], s25 offen sc1
    s_add_u32 s25, s39, 61440
    s_waitcnt lgkmcnt(9)
    buffer_store_dwordx4 v[80:83], v7, s[16:19], s25 offen sc1
    s_add_u32 s25, s39, 71680
    s_waitcnt lgkmcnt(8)
    buffer_store_dwordx4 v[84:87], v7, s[16:19], s25 offen sc1
    s_add_u32 s25, s39, 81920
    s_waitcnt lgkmcnt(7)
    buffer_store_dwordx4 v[88:91], v7, s[16:19], s25 offen sc1
    s_add_u32 s25, s39, 92160
    s_waitcnt lgkmcnt(6)
    buffer_store_dwordx4 v[92:95], v7, s[16:19], s25 offen sc1
    s_add_u32 s25, s39, 102400
    s_waitcnt lgkmcnt(5)
    buffer_store_dwordx4 v[96:99], v7, s[16:19], s25 offen sc1
    s_add_u32 s25, s39, 112640
    s_waitcnt lgkmcnt(4)
    buffer_store_dwordx4 v[100:103], v7, s[16:19], s25 offen sc1
    s_add_u32 s25, s39, 122880
    s_waitcnt lgkmcnt(3)
    buffer_store_dwordx4 v[104:107], v7, s[16:19], s25 offen sc1
    s_add_u32 s25, s39, 133120
    s_waitcnt lgkmcnt(2)
    buffer_store_dwordx4 v[108:111], v7, s[16:19], s25 offen sc1
    s_add_u32 s25, s39, 143360
    s_waitcnt lgkmcnt(1)
    buffer_store_dwordx4 v[112:115], v7, s[16:19], s25 offen sc1
    s_add_u32 s25, s39, 153600
    s_waitcnt lgkmcnt(0)
    buffer_store_dwordx4 v[116:119], v7, s[16:19], s25 offen sc1
    s_lshr_b32 s31, s30, 10
    s_mul_i32 s33, s38, 5
    s_add_u32 s33, s33, s20
    s_mul_i32 s34, s33, 9
    s_add_u32 s34, s34, s31
    s_add_u32 s35, s34, 0
    s_min_u32 s35, s35, 127
    s_add_u32 s35, s35, s22
    s_mul_i32 s50, s35, 1280
    s_mul_i32 s54, s35, 2560
    s_add_u32 s55, s54, 5242880
    s_add_u32 s56, s54, 10485760
    s_add_u32 s35, s34, 4
    s_min_u32 s35, s35, 127
    s_add_u32 s35, s35, s22
    s_mul_i32 s51, s35, 1280
    s_mul_i32 s57, s35, 2560
    s_add_u32 s58, s57, 5242880
    s_add_u32 s59, s57, 10485760
    s_add_u32 s35, s34, 8
    s_min_u32 s35, s35, 127
    s_add_u32 s35, s35, s22
    s_mul_i32 s52, s35, 1280
    s_mul_i32 s60, s35, 2560
    s_add_u32 s61, s60, 5242880
    s_add_u32 s62, s60, 10485760
    s_add_u32 s8, s4, 0x9400000
    s_addc_u32 s9, s5, 0
    s_and_b32 s9, s9, 0xffff
    s_mov_b32 s10, 0x280000
    s_mov_b32 s11, 0x20000
    s_add_u32 s12, s4, 0x9700000
    s_addc_u32 s13, s5, 0
    s_and_b32 s13, s13, 0xffff
    s_mov_b32 s14, 0x280000
    s_mov_b32 s15, 0x20000
    s_mov_b32 s24, s6
    s_mov_b32 s25, s7
    s_and_b32 s25, s25, 0xffff
    s_mov_b32 s26, 0x280000
    s_mov_b32 s27, 0x20000
    s_add_u32 s44, s4, 0xc000000
    s_addc_u32 s45, s5, 0
    s_and_b32 s45, s45, 0xffff
    s_mov_b32 s46, 0x1000
    s_mov_b32 s47, 0x20000
    s_lshl_b32 s36, s21, 8
    s_lshl_b32 s37, s33, 2
    s_add_u32 s37, s37, s36
    s_waitcnt vmcnt(0)
    s_barrier
    v_and_b32 v1, 63, v0
    v_lshlrev_b32 v2, 2, v1
    v_lshlrev_b32 v15, 3, v1
    v_xor_b32 v3, 32, v1
    v_lshlrev_b32 v3, 2, v3
    s_cmp_lg_u32 s31, 0
    s_cbranch_scc1 L_wo_kernel_fx
    v_mov_b32 v4, 1
    v_mov_b32 v5, 0
    s_mov_b64 exec, 1
    buffer_store_dword v4, v5, s[44:47], s37 offen sc1
    s_mov_b64 exec, -1
    buffer_load_dword v118, v2, s[24:27], s52 offen offset:0
    buffer_load_dword v119, v2, s[24:27], s52 offen offset:256
    buffer_load_dword v120, v2, s[24:27], s52 offen offset:512
    buffer_load_dword v121, v2, s[24:27], s52 offen offset:768
    buffer_load_dword v122, v2, s[24:27], s52 offen offset:1024
L_wo_kernel_fx:
    buffer_load_dword v46, v2, s[24:27], s50 offen offset:0
    buffer_load_dword v47, v2, s[24:27], s50 offen offset:256
    buffer_load_dword v48, v2, s[24:27], s50 offen offset:512
    buffer_load_dword v49, v2, s[24:27], s50 offen offset:768
    buffer_load_dword v50, v2, s[24:27], s50 offen offset:1024
    buffer_load_dword v82, v2, s[24:27], s51 offen offset:0
    buffer_load_dword v83, v2, s[24:27], s51 offen offset:256
    buffer_load_dword v84, v2, s[24:27], s51 offen offset:512
    buffer_load_dword v85, v2, s[24:27], s51 offen offset:768
    buffer_load_dword v86, v2, s[24:27], s51 offen offset:1024
    s_cbranch_scc1 L_wo_kernel_ft
    v_min_u32 v5, 14, v1
    v_lshlrev_b32 v5, 2, v5
L_wo_kernel_fp:
    buffer_load_dword v6, v5, s[44:47], s36 offen sc1
    s_waitcnt vmcnt(0)
    v_cmp_eq_u32 vcc, 0, v6
    s_cbranch_vccz L_wo_kernel_fw
    s_sleep 2
    s_branch L_wo_kernel_fp
L_wo_kernel_ft:
L_wo_kernel_fw:
    s_barrier
    buffer_load_dwordx2 v[16:17], v15, s[16:19], s54 offen offset:0 sc1
    buffer_load_dwordx2 v[26:27], v15, s[16:19], s55 offen offset:0 sc1
    buffer_load_dwordx2 v[36:37], v15, s[16:19], s56 offen offset:0 sc1
    buffer_load_dwordx2 v[18:19], v15, s[16:19], s54 offen offset:512 sc1
    buffer_load_dwordx2 v[28:29], v15, s[16:19], s55 offen offset:512 sc1
    buffer_load_dwordx2 v[38:39], v15, s[16:19], s56 offen offset:512 sc1
    buffer_load_dwordx2 v[20:21], v15, s[16:19], s54 offen offset:1024 sc1
    buffer_load_dwordx2 v[30:31], v15, s[16:19], s55 offen offset:1024 sc1
    buffer_load_dwordx2 v[40:41], v15, s[16:19], s56 offen offset:1024 sc1
    buffer_load_dwordx2 v[22:23], v15, s[16:19], s54 offen offset:1536 sc1
    buffer_load_dwordx2 v[32:33], v15, s[16:19], s55 offen offset:1536 sc1
    buffer_load_dwordx2 v[42:43], v15, s[16:19], s56 offen offset:1536 sc1
    buffer_load_dwordx2 v[24:25], v15, s[16:19], s54 offen offset:2048 sc1
    buffer_load_dwordx2 v[34:35], v15, s[16:19], s55 offen offset:2048 sc1
    buffer_load_dwordx2 v[44:45], v15, s[16:19], s56 offen offset:2048 sc1
    buffer_load_dwordx2 v[52:53], v15, s[16:19], s57 offen offset:0 sc1
    buffer_load_dwordx2 v[62:63], v15, s[16:19], s58 offen offset:0 sc1
    buffer_load_dwordx2 v[72:73], v15, s[16:19], s59 offen offset:0 sc1
    buffer_load_dwordx2 v[54:55], v15, s[16:19], s57 offen offset:512 sc1
    buffer_load_dwordx2 v[64:65], v15, s[16:19], s58 offen offset:512 sc1
    buffer_load_dwordx2 v[74:75], v15, s[16:19], s59 offen offset:512 sc1
    buffer_load_dwordx2 v[56:57], v15, s[16:19], s57 offen offset:1024 sc1
    buffer_load_dwordx2 v[66:67], v15, s[16:19], s58 offen offset:1024 sc1
    buffer_load_dwordx2 v[76:77], v15, s[16:19], s59 offen offset:1024 sc1
    buffer_load_dwordx2 v[58:59], v15, s[16:19], s57 offen offset:1536 sc1
    buffer_load_dwordx2 v[68:69], v15, s[16:19], s58 offen offset:1536 sc1
    buffer_load_dwordx2 v[78:79], v15, s[16:19], s59 offen offset:1536 sc1
    buffer_load_dwordx2 v[60:61], v15, s[16:19], s57 offen offset:2048 sc1
    buffer_load_dwordx2 v[70:71], v15, s[16:19], s58 offen offset:2048 sc1
    buffer_load_dwordx2 v[80:81], v15, s[16:19], s59 offen offset:2048 sc1
    s_cmp_lg_u32 s31, 0
    s_cbranch_scc1 L_wo_kernel_f2
    buffer_load_dwordx2 v[88:89], v15, s[16:19], s60 offen offset:0 sc1
    buffer_load_dwordx2 v[98:99], v15, s[16:19], s61 offen offset:0 sc1
    buffer_load_dwordx2 v[108:109], v15, s[16:19], s62 offen offset:0 sc1
    buffer_load_dwordx2 v[90:91], v15, s[16:19], s60 offen offset:512 sc1
    buffer_load_dwordx2 v[100:101], v15, s[16:19], s61 offen offset:512 sc1
    buffer_load_dwordx2 v[110:111], v15, s[16:19], s62 offen offset:512 sc1
    buffer_load_dwordx2 v[92:93], v15, s[16:19], s60 offen offset:1024 sc1
    buffer_load_dwordx2 v[102:103], v15, s[16:19], s61 offen offset:1024 sc1
    buffer_load_dwordx2 v[112:113], v15, s[16:19], s62 offen offset:1024 sc1
    buffer_load_dwordx2 v[94:95], v15, s[16:19], s60 offen offset:1536 sc1
    buffer_load_dwordx2 v[104:105], v15, s[16:19], s61 offen offset:1536 sc1
    buffer_load_dwordx2 v[114:115], v15, s[16:19], s62 offen offset:1536 sc1
    buffer_load_dwordx2 v[96:97], v15, s[16:19], s60 offen offset:2048 sc1
    buffer_load_dwordx2 v[106:107], v15, s[16:19], s61 offen offset:2048 sc1
    buffer_load_dwordx2 v[116:117], v15, s[16:19], s62 offen offset:2048 sc1
L_wo_kernel_f2:
    s_waitcnt vmcnt(0)
    v_add_f32 v16, v16, v26
    v_add_f32 v17, v17, v27
    v_add_f32 v18, v18, v28
    v_add_f32 v19, v19, v29
    v_add_f32 v20, v20, v30
    v_add_f32 v21, v21, v31
    v_add_f32 v22, v22, v32
    v_add_f32 v23, v23, v33
    v_add_f32 v24, v24, v34
    v_add_f32 v25, v25, v35
    v_add_f32 v16, v16, v36
    v_add_f32 v17, v17, v37
    v_add_f32 v18, v18, v38
    v_add_f32 v19, v19, v39
    v_add_f32 v20, v20, v40
    v_add_f32 v21, v21, v41
    v_add_f32 v22, v22, v42
    v_add_f32 v23, v23, v43
    v_add_f32 v24, v24, v44
    v_add_f32 v25, v25, v45
    v_cvt_pk_bf16_f32 v13, v16, v17
    v_lshlrev_b32 v16, 16, v13
    v_and_b32 v17, 0xffff0000, v13
    v_lshlrev_b32 v13, 16, v46
    v_and_b32 v14, 0xffff0000, v46
    v_add_f32 v16, v16, v13
    v_add_f32 v17, v17, v14
    v_cvt_pk_bf16_f32 v46, v16, v17
    buffer_store_dword v46, v2, s[8:11], s50 offen offset:0 sc1
    v_lshlrev_b32 v16, 16, v46
    v_and_b32 v17, 0xffff0000, v46
    v_cvt_pk_bf16_f32 v13, v18, v19
    v_lshlrev_b32 v18, 16, v13
    v_and_b32 v19, 0xffff0000, v13
    v_lshlrev_b32 v13, 16, v47
    v_and_b32 v14, 0xffff0000, v47
    v_add_f32 v18, v18, v13
    v_add_f32 v19, v19, v14
    v_cvt_pk_bf16_f32 v47, v18, v19
    buffer_store_dword v47, v2, s[8:11], s50 offen offset:256 sc1
    v_lshlrev_b32 v18, 16, v47
    v_and_b32 v19, 0xffff0000, v47
    v_cvt_pk_bf16_f32 v13, v20, v21
    v_lshlrev_b32 v20, 16, v13
    v_and_b32 v21, 0xffff0000, v13
    v_lshlrev_b32 v13, 16, v48
    v_and_b32 v14, 0xffff0000, v48
    v_add_f32 v20, v20, v13
    v_add_f32 v21, v21, v14
    v_cvt_pk_bf16_f32 v48, v20, v21
    buffer_store_dword v48, v2, s[8:11], s50 offen offset:512 sc1
    v_lshlrev_b32 v20, 16, v48
    v_and_b32 v21, 0xffff0000, v48
    v_cvt_pk_bf16_f32 v13, v22, v23
    v_lshlrev_b32 v22, 16, v13
    v_and_b32 v23, 0xffff0000, v13
    v_lshlrev_b32 v13, 16, v49
    v_and_b32 v14, 0xffff0000, v49
    v_add_f32 v22, v22, v13
    v_add_f32 v23, v23, v14
    v_cvt_pk_bf16_f32 v49, v22, v23
    buffer_store_dword v49, v2, s[8:11], s50 offen offset:768 sc1
    v_lshlrev_b32 v22, 16, v49
    v_and_b32 v23, 0xffff0000, v49
    v_cvt_pk_bf16_f32 v13, v24, v25
    v_lshlrev_b32 v24, 16, v13
    v_and_b32 v25, 0xffff0000, v13
    v_lshlrev_b32 v13, 16, v50
    v_and_b32 v14, 0xffff0000, v50
    v_add_f32 v24, v24, v13
    v_add_f32 v25, v25, v14
    v_cvt_pk_bf16_f32 v50, v24, v25
    buffer_store_dword v50, v2, s[8:11], s50 offen offset:1024 sc1
    v_lshlrev_b32 v24, 16, v50
    v_and_b32 v25, 0xffff0000, v50
    v_add_f32 v4, v16, v17
    v_add_f32 v4, v4, v18
    v_add_f32 v4, v4, v19
    v_add_f32 v4, v4, v20
    v_add_f32 v4, v4, v21
    v_add_f32 v4, v4, v22
    v_add_f32 v4, v4, v23
    v_add_f32 v4, v4, v24
    v_add_f32 v4, v4, v25
    v_add_f32 v52, v52, v62
    v_add_f32 v53, v53, v63
    v_add_f32 v54, v54, v64
    v_add_f32 v55, v55, v65
    v_add_f32 v56, v56, v66
    v_add_f32 v57, v57, v67
    v_add_f32 v58, v58, v68
    v_add_f32 v59, v59, v69
    v_add_f32 v60, v60, v70
    v_add_f32 v61, v61, v71
    v_add_f32 v52, v52, v72
    v_add_f32 v53, v53, v73
    v_add_f32 v54, v54, v74
    v_add_f32 v55, v55, v75
    v_add_f32 v56, v56, v76
    v_add_f32 v57, v57, v77
    v_add_f32 v58, v58, v78
    v_add_f32 v59, v59, v79
    v_add_f32 v60, v60, v80
    v_add_f32 v61, v61, v81
    v_cvt_pk_bf16_f32 v13, v52, v53
    v_lshlrev_b32 v52, 16, v13
    v_and_b32 v53, 0xffff0000, v13
    v_lshlrev_b32 v13, 16, v82
    v_and_b32 v14, 0xffff0000, v82
    v_add_f32 v52, v52, v13
    v_add_f32 v53, v53, v14
    v_cvt_pk_bf16_f32 v82, v52, v53
    buffer_store_dword v82, v2, s[8:11], s51 offen offset:0 sc1
    v_lshlrev_b32 v52, 16, v82
    v_and_b32 v53, 0xffff0000, v82
    v_cvt_pk_bf16_f32 v13, v54, v55
    v_lshlrev_b32 v54, 16, v13
    v_and_b32 v55, 0xffff0000, v13
    v_lshlrev_b32 v13, 16, v83
    v_and_b32 v14, 0xffff0000, v83
    v_add_f32 v54, v54, v13
    v_add_f32 v55, v55, v14
    v_cvt_pk_bf16_f32 v83, v54, v55
    buffer_store_dword v83, v2, s[8:11], s51 offen offset:256 sc1
    v_lshlrev_b32 v54, 16, v83
    v_and_b32 v55, 0xffff0000, v83
    v_cvt_pk_bf16_f32 v13, v56, v57
    v_lshlrev_b32 v56, 16, v13
    v_and_b32 v57, 0xffff0000, v13
    v_lshlrev_b32 v13, 16, v84
    v_and_b32 v14, 0xffff0000, v84
    v_add_f32 v56, v56, v13
    v_add_f32 v57, v57, v14
    v_cvt_pk_bf16_f32 v84, v56, v57
    buffer_store_dword v84, v2, s[8:11], s51 offen offset:512 sc1
    v_lshlrev_b32 v56, 16, v84
    v_and_b32 v57, 0xffff0000, v84
    v_cvt_pk_bf16_f32 v13, v58, v59
    v_lshlrev_b32 v58, 16, v13
    v_and_b32 v59, 0xffff0000, v13
    v_lshlrev_b32 v13, 16, v85
    v_and_b32 v14, 0xffff0000, v85
    v_add_f32 v58, v58, v13
    v_add_f32 v59, v59, v14
    v_cvt_pk_bf16_f32 v85, v58, v59
    buffer_store_dword v85, v2, s[8:11], s51 offen offset:768 sc1
    v_lshlrev_b32 v58, 16, v85
    v_and_b32 v59, 0xffff0000, v85
    v_cvt_pk_bf16_f32 v13, v60, v61
    v_lshlrev_b32 v60, 16, v13
    v_and_b32 v61, 0xffff0000, v13
    v_lshlrev_b32 v13, 16, v86
    v_and_b32 v14, 0xffff0000, v86
    v_add_f32 v60, v60, v13
    v_add_f32 v61, v61, v14
    v_cvt_pk_bf16_f32 v86, v60, v61
    buffer_store_dword v86, v2, s[8:11], s51 offen offset:1024 sc1
    v_lshlrev_b32 v60, 16, v86
    v_and_b32 v61, 0xffff0000, v86
    v_add_f32 v5, v52, v53
    v_add_f32 v5, v5, v54
    v_add_f32 v5, v5, v55
    v_add_f32 v5, v5, v56
    v_add_f32 v5, v5, v57
    v_add_f32 v5, v5, v58
    v_add_f32 v5, v5, v59
    v_add_f32 v5, v5, v60
    v_add_f32 v5, v5, v61
    v_add_f32 v88, v88, v98
    v_add_f32 v89, v89, v99
    v_add_f32 v90, v90, v100
    v_add_f32 v91, v91, v101
    v_add_f32 v92, v92, v102
    v_add_f32 v93, v93, v103
    v_add_f32 v94, v94, v104
    v_add_f32 v95, v95, v105
    v_add_f32 v96, v96, v106
    v_add_f32 v97, v97, v107
    v_add_f32 v88, v88, v108
    v_add_f32 v89, v89, v109
    v_add_f32 v90, v90, v110
    v_add_f32 v91, v91, v111
    v_add_f32 v92, v92, v112
    v_add_f32 v93, v93, v113
    v_add_f32 v94, v94, v114
    v_add_f32 v95, v95, v115
    v_add_f32 v96, v96, v116
    v_add_f32 v97, v97, v117
    v_cvt_pk_bf16_f32 v13, v88, v89
    v_lshlrev_b32 v88, 16, v13
    v_and_b32 v89, 0xffff0000, v13
    v_lshlrev_b32 v13, 16, v118
    v_and_b32 v14, 0xffff0000, v118
    v_add_f32 v88, v88, v13
    v_add_f32 v89, v89, v14
    v_cvt_pk_bf16_f32 v118, v88, v89
    v_lshlrev_b32 v88, 16, v118
    v_and_b32 v89, 0xffff0000, v118
    v_cvt_pk_bf16_f32 v13, v90, v91
    v_lshlrev_b32 v90, 16, v13
    v_and_b32 v91, 0xffff0000, v13
    v_lshlrev_b32 v13, 16, v119
    v_and_b32 v14, 0xffff0000, v119
    v_add_f32 v90, v90, v13
    v_add_f32 v91, v91, v14
    v_cvt_pk_bf16_f32 v119, v90, v91
    v_lshlrev_b32 v90, 16, v119
    v_and_b32 v91, 0xffff0000, v119
    v_cvt_pk_bf16_f32 v13, v92, v93
    v_lshlrev_b32 v92, 16, v13
    v_and_b32 v93, 0xffff0000, v13
    v_lshlrev_b32 v13, 16, v120
    v_and_b32 v14, 0xffff0000, v120
    v_add_f32 v92, v92, v13
    v_add_f32 v93, v93, v14
    v_cvt_pk_bf16_f32 v120, v92, v93
    v_lshlrev_b32 v92, 16, v120
    v_and_b32 v93, 0xffff0000, v120
    v_cvt_pk_bf16_f32 v13, v94, v95
    v_lshlrev_b32 v94, 16, v13
    v_and_b32 v95, 0xffff0000, v13
    v_lshlrev_b32 v13, 16, v121
    v_and_b32 v14, 0xffff0000, v121
    v_add_f32 v94, v94, v13
    v_add_f32 v95, v95, v14
    v_cvt_pk_bf16_f32 v121, v94, v95
    v_lshlrev_b32 v94, 16, v121
    v_and_b32 v95, 0xffff0000, v121
    v_cvt_pk_bf16_f32 v13, v96, v97
    v_lshlrev_b32 v96, 16, v13
    v_and_b32 v97, 0xffff0000, v13
    v_lshlrev_b32 v13, 16, v122
    v_and_b32 v14, 0xffff0000, v122
    v_add_f32 v96, v96, v13
    v_add_f32 v97, v97, v14
    v_cvt_pk_bf16_f32 v122, v96, v97
    v_lshlrev_b32 v96, 16, v122
    v_and_b32 v97, 0xffff0000, v122
    v_add_f32 v6, v88, v89
    v_add_f32 v6, v6, v90
    v_add_f32 v6, v6, v91
    v_add_f32 v6, v6, v92
    v_add_f32 v6, v6, v93
    v_add_f32 v6, v6, v94
    v_add_f32 v6, v6, v95
    v_add_f32 v6, v6, v96
    v_add_f32 v6, v6, v97
    ds_swizzle_b32 v7, v4 offset:0x41f
    ds_swizzle_b32 v8, v5 offset:0x41f
    ds_swizzle_b32 v9, v6 offset:0x41f
    s_waitcnt lgkmcnt(0)
    v_add_f32 v4, v4, v7
    v_add_f32 v5, v5, v8
    v_add_f32 v6, v6, v9
    ds_swizzle_b32 v7, v4 offset:0x81f
    ds_swizzle_b32 v8, v5 offset:0x81f
    ds_swizzle_b32 v9, v6 offset:0x81f
    s_waitcnt lgkmcnt(0)
    v_add_f32 v4, v4, v7
    v_add_f32 v5, v5, v8
    v_add_f32 v6, v6, v9
    ds_swizzle_b32 v7, v4 offset:0x101f
    ds_swizzle_b32 v8, v5 offset:0x101f
    ds_swizzle_b32 v9, v6 offset:0x101f
    s_waitcnt lgkmcnt(0)
    v_add_f32 v4, v4, v7
    v_add_f32 v5, v5, v8
    v_add_f32 v6, v6, v9
    ds_swizzle_b32 v7, v4 offset:0x201f
    ds_swizzle_b32 v8, v5 offset:0x201f
    ds_swizzle_b32 v9, v6 offset:0x201f
    s_waitcnt lgkmcnt(0)
    v_add_f32 v4, v4, v7
    v_add_f32 v5, v5, v8
    v_add_f32 v6, v6, v9
    ds_swizzle_b32 v7, v4 offset:0x401f
    ds_swizzle_b32 v8, v5 offset:0x401f
    ds_swizzle_b32 v9, v6 offset:0x401f
    s_waitcnt lgkmcnt(0)
    v_add_f32 v4, v4, v7
    v_add_f32 v5, v5, v8
    v_add_f32 v6, v6, v9
    ds_bpermute_b32 v7, v3, v4
    ds_bpermute_b32 v8, v3, v5
    ds_bpermute_b32 v9, v3, v6
    s_waitcnt lgkmcnt(0)
    v_add_f32 v4, v4, v7
    v_add_f32 v5, v5, v8
    v_add_f32 v6, v6, v9
    v_mul_f32 v4, 0x3acccccd, v4
    v_sub_f32 v16, v16, v4
    v_sub_f32 v17, v17, v4
    v_sub_f32 v18, v18, v4
    v_sub_f32 v19, v19, v4
    v_sub_f32 v20, v20, v4
    v_sub_f32 v21, v21, v4
    v_sub_f32 v22, v22, v4
    v_sub_f32 v23, v23, v4
    v_sub_f32 v24, v24, v4
    v_sub_f32 v25, v25, v4
    v_mul_f32 v10, v16, v16
    v_fmac_f32 v10, v17, v17
    v_fmac_f32 v10, v18, v18
    v_fmac_f32 v10, v19, v19
    v_fmac_f32 v10, v20, v20
    v_fmac_f32 v10, v21, v21
    v_fmac_f32 v10, v22, v22
    v_fmac_f32 v10, v23, v23
    v_fmac_f32 v10, v24, v24
    v_fmac_f32 v10, v25, v25
    v_mul_f32 v5, 0x3acccccd, v5
    v_sub_f32 v52, v52, v5
    v_sub_f32 v53, v53, v5
    v_sub_f32 v54, v54, v5
    v_sub_f32 v55, v55, v5
    v_sub_f32 v56, v56, v5
    v_sub_f32 v57, v57, v5
    v_sub_f32 v58, v58, v5
    v_sub_f32 v59, v59, v5
    v_sub_f32 v60, v60, v5
    v_sub_f32 v61, v61, v5
    v_mul_f32 v11, v52, v52
    v_fmac_f32 v11, v53, v53
    v_fmac_f32 v11, v54, v54
    v_fmac_f32 v11, v55, v55
    v_fmac_f32 v11, v56, v56
    v_fmac_f32 v11, v57, v57
    v_fmac_f32 v11, v58, v58
    v_fmac_f32 v11, v59, v59
    v_fmac_f32 v11, v60, v60
    v_fmac_f32 v11, v61, v61
    v_mul_f32 v6, 0x3acccccd, v6
    v_sub_f32 v88, v88, v6
    v_sub_f32 v89, v89, v6
    v_sub_f32 v90, v90, v6
    v_sub_f32 v91, v91, v6
    v_sub_f32 v92, v92, v6
    v_sub_f32 v93, v93, v6
    v_sub_f32 v94, v94, v6
    v_sub_f32 v95, v95, v6
    v_sub_f32 v96, v96, v6
    v_sub_f32 v97, v97, v6
    v_mul_f32 v12, v88, v88
    v_fmac_f32 v12, v89, v89
    v_fmac_f32 v12, v90, v90
    v_fmac_f32 v12, v91, v91
    v_fmac_f32 v12, v92, v92
    v_fmac_f32 v12, v93, v93
    v_fmac_f32 v12, v94, v94
    v_fmac_f32 v12, v95, v95
    v_fmac_f32 v12, v96, v96
    v_fmac_f32 v12, v97, v97
    ds_swizzle_b32 v7, v10 offset:0x41f
    ds_swizzle_b32 v8, v11 offset:0x41f
    ds_swizzle_b32 v9, v12 offset:0x41f
    s_waitcnt lgkmcnt(0)
    v_add_f32 v10, v10, v7
    v_add_f32 v11, v11, v8
    v_add_f32 v12, v12, v9
    ds_swizzle_b32 v7, v10 offset:0x81f
    ds_swizzle_b32 v8, v11 offset:0x81f
    ds_swizzle_b32 v9, v12 offset:0x81f
    s_waitcnt lgkmcnt(0)
    v_add_f32 v10, v10, v7
    v_add_f32 v11, v11, v8
    v_add_f32 v12, v12, v9
    ds_swizzle_b32 v7, v10 offset:0x101f
    ds_swizzle_b32 v8, v11 offset:0x101f
    ds_swizzle_b32 v9, v12 offset:0x101f
    s_waitcnt lgkmcnt(0)
    v_add_f32 v10, v10, v7
    v_add_f32 v11, v11, v8
    v_add_f32 v12, v12, v9
    ds_swizzle_b32 v7, v10 offset:0x201f
    ds_swizzle_b32 v8, v11 offset:0x201f
    ds_swizzle_b32 v9, v12 offset:0x201f
    s_waitcnt lgkmcnt(0)
    v_add_f32 v10, v10, v7
    v_add_f32 v11, v11, v8
    v_add_f32 v12, v12, v9
    ds_swizzle_b32 v7, v10 offset:0x401f
    ds_swizzle_b32 v8, v11 offset:0x401f
    ds_swizzle_b32 v9, v12 offset:0x401f
    s_waitcnt lgkmcnt(0)
    v_add_f32 v10, v10, v7
    v_add_f32 v11, v11, v8
    v_add_f32 v12, v12, v9
    ds_bpermute_b32 v7, v3, v10
    ds_bpermute_b32 v8, v3, v11
    ds_bpermute_b32 v9, v3, v12
    s_waitcnt lgkmcnt(0)
    v_add_f32 v10, v10, v7
    v_add_f32 v11, v11, v8
    v_add_f32 v12, v12, v9
    v_mul_f32 v10, 0x3acccccd, v10
    v_add_f32 v10, 0x3727c5ac, v10
    v_rsq_f32 v10, v10
    v_mul_f32 v11, 0x3acccccd, v11
    v_add_f32 v11, 0x3727c5ac, v11
    v_rsq_f32 v11, v11
    v_mul_f32 v12, 0x3acccccd, v12
    v_add_f32 v12, 0x3727c5ac, v12
    v_rsq_f32 v12, v12
    s_nop 1
    v_mul_f32 v16, v16, v10
    v_mul_f32 v17, v17, v10
    v_mul_f32 v18, v18, v10
    v_mul_f32 v19, v19, v10
    v_mul_f32 v20, v20, v10
    v_mul_f32 v21, v21, v10
    v_mul_f32 v22, v22, v10
    v_mul_f32 v23, v23, v10
    v_mul_f32 v24, v24, v10
    v_mul_f32 v25, v25, v10
    v_cvt_pk_bf16_f32 v26, v16, v17
    v_cvt_pk_bf16_f32 v27, v18, v19
    v_cvt_pk_bf16_f32 v28, v20, v21
    v_cvt_pk_bf16_f32 v29, v22, v23
    v_cvt_pk_bf16_f32 v30, v24, v25
    buffer_store_dword v26, v2, s[12:15], s50 offen offset:0 sc1
    buffer_store_dword v27, v2, s[12:15], s50 offen offset:256 sc1
    buffer_store_dword v28, v2, s[12:15], s50 offen offset:512 sc1
    buffer_store_dword v29, v2, s[12:15], s50 offen offset:768 sc1
    buffer_store_dword v30, v2, s[12:15], s50 offen offset:1024 sc1
    v_mul_f32 v52, v52, v11
    v_mul_f32 v53, v53, v11
    v_mul_f32 v54, v54, v11
    v_mul_f32 v55, v55, v11
    v_mul_f32 v56, v56, v11
    v_mul_f32 v57, v57, v11
    v_mul_f32 v58, v58, v11
    v_mul_f32 v59, v59, v11
    v_mul_f32 v60, v60, v11
    v_mul_f32 v61, v61, v11
    v_cvt_pk_bf16_f32 v62, v52, v53
    v_cvt_pk_bf16_f32 v63, v54, v55
    v_cvt_pk_bf16_f32 v64, v56, v57
    v_cvt_pk_bf16_f32 v65, v58, v59
    v_cvt_pk_bf16_f32 v66, v60, v61
    buffer_store_dword v62, v2, s[12:15], s51 offen offset:0 sc1
    buffer_store_dword v63, v2, s[12:15], s51 offen offset:256 sc1
    buffer_store_dword v64, v2, s[12:15], s51 offen offset:512 sc1
    buffer_store_dword v65, v2, s[12:15], s51 offen offset:768 sc1
    buffer_store_dword v66, v2, s[12:15], s51 offen offset:1024 sc1
    s_cbranch_scc1 L_wo_kernel_fe
    buffer_store_dword v118, v2, s[8:11], s52 offen offset:0 sc1
    buffer_store_dword v119, v2, s[8:11], s52 offen offset:256 sc1
    buffer_store_dword v120, v2, s[8:11], s52 offen offset:512 sc1
    buffer_store_dword v121, v2, s[8:11], s52 offen offset:768 sc1
    buffer_store_dword v122, v2, s[8:11], s52 offen offset:1024 sc1
    v_mul_f32 v88, v88, v12
    v_mul_f32 v89, v89, v12
    v_mul_f32 v90, v90, v12
    v_mul_f32 v91, v91, v12
    v_mul_f32 v92, v92, v12
    v_mul_f32 v93, v93, v12
    v_mul_f32 v94, v94, v12
    v_mul_f32 v95, v95, v12
    v_mul_f32 v96, v96, v12
    v_mul_f32 v97, v97, v12
    v_cvt_pk_bf16_f32 v98, v88, v89
    v_cvt_pk_bf16_f32 v99, v90, v91
    v_cvt_pk_bf16_f32 v100, v92, v93
    v_cvt_pk_bf16_f32 v101, v94, v95
    v_cvt_pk_bf16_f32 v102, v96, v97
    buffer_store_dword v98, v2, s[12:15], s52 offen offset:0 sc1
    buffer_store_dword v99, v2, s[12:15], s52 offen offset:256 sc1
    buffer_store_dword v100, v2, s[12:15], s52 offen offset:512 sc1
    buffer_store_dword v101, v2, s[12:15], s52 offen offset:768 sc1
    buffer_store_dword v102, v2, s[12:15], s52 offen offset:1024 sc1
L_wo_kernel_fe:
    s_waitcnt vmcnt(0)
    s_barrier
    s_cbranch_scc1 L_ffn1_entry
    v_mov_b32 v4, 1
    v_mov_b32 v5, 0
    s_mov_b64 exec, 1
    buffer_store_dword v4, v5, s[44:47], s37 offen offset:128 sc1
    s_mov_b64 exec, -1
    s_branch L_ffn1_entry
    s_endpgm
    v_lshrrev_b32 v1, 6, v0
    v_and_b32 v2, 1, v1
    v_lshrrev_b32 v3, 1, v1
    v_mul_u32_u24 v2, 64, v2
    v_mul_u32_u24 v3, 64, v3
    v_and_b32 v1, 31, v0
    v_bfe_u32 v4, v0, 5, 1
    v_lshlrev_b32 v4, 2, v4
    v_add_u32 v1, v1, v2
    v_add_u32 v1, s22, v1
    v_add_u32 v3, v3, v4
    v_add_u32 v3, s23, v3
    s_mov_b32 s24, 2560
    v_mul_lo_u32 v1, v1, s24
    v_lshl_add_u32 v1, v3, 2, v1
    s_mul_i32 s39, s38, 5242880
    s_add_u32 s25, s39, 0
    buffer_store_dwordx4 v[56:59], v1, s[16:19], s25 offen offset:0 sc1
    buffer_store_dwordx4 v[60:63], v1, s[16:19], s25 offen offset:32 sc1
    buffer_store_dwordx4 v[64:67], v1, s[16:19], s25 offen offset:64 sc1
    buffer_store_dwordx4 v[68:71], v1, s[16:19], s25 offen offset:96 sc1
    s_add_u32 s25, s39, 81920
    buffer_store_dwordx4 v[72:75], v1, s[16:19], s25 offen offset:0 sc1
    buffer_store_dwordx4 v[76:79], v1, s[16:19], s25 offen offset:32 sc1
    buffer_store_dwordx4 v[80:83], v1, s[16:19], s25 offen offset:64 sc1
    buffer_store_dwordx4 v[84:87], v1, s[16:19], s25 offen offset:96 sc1
    s_add_u32 s25, s39, 0
    buffer_store_dwordx4 v[88:91], v1, s[16:19], s25 offen offset:128 sc1
    buffer_store_dwordx4 v[92:95], v1, s[16:19], s25 offen offset:160 sc1
    buffer_store_dwordx4 v[96:99], v1, s[16:19], s25 offen offset:192 sc1
    buffer_store_dwordx4 v[100:103], v1, s[16:19], s25 offen offset:224 sc1
    s_add_u32 s25, s39, 81920
    buffer_store_dwordx4 v[104:107], v1, s[16:19], s25 offen offset:128 sc1
    buffer_store_dwordx4 v[108:111], v1, s[16:19], s25 offen offset:160 sc1
    buffer_store_dwordx4 v[112:115], v1, s[16:19], s25 offen offset:192 sc1
    buffer_store_dwordx4 v[116:119], v1, s[16:19], s25 offen offset:224 sc1
L_wo_kernel_end:
    s_endpgm
.globl ffn1_kernel
.p2align 8
.type ffn1_kernel,@function
ffn1_kernel:
L_ffn1_entry:
    s_cmp_ge_u32 s2, 256
    s_cbranch_scc1 L_ffn1_kernel_end
    s_load_dwordx2 s[4:5], s[0:1], 104
    s_load_dwordx2 s[6:7], s[0:1], 0
    s_load_dwordx2 s[28:29], s[0:1], 88
    s_mov_b32 s38, 0
    s_and_b32 s20, s2, 7
    s_lshr_b32 s39, s2, 3
    s_and_b32 s21, s20, 1
    s_lshl_b32 s21, s21, 3
    s_and_b32 s22, s39, 7
    s_add_u32 s21, s21, s22
    s_lshr_b32 s20, s20, 1
    s_lshl_b32 s20, s20, 2
    s_lshr_b32 s39, s39, 3
    s_add_u32 s20, s20, s39
    s_mul_i32 s22, s21, 128
    s_mul_i32 s23, s20, 192
    s_waitcnt lgkmcnt(0)
    s_add_u32 s8, s4, 0x9700000
    s_addc_u32 s9, s5, 0
    s_and_b32 s9, s9, 0xffff
    s_mov_b32 s10, 0x280000
    s_mov_b32 s11, 0x20000
    s_add_u32 s12, s4, 0x2200000
    s_addc_u32 s13, s5, 0
    s_and_b32 s13, s13, 0xffff
    s_mov_b32 s14, 0x3c0000
    s_mov_b32 s15, 0x20000
    v_lshrrev_b32 v1, 3, v0
    v_and_b32 v12, 7, v0
    v_and_b32 v13, 7, v1
    v_xor_b32 v12, v12, v13
    v_lshlrev_b32 v12, 4, v12
    s_mov_b32 s24, 1280
    s_mov_b32 s25, 1280
    v_add_u32 v2, s22, v1
    v_mul_lo_u32 v2, v2, s24
    v_add_u32 v2, v2, v12
    v_add_u32 v3, s22, v1
    v_add_u32 v3, 32, v3
    v_mul_lo_u32 v3, v3, s24
    v_add_u32 v3, v3, v12
    v_add_u32 v4, s22, v1
    v_add_u32 v4, 64, v4
    v_mul_lo_u32 v4, v4, s24
    v_add_u32 v4, v4, v12
    v_add_u32 v5, s22, v1
    v_add_u32 v5, 96, v5
    v_mul_lo_u32 v5, v5, s24
    v_add_u32 v5, v5, v12
    v_add_u32 v6, s23, v1
    v_mul_lo_u32 v6, v6, s25
    v_add_u32 v6, v6, v12
    v_add_u32 v7, s23, v1
    v_add_u32 v7, 32, v7
    v_mul_lo_u32 v7, v7, s25
    v_add_u32 v7, v7, v12
    v_add_u32 v8, s23, v1
    v_add_u32 v8, 64, v8
    v_mul_lo_u32 v8, v8, s25
    v_add_u32 v8, v8, v12
    v_add_u32 v9, s23, v1
    v_add_u32 v9, 96, v9
    v_mul_lo_u32 v9, v9, s25
    v_add_u32 v9, v9, v12
    v_add_u32 v10, s23, v1
    v_add_u32 v10, 128, v10
    v_mul_lo_u32 v10, v10, s25
    v_add_u32 v10, v10, v12
    v_add_u32 v11, s23, v1
    v_add_u32 v11, 160, v11
    v_mul_lo_u32 v11, v11, s25
    v_add_u32 v11, v11, v12
    v_mul_u32_u24 v1, 144, v1
    v_add_u32 v12, v12, v1
    v_lshrrev_b32 v1, 6, v0
    v_and_b32 v13, 1, v1
    v_lshrrev_b32 v14, 1, v1
    v_mul_u32_u24 v13, 64, v13
    v_mul_u32_u24 v14, 96, v14
    v_and_b32 v1, 31, v0
    v_add_u32 v13, v13, v1
    v_add_u32 v14, v14, v1
    v_mul_u32_u24 v13, 144, v13
    v_mul_u32_u24 v14, 144, v14
    v_bfe_u32 v1, v0, 5, 1
    v_lshlrev_b32 v1, 4, v1
    v_add_u32 v13, v13, v1
    v_add_u32 v14, v14, v1
    v_add_u32 v14, 18432, v14
    v_add_u32 v15, 46080, v12
    v_add_u32 v16, 46080, v13
    v_add_u32 v17, 46080, v14
    v_lshrrev_b32 v1, 6, v0
    s_nop 0
    v_readfirstlane_b32 s30, v1
    s_lshl_b32 s30, s30, 10
    v_and_b32 v18, 1, v1
    v_lshrrev_b32 v22, 1, v1
    v_mul_u32_u24 v18, 64, v18
    v_mul_u32_u24 v22, 96, v22
    v_and_b32 v1, 31, v0
    v_add_u32 v18, v18, v1
    v_add_u32 v22, v22, v1
    v_lshlrev_b32 v18, 7, v18
    v_lshlrev_b32 v22, 7, v22
    v_bfe_u32 v12, v0, 5, 1
    v_and_b32 v1, 7, v0
    v_xor_b32 v1, v1, v12
    v_lshlrev_b32 v1, 4, v1
    v_add_u32 v18, v18, v1
    v_add_u32 v22, v22, v1
    v_xor_b32 v19, 32, v18
    v_xor_b32 v23, 32, v22
    v_xor_b32 v20, 64, v18
    v_xor_b32 v24, 64, v22
    v_xor_b32 v21, 96, v18
    v_xor_b32 v25, 96, v22
    v_add_u32 v22, 49152, v22
    v_add_u32 v23, 49152, v23
    v_add_u32 v24, 49152, v24
    v_add_u32 v25, 49152, v25
    v_mov_b32 v68, 0
    v_mov_b32 v69, 0
    v_mov_b32 v70, 0
    v_mov_b32 v71, 0
    v_mov_b32 v72, 0
    v_mov_b32 v73, 0
    v_mov_b32 v74, 0
    v_mov_b32 v75, 0
    v_mov_b32 v76, 0
    v_mov_b32 v77, 0
    v_mov_b32 v78, 0
    v_mov_b32 v79, 0
    v_mov_b32 v80, 0
    v_mov_b32 v81, 0
    v_mov_b32 v82, 0
    v_mov_b32 v83, 0
    v_mov_b32 v84, 0
    v_mov_b32 v85, 0
    v_mov_b32 v86, 0
    v_mov_b32 v87, 0
    v_mov_b32 v88, 0
    v_mov_b32 v89, 0
    v_mov_b32 v90, 0
    v_mov_b32 v91, 0
    v_mov_b32 v92, 0
    v_mov_b32 v93, 0
    v_mov_b32 v94, 0
    v_mov_b32 v95, 0
    v_mov_b32 v96, 0
    v_mov_b32 v97, 0
    v_mov_b32 v98, 0
    v_mov_b32 v99, 0
    v_mov_b32 v100, 0
    v_mov_b32 v101, 0
    v_mov_b32 v102, 0
    v_mov_b32 v103, 0
    v_mov_b32 v104, 0
    v_mov_b32 v105, 0
    v_mov_b32 v106, 0
    v_mov_b32 v107, 0
    v_mov_b32 v108, 0
    v_mov_b32 v109, 0
    v_mov_b32 v110, 0
    v_mov_b32 v111, 0
    v_mov_b32 v112, 0
    v_mov_b32 v113, 0
    v_mov_b32 v114, 0
    v_mov_b32 v115, 0
    v_mov_b32 v116, 0
    v_mov_b32 v117, 0
    v_mov_b32 v118, 0
    v_mov_b32 v119, 0
    v_mov_b32 v120, 0
    v_mov_b32 v121, 0
    v_mov_b32 v122, 0
    v_mov_b32 v123, 0
    v_mov_b32 v124, 0
    v_mov_b32 v125, 0
    v_mov_b32 v126, 0
    v_mov_b32 v127, 0
    v_mov_b32 v128, 0
    v_mov_b32 v129, 0
    v_mov_b32 v130, 0
    v_mov_b32 v131, 0
    v_mov_b32 v132, 0
    v_mov_b32 v133, 0
    v_mov_b32 v134, 0
    v_mov_b32 v135, 0
    v_mov_b32 v136, 0
    v_mov_b32 v137, 0
    v_mov_b32 v138, 0
    v_mov_b32 v139, 0
    v_mov_b32 v140, 0
    v_mov_b32 v141, 0
    v_mov_b32 v142, 0
    v_mov_b32 v143, 0
    v_mov_b32 v144, 0
    v_mov_b32 v145, 0
    v_mov_b32 v146, 0
    v_mov_b32 v147, 0
    v_mov_b32 v148, 0
    v_mov_b32 v149, 0
    v_mov_b32 v150, 0
    v_mov_b32 v151, 0
    v_mov_b32 v152, 0
    v_mov_b32 v153, 0
    v_mov_b32 v154, 0
    v_mov_b32 v155, 0
    v_mov_b32 v156, 0
    v_mov_b32 v157, 0
    v_mov_b32 v158, 0
    v_mov_b32 v159, 0
    v_mov_b32 v160, 0
    v_mov_b32 v161, 0
    v_mov_b32 v162, 0
    v_mov_b32 v163, 0
    s_mul_i32 s26, s38, 1280
    s_mov_b32 s31, s26
    s_add_u32 m0, s30, 49152
    s_nop 0
    buffer_load_dwordx4 v6, s[12:15], s31 offen lds
    s_add_u32 m0, s30, 53248
    s_nop 0
    buffer_load_dwordx4 v7, s[12:15], s31 offen lds
    s_add_u32 m0, s30, 57344
    s_nop 0
    buffer_load_dwordx4 v8, s[12:15], s31 offen lds
    s_add_u32 m0, s30, 61440
    s_nop 0
    buffer_load_dwordx4 v9, s[12:15], s31 offen lds
    s_add_u32 m0, s30, 65536
    s_nop 0
    buffer_load_dwordx4 v10, s[12:15], s31 offen lds
    s_add_u32 m0, s30, 69632
    s_nop 0
    buffer_load_dwordx4 v11, s[12:15], s31 offen lds
    s_add_u32 s31, s31, 128
    s_add_u32 m0, s30, 73728
    s_nop 0
    buffer_load_dwordx4 v6, s[12:15], s31 offen lds
    s_add_u32 m0, s30, 77824
    s_nop 0
    buffer_load_dwordx4 v7, s[12:15], s31 offen lds
    s_add_u32 m0, s30, 81920
    s_nop 0
    buffer_load_dwordx4 v8, s[12:15], s31 offen lds
    s_add_u32 m0, s30, 86016
    s_nop 0
    buffer_load_dwordx4 v9, s[12:15], s31 offen lds
    s_add_u32 m0, s30, 90112
    s_nop 0
    buffer_load_dwordx4 v10, s[12:15], s31 offen lds
    s_add_u32 m0, s30, 94208
    s_nop 0
    buffer_load_dwordx4 v11, s[12:15], s31 offen lds
    s_add_u32 s31, s31, 128
    s_cmp_lg_u32 s30, 0
    s_cbranch_scc1 L_ffn1_kernel_cw
    s_add_u32 s44, s4, 0xc000000
    s_addc_u32 s45, s5, 0
    s_and_b32 s45, s45, 0xffff
    s_mov_b32 s46, 0x1000
    s_mov_b32 s47, 0x20000
    s_lshl_b32 s36, s21, 8
    v_min_u32 v164, 14, v0
    v_lshlrev_b32 v164, 2, v164
L_ffn1_kernel_cp:
    buffer_load_dword v165, v164, s[44:47], s36 offen offset:128 sc1
    s_waitcnt vmcnt(0)
    v_cmp_eq_u32 vcc, 0, v165
    s_cbranch_vccz L_ffn1_kernel_cw
    s_sleep 1
    s_branch L_ffn1_kernel_cp
L_ffn1_kernel_cw:
    s_barrier
    s_add_u32 m0, s30, 0
    s_nop 0
    buffer_load_dwordx4 v2, s[8:11], s26 offen lds
    s_add_u32 m0, s30, 4096
    s_nop 0
    buffer_load_dwordx4 v3, s[8:11], s26 offen lds
    s_add_u32 m0, s30, 8192
    s_nop 0
    buffer_load_dwordx4 v4, s[8:11], s26 offen lds
    s_add_u32 m0, s30, 12288
    s_nop 0
    buffer_load_dwordx4 v5, s[8:11], s26 offen lds
    s_add_u32 s26, s26, 128
    s_add_u32 m0, s30, 16384
    s_nop 0
    buffer_load_dwordx4 v2, s[8:11], s26 offen lds
    s_add_u32 m0, s30, 20480
    s_nop 0
    buffer_load_dwordx4 v3, s[8:11], s26 offen lds
    s_add_u32 m0, s30, 24576
    s_nop 0
    buffer_load_dwordx4 v4, s[8:11], s26 offen lds
    s_add_u32 m0, s30, 28672
    s_nop 0
    buffer_load_dwordx4 v5, s[8:11], s26 offen lds
    s_add_u32 s26, s26, 128
    s_waitcnt vmcnt(4)
    s_barrier
    ds_read_b128 v[28:31], v18 offset:0
    ds_read_b128 v[32:35], v18 offset:4096
    ds_read_b128 v[36:39], v22 offset:0
    ds_read_b128 v[40:43], v22 offset:4096
    ds_read_b128 v[44:47], v22 offset:8192
    s_mov_b32 s27, 0
L_ffn1_kernel_loopm:
    ds_read_b128 v[48:51], v19 offset:0
    ds_read_b128 v[52:55], v19 offset:4096
    ds_read_b128 v[56:59], v23 offset:0
    ds_read_b128 v[60:63], v23 offset:4096
    ds_read_b128 v[64:67], v23 offset:8192
    s_waitcnt lgkmcnt(5)
    v_mfma_f32_32x32x16_bf16 v[68:83], v[36:39], v[28:31], v[68:83]
    v_mfma_f32_32x32x16_bf16 v[84:99], v[36:39], v[32:35], v[84:99]
    v_mfma_f32_32x32x16_bf16 v[100:115], v[40:43], v[28:31], v[100:115]
    v_mfma_f32_32x32x16_bf16 v[116:131], v[40:43], v[32:35], v[116:131]
    v_mfma_f32_32x32x16_bf16 v[132:147], v[44:47], v[28:31], v[132:147]
    v_mfma_f32_32x32x16_bf16 v[148:163], v[44:47], v[32:35], v[148:163]
    ds_read_b128 v[28:31], v20 offset:0
    ds_read_b128 v[32:35], v20 offset:4096
    ds_read_b128 v[36:39], v24 offset:0
    ds_read_b128 v[40:43], v24 offset:4096
    ds_read_b128 v[44:47], v24 offset:8192
    s_waitcnt lgkmcnt(5)
    v_mfma_f32_32x32x16_bf16 v[68:83], v[56:59], v[48:51], v[68:83]
    v_mfma_f32_32x32x16_bf16 v[84:99], v[56:59], v[52:55], v[84:99]
    v_mfma_f32_32x32x16_bf16 v[100:115], v[60:63], v[48:51], v[100:115]
    v_mfma_f32_32x32x16_bf16 v[116:131], v[60:63], v[52:55], v[116:131]
    v_mfma_f32_32x32x16_bf16 v[132:147], v[64:67], v[48:51], v[132:147]
    v_mfma_f32_32x32x16_bf16 v[148:163], v[64:67], v[52:55], v[148:163]
    ds_read_b128 v[48:51], v21 offset:0
    ds_read_b128 v[52:55], v21 offset:4096
    ds_read_b128 v[56:59], v25 offset:0
    ds_read_b128 v[60:63], v25 offset:4096
    ds_read_b128 v[64:67], v25 offset:8192
    s_waitcnt lgkmcnt(5)
    v_mfma_f32_32x32x16_bf16 v[68:83], v[36:39], v[28:31], v[68:83]
    v_mfma_f32_32x32x16_bf16 v[84:99], v[36:39], v[32:35], v[84:99]
    v_mfma_f32_32x32x16_bf16 v[100:115], v[40:43], v[28:31], v[100:115]
    v_mfma_f32_32x32x16_bf16 v[116:131], v[40:43], v[32:35], v[116:131]
    v_mfma_f32_32x32x16_bf16 v[132:147], v[44:47], v[28:31], v[132:147]
    v_mfma_f32_32x32x16_bf16 v[148:163], v[44:47], v[32:35], v[148:163]
    s_waitcnt vmcnt(0)
    s_barrier
    ds_read_b128 v[28:31], v18 offset:16384
    ds_read_b128 v[32:35], v18 offset:20480
    ds_read_b128 v[36:39], v22 offset:24576
    ds_read_b128 v[40:43], v22 offset:28672
    ds_read_b128 v[44:47], v22 offset:32768
    s_add_u32 m0, s30, 32768
    s_nop 0
    buffer_load_dwordx4 v2, s[8:11], s26 offen lds
    s_add_u32 m0, s30, 36864
    s_nop 0
    buffer_load_dwordx4 v3, s[8:11], s26 offen lds
    s_add_u32 m0, s30, 40960
    s_nop 0
    buffer_load_dwordx4 v4, s[8:11], s26 offen lds
    s_add_u32 m0, s30, 45056
    s_nop 0
    buffer_load_dwordx4 v5, s[8:11], s26 offen lds
    s_add_u32 m0, s30, 98304
    s_nop 0
    buffer_load_dwordx4 v6, s[12:15], s26 offen lds
    s_add_u32 m0, s30, 102400
    s_nop 0
    buffer_load_dwordx4 v7, s[12:15], s26 offen lds
    s_add_u32 m0, s30, 106496
    s_nop 0
    buffer_load_dwordx4 v8, s[12:15], s26 offen lds
    s_add_u32 m0, s30, 110592
    s_nop 0
    buffer_load_dwordx4 v9, s[12:15], s26 offen lds
    s_add_u32 m0, s30, 114688
    s_nop 0
    buffer_load_dwordx4 v10, s[12:15], s26 offen lds
    s_add_u32 m0, s30, 118784
    s_nop 0
    buffer_load_dwordx4 v11, s[12:15], s26 offen lds
    s_add_u32 s26, s26, 128
    s_waitcnt lgkmcnt(5)
    v_mfma_f32_32x32x16_bf16 v[68:83], v[56:59], v[48:51], v[68:83]
    v_mfma_f32_32x32x16_bf16 v[84:99], v[56:59], v[52:55], v[84:99]
    v_mfma_f32_32x32x16_bf16 v[100:115], v[60:63], v[48:51], v[100:115]
    v_mfma_f32_32x32x16_bf16 v[116:131], v[60:63], v[52:55], v[116:131]
    v_mfma_f32_32x32x16_bf16 v[132:147], v[64:67], v[48:51], v[132:147]
    v_mfma_f32_32x32x16_bf16 v[148:163], v[64:67], v[52:55], v[148:163]
    ds_read_b128 v[48:51], v19 offset:16384
    ds_read_b128 v[52:55], v19 offset:20480
    ds_read_b128 v[56:59], v23 offset:24576
    ds_read_b128 v[60:63], v23 offset:28672
    ds_read_b128 v[64:67], v23 offset:32768
    s_waitcnt lgkmcnt(5)
    v_mfma_f32_32x32x16_bf16 v[68:83], v[36:39], v[28:31], v[68:83]
    v_mfma_f32_32x32x16_bf16 v[84:99], v[36:39], v[32:35], v[84:99]
    v_mfma_f32_32x32x16_bf16 v[100:115], v[40:43], v[28:31], v[100:115]
    v_mfma_f32_32x32x16_bf16 v[116:131], v[40:43], v[32:35], v[116:131]
    v_mfma_f32_32x32x16_bf16 v[132:147], v[44:47], v[28:31], v[132:147]
    v_mfma_f32_32x32x16_bf16 v[148:163], v[44:47], v[32:35], v[148:163]
    ds_read_b128 v[28:31], v20 offset:16384
    ds_read_b128 v[32:35], v20 offset:20480
    ds_read_b128 v[36:39], v24 offset:24576
    ds_read_b128 v[40:43], v24 offset:28672
    ds_read_b128 v[44:47], v24 offset:32768
    s_waitcnt lgkmcnt(5)
    v_mfma_f32_32x32x16_bf16 v[68:83], v[56:59], v[48:51], v[68:83]
    v_mfma_f32_32x32x16_bf16 v[84:99], v[56:59], v[52:55], v[84:99]
    v_mfma_f32_32x32x16_bf16 v[100:115], v[60:63], v[48:51], v[100:115]
    v_mfma_f32_32x32x16_bf16 v[116:131], v[60:63], v[52:55], v[116:131]
    v_mfma_f32_32x32x16_bf16 v[132:147], v[64:67], v[48:51], v[132:147]
    v_mfma_f32_32x32x16_bf16 v[148:163], v[64:67], v[52:55], v[148:163]
    ds_read_b128 v[48:51], v21 offset:16384
    ds_read_b128 v[52:55], v21 offset:20480
    ds_read_b128 v[56:59], v25 offset:24576
    ds_read_b128 v[60:63], v25 offset:28672
    ds_read_b128 v[64:67], v25 offset:32768
    s_waitcnt lgkmcnt(5)
    v_mfma_f32_32x32x16_bf16 v[68:83], v[36:39], v[28:31], v[68:83]
    v_mfma_f32_32x32x16_bf16 v[84:99], v[36:39], v[32:35], v[84:99]
    v_mfma_f32_32x32x16_bf16 v[100:115], v[40:43], v[28:31], v[100:115]
    v_mfma_f32_32x32x16_bf16 v[116:131], v[40:43], v[32:35], v[116:131]
    v_mfma_f32_32x32x16_bf16 v[132:147], v[44:47], v[28:31], v[132:147]
    v_mfma_f32_32x32x16_bf16 v[148:163], v[44:47], v[32:35], v[148:163]
    s_waitcnt vmcnt(0)
    s_barrier
    ds_read_b128 v[28:31], v18 offset:32768
    ds_read_b128 v[32:35], v18 offset:36864
    ds_read_b128 v[36:39], v22 offset:49152
    ds_read_b128 v[40:43], v22 offset:53248
    ds_read_b128 v[44:47], v22 offset:57344
    s_add_u32 m0, s30, 0
    s_nop 0
    buffer_load_dwordx4 v2, s[8:11], s26 offen lds
    s_add_u32 m0, s30, 4096
    s_nop 0
    buffer_load_dwordx4 v3, s[8:11], s26 offen lds
    s_add_u32 m0, s30, 8192
    s_nop 0
    buffer_load_dwordx4 v4, s[8:11], s26 offen lds
    s_add_u32 m0, s30, 12288
    s_nop 0
    buffer_load_dwordx4 v5, s[8:11], s26 offen lds
    s_add_u32 m0, s30, 49152
    s_nop 0
    buffer_load_dwordx4 v6, s[12:15], s26 offen lds
    s_add_u32 m0, s30, 53248
    s_nop 0
    buffer_load_dwordx4 v7, s[12:15], s26 offen lds
    s_add_u32 m0, s30, 57344
    s_nop 0
    buffer_load_dwordx4 v8, s[12:15], s26 offen lds
    s_add_u32 m0, s30, 61440
    s_nop 0
    buffer_load_dwordx4 v9, s[12:15], s26 offen lds
    s_add_u32 m0, s30, 65536
    s_nop 0
    buffer_load_dwordx4 v10, s[12:15], s26 offen lds
    s_add_u32 m0, s30, 69632
    s_nop 0
    buffer_load_dwordx4 v11, s[12:15], s26 offen lds
    s_add_u32 s26, s26, 128
    s_waitcnt lgkmcnt(5)
    v_mfma_f32_32x32x16_bf16 v[68:83], v[56:59], v[48:51], v[68:83]
    v_mfma_f32_32x32x16_bf16 v[84:99], v[56:59], v[52:55], v[84:99]
    v_mfma_f32_32x32x16_bf16 v[100:115], v[60:63], v[48:51], v[100:115]
    v_mfma_f32_32x32x16_bf16 v[116:131], v[60:63], v[52:55], v[116:131]
    v_mfma_f32_32x32x16_bf16 v[132:147], v[64:67], v[48:51], v[132:147]
    v_mfma_f32_32x32x16_bf16 v[148:163], v[64:67], v[52:55], v[148:163]
    ds_read_b128 v[48:51], v19 offset:32768
    ds_read_b128 v[52:55], v19 offset:36864
    ds_read_b128 v[56:59], v23 offset:49152
    ds_read_b128 v[60:63], v23 offset:53248
    ds_read_b128 v[64:67], v23 offset:57344
    s_waitcnt lgkmcnt(5)
    v_mfma_f32_32x32x16_bf16 v[68:83], v[36:39], v[28:31], v[68:83]
    v_mfma_f32_32x32x16_bf16 v[84:99], v[36:39], v[32:35], v[84:99]
    v_mfma_f32_32x32x16_bf16 v[100:115], v[40:43], v[28:31], v[100:115]
    v_mfma_f32_32x32x16_bf16 v[116:131], v[40:43], v[32:35], v[116:131]
    v_mfma_f32_32x32x16_bf16 v[132:147], v[44:47], v[28:31], v[132:147]
    v_mfma_f32_32x32x16_bf16 v[148:163], v[44:47], v[32:35], v[148:163]
    ds_read_b128 v[28:31], v20 offset:32768
    ds_read_b128 v[32:35], v20 offset:36864
    ds_read_b128 v[36:39], v24 offset:49152
    ds_read_b128 v[40:43], v24 offset:53248
    ds_read_b128 v[44:47], v24 offset:57344
    s_waitcnt lgkmcnt(5)
    v_mfma_f32_32x32x16_bf16 v[68:83], v[56:59], v[48:51], v[68:83]
    v_mfma_f32_32x32x16_bf16 v[84:99], v[56:59], v[52:55], v[84:99]
    v_mfma_f32_32x32x16_bf16 v[100:115], v[60:63], v[48:51], v[100:115]
    v_mfma_f32_32x32x16_bf16 v[116:131], v[60:63], v[52:55], v[116:131]
    v_mfma_f32_32x32x16_bf16 v[132:147], v[64:67], v[48:51], v[132:147]
    v_mfma_f32_32x32x16_bf16 v[148:163], v[64:67], v[52:55], v[148:163]
    ds_read_b128 v[48:51], v21 offset:32768
    ds_read_b128 v[52:55], v21 offset:36864
    ds_read_b128 v[56:59], v25 offset:49152
    ds_read_b128 v[60:63], v25 offset:53248
    ds_read_b128 v[64:67], v25 offset:57344
    s_waitcnt lgkmcnt(5)
    v_mfma_f32_32x32x16_bf16 v[68:83], v[36:39], v[28:31], v[68:83]
    v_mfma_f32_32x32x16_bf16 v[84:99], v[36:39], v[32:35], v[84:99]
    v_mfma_f32_32x32x16_bf16 v[100:115], v[40:43], v[28:31], v[100:115]
    v_mfma_f32_32x32x16_bf16 v[116:131], v[40:43], v[32:35], v[116:131]
    v_mfma_f32_32x32x16_bf16 v[132:147], v[44:47], v[28:31], v[132:147]
    v_mfma_f32_32x32x16_bf16 v[148:163], v[44:47], v[32:35], v[148:163]
    s_waitcnt vmcnt(0)
    s_barrier
    ds_read_b128 v[28:31], v18 offset:0
    ds_read_b128 v[32:35], v18 offset:4096
    ds_read_b128 v[36:39], v22 offset:0
    ds_read_b128 v[40:43], v22 offset:4096
    ds_read_b128 v[44:47], v22 offset:8192
    s_add_u32 m0, s30, 16384
    s_nop 0
    buffer_load_dwordx4 v2, s[8:11], s26 offen lds
    s_add_u32 m0, s30, 20480
    s_nop 0
    buffer_load_dwordx4 v3, s[8:11], s26 offen lds
    s_add_u32 m0, s30, 24576
    s_nop 0
    buffer_load_dwordx4 v4, s[8:11], s26 offen lds
    s_add_u32 m0, s30, 28672
    s_nop 0
    buffer_load_dwordx4 v5, s[8:11], s26 offen lds
    s_add_u32 m0, s30, 73728
    s_nop 0
    buffer_load_dwordx4 v6, s[12:15], s26 offen lds
    s_add_u32 m0, s30, 77824
    s_nop 0
    buffer_load_dwordx4 v7, s[12:15], s26 offen lds
    s_add_u32 m0, s30, 81920
    s_nop 0
    buffer_load_dwordx4 v8, s[12:15], s26 offen lds
    s_add_u32 m0, s30, 86016
    s_nop 0
    buffer_load_dwordx4 v9, s[12:15], s26 offen lds
    s_add_u32 m0, s30, 90112
    s_nop 0
    buffer_load_dwordx4 v10, s[12:15], s26 offen lds
    s_add_u32 m0, s30, 94208
    s_nop 0
    buffer_load_dwordx4 v11, s[12:15], s26 offen lds
    s_add_u32 s26, s26, 128
    s_waitcnt lgkmcnt(5)
    v_mfma_f32_32x32x16_bf16 v[68:83], v[56:59], v[48:51], v[68:83]
    v_mfma_f32_32x32x16_bf16 v[84:99], v[56:59], v[52:55], v[84:99]
    v_mfma_f32_32x32x16_bf16 v[100:115], v[60:63], v[48:51], v[100:115]
    v_mfma_f32_32x32x16_bf16 v[116:131], v[60:63], v[52:55], v[116:131]
    v_mfma_f32_32x32x16_bf16 v[132:147], v[64:67], v[48:51], v[132:147]
    v_mfma_f32_32x32x16_bf16 v[148:163], v[64:67], v[52:55], v[148:163]
    s_add_u32 s27, s27, 1
    s_cmp_lt_u32 s27, 2
    s_cbranch_scc1 L_ffn1_kernel_loopm
    ds_read_b128 v[48:51], v19 offset:0
    ds_read_b128 v[52:55], v19 offset:4096
    ds_read_b128 v[56:59], v23 offset:0
    ds_read_b128 v[60:63], v23 offset:4096
    ds_read_b128 v[64:67], v23 offset:8192
    s_waitcnt lgkmcnt(5)
    v_mfma_f32_32x32x16_bf16 v[68:83], v[36:39], v[28:31], v[68:83]
    v_mfma_f32_32x32x16_bf16 v[84:99], v[36:39], v[32:35], v[84:99]
    v_mfma_f32_32x32x16_bf16 v[100:115], v[40:43], v[28:31], v[100:115]
    v_mfma_f32_32x32x16_bf16 v[116:131], v[40:43], v[32:35], v[116:131]
    v_mfma_f32_32x32x16_bf16 v[132:147], v[44:47], v[28:31], v[132:147]
    v_mfma_f32_32x32x16_bf16 v[148:163], v[44:47], v[32:35], v[148:163]
    ds_read_b128 v[28:31], v20 offset:0
    ds_read_b128 v[32:35], v20 offset:4096
    ds_read_b128 v[36:39], v24 offset:0
    ds_read_b128 v[40:43], v24 offset:4096
    ds_read_b128 v[44:47], v24 offset:8192
    s_waitcnt lgkmcnt(5)
    v_mfma_f32_32x32x16_bf16 v[68:83], v[56:59], v[48:51], v[68:83]
    v_mfma_f32_32x32x16_bf16 v[84:99], v[56:59], v[52:55], v[84:99]
    v_mfma_f32_32x32x16_bf16 v[100:115], v[60:63], v[48:51], v[100:115]
    v_mfma_f32_32x32x16_bf16 v[116:131], v[60:63], v[52:55], v[116:131]
    v_mfma_f32_32x32x16_bf16 v[132:147], v[64:67], v[48:51], v[132:147]
    v_mfma_f32_32x32x16_bf16 v[148:163], v[64:67], v[52:55], v[148:163]
    ds_read_b128 v[48:51], v21 offset:0
    ds_read_b128 v[52:55], v21 offset:4096
    ds_read_b128 v[56:59], v25 offset:0
    ds_read_b128 v[60:63], v25 offset:4096
    ds_read_b128 v[64:67], v25 offset:8192
    s_waitcnt lgkmcnt(5)
    v_mfma_f32_32x32x16_bf16 v[68:83], v[36:39], v[28:31], v[68:83]
    v_mfma_f32_32x32x16_bf16 v[84:99], v[36:39], v[32:35], v[84:99]
    v_mfma_f32_32x32x16_bf16 v[100:115], v[40:43], v[28:31], v[100:115]
    v_mfma_f32_32x32x16_bf16 v[116:131], v[40:43], v[32:35], v[116:131]
    v_mfma_f32_32x32x16_bf16 v[132:147], v[44:47], v[28:31], v[132:147]
    v_mfma_f32_32x32x16_bf16 v[148:163], v[44:47], v[32:35], v[148:163]
    s_waitcnt vmcnt(0)
    s_barrier
    ds_read_b128 v[28:31], v18 offset:16384
    ds_read_b128 v[32:35], v18 offset:20480
    ds_read_b128 v[36:39], v22 offset:24576
    ds_read_b128 v[40:43], v22 offset:28672
    ds_read_b128 v[44:47], v22 offset:32768
    s_add_u32 m0, s30, 32768
    s_nop 0
    buffer_load_dwordx4 v2, s[8:11], s26 offen lds
    s_add_u32 m0, s30, 36864
    s_nop 0
    buffer_load_dwordx4 v3, s[8:11], s26 offen lds
    s_add_u32 m0, s30, 40960
    s_nop 0
    buffer_load_dwordx4 v4, s[8:11], s26 offen lds
    s_add_u32 m0, s30, 45056
    s_nop 0
    buffer_load_dwordx4 v5, s[8:11], s26 offen lds
    s_add_u32 m0, s30, 98304
    s_nop 0
    buffer_load_dwordx4 v6, s[12:15], s26 offen lds
    s_add_u32 m0, s30, 102400
    s_nop 0
    buffer_load_dwordx4 v7, s[12:15], s26 offen lds
    s_add_u32 m0, s30, 106496
    s_nop 0
    buffer_load_dwordx4 v8, s[12:15], s26 offen lds
    s_add_u32 m0, s30, 110592
    s_nop 0
    buffer_load_dwordx4 v9, s[12:15], s26 offen lds
    s_add_u32 m0, s30, 114688
    s_nop 0
    buffer_load_dwordx4 v10, s[12:15], s26 offen lds
    s_add_u32 m0, s30, 118784
    s_nop 0
    buffer_load_dwordx4 v11, s[12:15], s26 offen lds
    s_add_u32 s26, s26, 128
    s_waitcnt lgkmcnt(5)
    v_mfma_f32_32x32x16_bf16 v[68:83], v[56:59], v[48:51], v[68:83]
    v_mfma_f32_32x32x16_bf16 v[84:99], v[56:59], v[52:55], v[84:99]
    v_mfma_f32_32x32x16_bf16 v[100:115], v[60:63], v[48:51], v[100:115]
    v_mfma_f32_32x32x16_bf16 v[116:131], v[60:63], v[52:55], v[116:131]
    v_mfma_f32_32x32x16_bf16 v[132:147], v[64:67], v[48:51], v[132:147]
    v_mfma_f32_32x32x16_bf16 v[148:163], v[64:67], v[52:55], v[148:163]
    ds_read_b128 v[48:51], v19 offset:16384
    ds_read_b128 v[52:55], v19 offset:20480
    ds_read_b128 v[56:59], v23 offset:24576
    ds_read_b128 v[60:63], v23 offset:28672
    ds_read_b128 v[64:67], v23 offset:32768
    s_waitcnt lgkmcnt(5)
    v_mfma_f32_32x32x16_bf16 v[68:83], v[36:39], v[28:31], v[68:83]
    v_mfma_f32_32x32x16_bf16 v[84:99], v[36:39], v[32:35], v[84:99]
    v_mfma_f32_32x32x16_bf16 v[100:115], v[40:43], v[28:31], v[100:115]
    v_mfma_f32_32x32x16_bf16 v[116:131], v[40:43], v[32:35], v[116:131]
    v_mfma_f32_32x32x16_bf16 v[132:147], v[44:47], v[28:31], v[132:147]
    v_mfma_f32_32x32x16_bf16 v[148:163], v[44:47], v[32:35], v[148:163]
    ds_read_b128 v[28:31], v20 offset:16384
    ds_read_b128 v[32:35], v20 offset:20480
    ds_read_b128 v[36:39], v24 offset:24576
    ds_read_b128 v[40:43], v24 offset:28672
    ds_read_b128 v[44:47], v24 offset:32768
    s_waitcnt lgkmcnt(5)
    v_mfma_f32_32x32x16_bf16 v[68:83], v[56:59], v[48:51], v[68:83]
    v_mfma_f32_32x32x16_bf16 v[84:99], v[56:59], v[52:55], v[84:99]
    v_mfma_f32_32x32x16_bf16 v[100:115], v[60:63], v[48:51], v[100:115]
    v_mfma_f32_32x32x16_bf16 v[116:131], v[60:63], v[52:55], v[116:131]
    v_mfma_f32_32x32x16_bf16 v[132:147], v[64:67], v[48:51], v[132:147]
    v_mfma_f32_32x32x16_bf16 v[148:163], v[64:67], v[52:55], v[148:163]
    ds_read_b128 v[48:51], v21 offset:16384
    ds_read_b128 v[52:55], v21 offset:20480
    ds_read_b128 v[56:59], v25 offset:24576
    ds_read_b128 v[60:63], v25 offset:28672
    ds_read_b128 v[64:67], v25 offset:32768
    s_waitcnt lgkmcnt(5)
    v_mfma_f32_32x32x16_bf16 v[68:83], v[36:39], v[28:31], v[68:83]
    v_mfma_f32_32x32x16_bf16 v[84:99], v[36:39], v[32:35], v[84:99]
    v_mfma_f32_32x32x16_bf16 v[100:115], v[40:43], v[28:31], v[100:115]
    v_mfma_f32_32x32x16_bf16 v[116:131], v[40:43], v[32:35], v[116:131]
    v_mfma_f32_32x32x16_bf16 v[132:147], v[44:47], v[28:31], v[132:147]
    v_mfma_f32_32x32x16_bf16 v[148:163], v[44:47], v[32:35], v[148:163]
    s_waitcnt vmcnt(0)
    s_barrier
    ds_read_b128 v[28:31], v18 offset:32768
    ds_read_b128 v[32:35], v18 offset:36864
    ds_read_b128 v[36:39], v22 offset:49152
    ds_read_b128 v[40:43], v22 offset:53248
    ds_read_b128 v[44:47], v22 offset:57344
    s_add_u32 m0, s30, 0
    s_nop 0
    buffer_load_dwordx4 v2, s[8:11], s26 offen lds
    s_add_u32 m0, s30, 4096
    s_nop 0
    buffer_load_dwordx4 v3, s[8:11], s26 offen lds
    s_add_u32 m0, s30, 8192
    s_nop 0
    buffer_load_dwordx4 v4, s[8:11], s26 offen lds
    s_add_u32 m0, s30, 12288
    s_nop 0
    buffer_load_dwordx4 v5, s[8:11], s26 offen lds
    s_add_u32 m0, s30, 49152
    s_nop 0
    buffer_load_dwordx4 v6, s[12:15], s26 offen lds
    s_add_u32 m0, s30, 53248
    s_nop 0
    buffer_load_dwordx4 v7, s[12:15], s26 offen lds
    s_add_u32 m0, s30, 57344
    s_nop 0
    buffer_load_dwordx4 v8, s[12:15], s26 offen lds
    s_add_u32 m0, s30, 61440
    s_nop 0
    buffer_load_dwordx4 v9, s[12:15], s26 offen lds
    s_add_u32 m0, s30, 65536
    s_nop 0
    buffer_load_dwordx4 v10, s[12:15], s26 offen lds
    s_add_u32 m0, s30, 69632
    s_nop 0
    buffer_load_dwordx4 v11, s[12:15], s26 offen lds
    s_add_u32 s26, s26, 128
    s_waitcnt lgkmcnt(5)
    v_mfma_f32_32x32x16_bf16 v[68:83], v[56:59], v[48:51], v[68:83]
    v_mfma_f32_32x32x16_bf16 v[84:99], v[56:59], v[52:55], v[84:99]
    v_mfma_f32_32x32x16_bf16 v[100:115], v[60:63], v[48:51], v[100:115]
    v_mfma_f32_32x32x16_bf16 v[116:131], v[60:63], v[52:55], v[116:131]
    v_mfma_f32_32x32x16_bf16 v[132:147], v[64:67], v[48:51], v[132:147]
    v_mfma_f32_32x32x16_bf16 v[148:163], v[64:67], v[52:55], v[148:163]
    ds_read_b128 v[48:51], v19 offset:32768
    ds_read_b128 v[52:55], v19 offset:36864
    ds_read_b128 v[56:59], v23 offset:49152
    ds_read_b128 v[60:63], v23 offset:53248
    ds_read_b128 v[64:67], v23 offset:57344
    s_waitcnt lgkmcnt(5)
    v_mfma_f32_32x32x16_bf16 v[68:83], v[36:39], v[28:31], v[68:83]
    v_mfma_f32_32x32x16_bf16 v[84:99], v[36:39], v[32:35], v[84:99]
    v_mfma_f32_32x32x16_bf16 v[100:115], v[40:43], v[28:31], v[100:115]
    v_mfma_f32_32x32x16_bf16 v[116:131], v[40:43], v[32:35], v[116:131]
    v_mfma_f32_32x32x16_bf16 v[132:147], v[44:47], v[28:31], v[132:147]
    v_mfma_f32_32x32x16_bf16 v[148:163], v[44:47], v[32:35], v[148:163]
    ds_read_b128 v[28:31], v20 offset:32768
    ds_read_b128 v[32:35], v20 offset:36864
    ds_read_b128 v[36:39], v24 offset:49152
    ds_read_b128 v[40:43], v24 offset:53248
    ds_read_b128 v[44:47], v24 offset:57344
    s_waitcnt lgkmcnt(5)
    v_mfma_f32_32x32x16_bf16 v[68:83], v[56:59], v[48:51], v[68:83]
    v_mfma_f32_32x32x16_bf16 v[84:99], v[56:59], v[52:55], v[84:99]
    v_mfma_f32_32x32x16_bf16 v[100:115], v[60:63], v[48:51], v[100:115]
    v_mfma_f32_32x32x16_bf16 v[116:131], v[60:63], v[52:55], v[116:131]
    v_mfma_f32_32x32x16_bf16 v[132:147], v[64:67], v[48:51], v[132:147]
    v_mfma_f32_32x32x16_bf16 v[148:163], v[64:67], v[52:55], v[148:163]
    ds_read_b128 v[48:51], v21 offset:32768
    ds_read_b128 v[52:55], v21 offset:36864
    ds_read_b128 v[56:59], v25 offset:49152
    ds_read_b128 v[60:63], v25 offset:53248
    ds_read_b128 v[64:67], v25 offset:57344
    s_waitcnt lgkmcnt(5)
    v_mfma_f32_32x32x16_bf16 v[68:83], v[36:39], v[28:31], v[68:83]
    v_mfma_f32_32x32x16_bf16 v[84:99], v[36:39], v[32:35], v[84:99]
    v_mfma_f32_32x32x16_bf16 v[100:115], v[40:43], v[28:31], v[100:115]
    v_mfma_f32_32x32x16_bf16 v[116:131], v[40:43], v[32:35], v[116:131]
    v_mfma_f32_32x32x16_bf16 v[132:147], v[44:47], v[28:31], v[132:147]
    v_mfma_f32_32x32x16_bf16 v[148:163], v[44:47], v[32:35], v[148:163]
    s_waitcnt vmcnt(0)
    s_barrier
    ds_read_b128 v[28:31], v18 offset:0
    ds_read_b128 v[32:35], v18 offset:4096
    ds_read_b128 v[36:39], v22 offset:0
    ds_read_b128 v[40:43], v22 offset:4096
    ds_read_b128 v[44:47], v22 offset:8192
    s_waitcnt lgkmcnt(5)
    v_mfma_f32_32x32x16_bf16 v[68:83], v[56:59], v[48:51], v[68:83]
    v_mfma_f32_32x32x16_bf16 v[84:99], v[56:59], v[52:55], v[84:99]
    v_mfma_f32_32x32x16_bf16 v[100:115], v[60:63], v[48:51], v[100:115]
    v_mfma_f32_32x32x16_bf16 v[116:131], v[60:63], v[52:55], v[116:131]
    v_mfma_f32_32x32x16_bf16 v[132:147], v[64:67], v[48:51], v[132:147]
    v_mfma_f32_32x32x16_bf16 v[148:163], v[64:67], v[52:55], v[148:163]
    ds_read_b128 v[48:51], v19 offset:0
    ds_read_b128 v[52:55], v19 offset:4096
    ds_read_b128 v[56:59], v23 offset:0
    ds_read_b128 v[60:63], v23 offset:4096
    ds_read_b128 v[64:67], v23 offset:8192
    s_waitcnt lgkmcnt(5)
    v_mfma_f32_32x32x16_bf16 v[68:83], v[36:39], v[28:31], v[68:83]
    v_mfma_f32_32x32x16_bf16 v[84:99], v[36:39], v[32:35], v[84:99]
    v_mfma_f32_32x32x16_bf16 v[100:115], v[40:43], v[28:31], v[100:115]
    v_mfma_f32_32x32x16_bf16 v[116:131], v[40:43], v[32:35], v[116:131]
    v_mfma_f32_32x32x16_bf16 v[132:147], v[44:47], v[28:31], v[132:147]
    v_mfma_f32_32x32x16_bf16 v[148:163], v[44:47], v[32:35], v[148:163]
    ds_read_b128 v[28:31], v20 offset:0
    ds_read_b128 v[32:35], v20 offset:4096
    ds_read_b128 v[36:39], v24 offset:0
    ds_read_b128 v[40:43], v24 offset:4096
    ds_read_b128 v[44:47], v24 offset:8192
    s_waitcnt lgkmcnt(5)
    v_mfma_f32_32x32x16_bf16 v[68:83], v[56:59], v[48:51], v[68:83]
    v_mfma_f32_32x32x16_bf16 v[84:99], v[56:59], v[52:55], v[84:99]
    v_mfma_f32_32x32x16_bf16 v[100:115], v[60:63], v[48:51], v[100:115]
    v_mfma_f32_32x32x16_bf16 v[116:131], v[60:63], v[52:55], v[116:131]
    v_mfma_f32_32x32x16_bf16 v[132:147], v[64:67], v[48:51], v[132:147]
    v_mfma_f32_32x32x16_bf16 v[148:163], v[64:67], v[52:55], v[148:163]
    ds_read_b128 v[48:51], v21 offset:0
    ds_read_b128 v[52:55], v21 offset:4096
    ds_read_b128 v[56:59], v25 offset:0
    ds_read_b128 v[60:63], v25 offset:4096
    ds_read_b128 v[64:67], v25 offset:8192
    s_waitcnt lgkmcnt(5)
    v_mfma_f32_32x32x16_bf16 v[68:83], v[36:39], v[28:31], v[68:83]
    v_mfma_f32_32x32x16_bf16 v[84:99], v[36:39], v[32:35], v[84:99]
    v_mfma_f32_32x32x16_bf16 v[100:115], v[40:43], v[28:31], v[100:115]
    v_mfma_f32_32x32x16_bf16 v[116:131], v[40:43], v[32:35], v[116:131]
    v_mfma_f32_32x32x16_bf16 v[132:147], v[44:47], v[28:31], v[132:147]
    v_mfma_f32_32x32x16_bf16 v[148:163], v[44:47], v[32:35], v[148:163]
    s_waitcnt lgkmcnt(0)
    v_mfma_f32_32x32x16_bf16 v[68:83], v[56:59], v[48:51], v[68:83]
    v_mfma_f32_32x32x16_bf16 v[84:99], v[56:59], v[52:55], v[84:99]
    v_mfma_f32_32x32x16_bf16 v[100:115], v[60:63], v[48:51], v[100:115]
    v_mfma_f32_32x32x16_bf16 v[116:131], v[60:63], v[52:55], v[116:131]
    v_mfma_f32_32x32x16_bf16 v[132:147], v[64:67], v[48:51], v[132:147]
    v_mfma_f32_32x32x16_bf16 v[148:163], v[64:67], v[52:55], v[148:163]
    s_nop 15
    s_nop 3
    s_add_u32 s16, s4, 0x9a00000
    s_addc_u32 s17, s5, 0
    s_and_b32 s17, s17, 0xffff
    s_mov_b32 s18, 0x600000
    s_mov_b32 s19, 0x20000
    v_lshrrev_b32 v1, 6, v0
    v_and_b32 v2, 1, v1
    v_lshrrev_b32 v3, 1, v1
    v_mul_u32_u24 v2, 64, v2
    v_mul_u32_u24 v3, 96, v3
    v_and_b32 v1, 31, v0
    v_bfe_u32 v4, v0, 5, 1
    v_lshlrev_b32 v4, 2, v4
    s_lshr_b32 s31, s30, 10
    s_mul_i32 s31, s31, 7168
    v_mul_u32_u24 v5, 112, v1
    v_lshl_add_u32 v5, v4, 1, v5
    v_add_u32 v5, s31, v5
    v_add_u32 v2, s22, v2
    v_add_u32 v3, s23, v3
    v_and_b32 v1, 63, v0
    s_mov_b32 s24, 43691
    v_add_u32 v4, 0, v1
    v_mul_lo_u32 v6, v4, s24
    v_lshrrev_b32 v6, 18, v6
    v_mul_u32_u24 v7, 6, v6
    v_sub_u32 v4, v4, v7
    v_lshlrev_b32 v4, 4, v4
    v_mul_u32_u24 v7, 112, v6
    v_add3_u32 v28, v7, v4, s31
    v_add_u32 v6, v6, v2
    v_mul_u32_u24 v6, 3072, v6
    v_add3_u32 v36, v6, v4, v3
    v_add_u32 v4, 64, v1
    v_mul_lo_u32 v6, v4, s24
    v_lshrrev_b32 v6, 18, v6
    v_mul_u32_u24 v7, 6, v6
    v_sub_u32 v4, v4, v7
    v_lshlrev_b32 v4, 4, v4
    v_mul_u32_u24 v7, 112, v6
    v_add3_u32 v29, v7, v4, s31
    v_add_u32 v6, v6, v2
    v_mul_u32_u24 v6, 3072, v6
    v_add3_u32 v37, v6, v4, v3
    v_add_u32 v4, 128, v1
    v_mul_lo_u32 v6, v4, s24
    v_lshrrev_b32 v6, 18, v6
    v_mul_u32_u24 v7, 6, v6
    v_sub_u32 v4, v4, v7
    v_lshlrev_b32 v4, 4, v4
    v_mul_u32_u24 v7, 112, v6
    v_add3_u32 v30, v7, v4, s31
    v_add_u32 v6, v6, v2
    v_mul_u32_u24 v6, 3072, v6
    v_add3_u32 v38, v6, v4, v3
    v_add_u32 v4, 192, v1
    v_mul_lo_u32 v6, v4, s24
    v_lshrrev_b32 v6, 18, v6
    v_mul_u32_u24 v7, 6, v6
    v_sub_u32 v4, v4, v7
    v_lshlrev_b32 v4, 4, v4
    v_mul_u32_u24 v7, 112, v6
    v_add3_u32 v31, v7, v4, s31
    v_add_u32 v6, v6, v2
    v_mul_u32_u24 v6, 3072, v6
    v_add3_u32 v39, v6, v4, v3
    v_add_u32 v4, 256, v1
    v_mul_lo_u32 v6, v4, s24
    v_lshrrev_b32 v6, 18, v6
    v_mul_u32_u24 v7, 6, v6
    v_sub_u32 v4, v4, v7
    v_lshlrev_b32 v4, 4, v4
    v_mul_u32_u24 v7, 112, v6
    v_add3_u32 v32, v7, v4, s31
    v_add_u32 v6, v6, v2
    v_mul_u32_u24 v6, 3072, v6
    v_add3_u32 v40, v6, v4, v3
    v_add_u32 v4, 320, v1
    v_mul_lo_u32 v6, v4, s24
    v_lshrrev_b32 v6, 18, v6
    v_mul_u32_u24 v7, 6, v6
    v_sub_u32 v4, v4, v7
    v_lshlrev_b32 v4, 4, v4
    v_mul_u32_u24 v7, 112, v6
    v_add3_u32 v33, v7, v4, s31
    v_add_u32 v6, v6, v2
    v_mul_u32_u24 v6, 3072, v6
    v_add3_u32 v41, v6, v4, v3
    s_barrier
    v_cvt_pk_bf16_f32 v166, v68, v69
    v_cvt_pk_bf16_f32 v167, v72, v73
    v_lshlrev_b32 v168, 16, v166
    v_and_b32 v169, 0xffff0000, v166
    v_lshlrev_b32 v170, 16, v167
    v_and_b32 v171, 0xffff0000, v167
    v_mul_f32 v168, v168, v170
    v_mul_f32 v169, v169, v171
    v_cvt_pk_bf16_f32 v68, v168, v169
    v_cvt_pk_bf16_f32 v166, v70, v71
    v_cvt_pk_bf16_f32 v167, v74, v75
    v_lshlrev_b32 v168, 16, v166
    v_and_b32 v169, 0xffff0000, v166
    v_lshlrev_b32 v170, 16, v167
    v_and_b32 v171, 0xffff0000, v167
    v_mul_f32 v168, v168, v170
    v_mul_f32 v169, v169, v171
    v_cvt_pk_bf16_f32 v69, v168, v169
    ds_write_b64 v5, v[68:69] offset:0
    v_cvt_pk_bf16_f32 v166, v76, v77
    v_cvt_pk_bf16_f32 v167, v80, v81
    v_lshlrev_b32 v168, 16, v166
    v_and_b32 v169, 0xffff0000, v166
    v_lshlrev_b32 v170, 16, v167
    v_and_b32 v171, 0xffff0000, v167
    v_mul_f32 v168, v168, v170
    v_mul_f32 v169, v169, v171
    v_cvt_pk_bf16_f32 v76, v168, v169
    v_cvt_pk_bf16_f32 v166, v78, v79
    v_cvt_pk_bf16_f32 v167, v82, v83
    v_lshlrev_b32 v168, 16, v166
    v_and_b32 v169, 0xffff0000, v166
    v_lshlrev_b32 v170, 16, v167
    v_and_b32 v171, 0xffff0000, v167
    v_mul_f32 v168, v168, v170
    v_mul_f32 v169, v169, v171
    v_cvt_pk_bf16_f32 v77, v168, v169
    ds_write_b64 v5, v[76:77] offset:16
    v_cvt_pk_bf16_f32 v166, v84, v85
    v_cvt_pk_bf16_f32 v167, v88, v89
    v_lshlrev_b32 v168, 16, v166
    v_and_b32 v169, 0xffff0000, v166
    v_lshlrev_b32 v170, 16, v167
    v_and_b32 v171, 0xffff0000, v167
    v_mul_f32 v168, v168, v170
    v_mul_f32 v169, v169, v171
    v_cvt_pk_bf16_f32 v84, v168, v169
    v_cvt_pk_bf16_f32 v166, v86, v87
    v_cvt_pk_bf16_f32 v167, v90, v91
    v_lshlrev_b32 v168, 16, v166
    v_and_b32 v169, 0xffff0000, v166
    v_lshlrev_b32 v170, 16, v167
    v_and_b32 v171, 0xffff0000, v167
    v_mul_f32 v168, v168, v170
    v_mul_f32 v169, v169, v171
    v_cvt_pk_bf16_f32 v85, v168, v169
    ds_write_b64 v5, v[84:85] offset:3584
    v_cvt_pk_bf16_f32 v166, v92, v93
    v_cvt_pk_bf16_f32 v167, v96, v97
    v_lshlrev_b32 v168, 16, v166
    v_and_b32 v169, 0xffff0000, v166
    v_lshlrev_b32 v170, 16, v167
    v_and_b32 v171, 0xffff0000, v167
    v_mul_f32 v168, v168, v170
    v_mul_f32 v169, v169, v171
    v_cvt_pk_bf16_f32 v92, v168, v169
    v_cvt_pk_bf16_f32 v166, v94, v95
    v_cvt_pk_bf16_f32 v167, v98, v99
    v_lshlrev_b32 v168, 16, v166
    v_and_b32 v169, 0xffff0000, v166
    v_lshlrev_b32 v170, 16, v167
    v_and_b32 v171, 0xffff0000, v167
    v_mul_f32 v168, v168, v170
    v_mul_f32 v169, v169, v171
    v_cvt_pk_bf16_f32 v93, v168, v169
    ds_write_b64 v5, v[92:93] offset:3600
    v_cvt_pk_bf16_f32 v166, v100, v101
    v_cvt_pk_bf16_f32 v167, v104, v105
    v_lshlrev_b32 v168, 16, v166
    v_and_b32 v169, 0xffff0000, v166
    v_lshlrev_b32 v170, 16, v167
    v_and_b32 v171, 0xffff0000, v167
    v_mul_f32 v168, v168, v170
    v_mul_f32 v169, v169, v171
    v_cvt_pk_bf16_f32 v100, v168, v169
    v_cvt_pk_bf16_f32 v166, v102, v103
    v_cvt_pk_bf16_f32 v167, v106, v107
    v_lshlrev_b32 v168, 16, v166
    v_and_b32 v169, 0xffff0000, v166
    v_lshlrev_b32 v170, 16, v167
    v_and_b32 v171, 0xffff0000, v167
    v_mul_f32 v168, v168, v170
    v_mul_f32 v169, v169, v171
    v_cvt_pk_bf16_f32 v101, v168, v169
    ds_write_b64 v5, v[100:101] offset:32
    v_cvt_pk_bf16_f32 v166, v108, v109
    v_cvt_pk_bf16_f32 v167, v112, v113
    v_lshlrev_b32 v168, 16, v166
    v_and_b32 v169, 0xffff0000, v166
    v_lshlrev_b32 v170, 16, v167
    v_and_b32 v171, 0xffff0000, v167
    v_mul_f32 v168, v168, v170
    v_mul_f32 v169, v169, v171
    v_cvt_pk_bf16_f32 v108, v168, v169
    v_cvt_pk_bf16_f32 v166, v110, v111
    v_cvt_pk_bf16_f32 v167, v114, v115
    v_lshlrev_b32 v168, 16, v166
    v_and_b32 v169, 0xffff0000, v166
    v_lshlrev_b32 v170, 16, v167
    v_and_b32 v171, 0xffff0000, v167
    v_mul_f32 v168, v168, v170
    v_mul_f32 v169, v169, v171
    v_cvt_pk_bf16_f32 v109, v168, v169
    ds_write_b64 v5, v[108:109] offset:48
    v_cvt_pk_bf16_f32 v166, v116, v117
    v_cvt_pk_bf16_f32 v167, v120, v121
    v_lshlrev_b32 v168, 16, v166
    v_and_b32 v169, 0xffff0000, v166
    v_lshlrev_b32 v170, 16, v167
    v_and_b32 v171, 0xffff0000, v167
    v_mul_f32 v168, v168, v170
    v_mul_f32 v169, v169, v171
    v_cvt_pk_bf16_f32 v116, v168, v169
    v_cvt_pk_bf16_f32 v166, v118, v119
    v_cvt_pk_bf16_f32 v167, v122, v123
    v_lshlrev_b32 v168, 16, v166
    v_and_b32 v169, 0xffff0000, v166
    v_lshlrev_b32 v170, 16, v167
    v_and_b32 v171, 0xffff0000, v167
    v_mul_f32 v168, v168, v170
    v_mul_f32 v169, v169, v171
    v_cvt_pk_bf16_f32 v117, v168, v169
    ds_write_b64 v5, v[116:117] offset:3616
    v_cvt_pk_bf16_f32 v166, v124, v125
    v_cvt_pk_bf16_f32 v167, v128, v129
    v_lshlrev_b32 v168, 16, v166
    v_and_b32 v169, 0xffff0000, v166
    v_lshlrev_b32 v170, 16, v167
    v_and_b32 v171, 0xffff0000, v167
    v_mul_f32 v168, v168, v170
    v_mul_f32 v169, v169, v171
    v_cvt_pk_bf16_f32 v124, v168, v169
    v_cvt_pk_bf16_f32 v166, v126, v127
    v_cvt_pk_bf16_f32 v167, v130, v131
    v_lshlrev_b32 v168, 16, v166
    v_and_b32 v169, 0xffff0000, v166
    v_lshlrev_b32 v170, 16, v167
    v_and_b32 v171, 0xffff0000, v167
    v_mul_f32 v168, v168, v170
    v_mul_f32 v169, v169, v171
    v_cvt_pk_bf16_f32 v125, v168, v169
    ds_write_b64 v5, v[124:125] offset:3632
    v_cvt_pk_bf16_f32 v166, v132, v133
    v_cvt_pk_bf16_f32 v167, v136, v137
    v_lshlrev_b32 v168, 16, v166
    v_and_b32 v169, 0xffff0000, v166
    v_lshlrev_b32 v170, 16, v167
    v_and_b32 v171, 0xffff0000, v167
    v_mul_f32 v168, v168, v170
    v_mul_f32 v169, v169, v171
    v_cvt_pk_bf16_f32 v132, v168, v169
    v_cvt_pk_bf16_f32 v166, v134, v135
    v_cvt_pk_bf16_f32 v167, v138, v139
    v_lshlrev_b32 v168, 16, v166
    v_and_b32 v169, 0xffff0000, v166
    v_lshlrev_b32 v170, 16, v167
    v_and_b32 v171, 0xffff0000, v167
    v_mul_f32 v168, v168, v170
    v_mul_f32 v169, v169, v171
    v_cvt_pk_bf16_f32 v133, v168, v169
    ds_write_b64 v5, v[132:133] offset:64
    v_cvt_pk_bf16_f32 v166, v140, v141
    v_cvt_pk_bf16_f32 v167, v144, v145
    v_lshlrev_b32 v168, 16, v166
    v_and_b32 v169, 0xffff0000, v166
    v_lshlrev_b32 v170, 16, v167
    v_and_b32 v171, 0xffff0000, v167
    v_mul_f32 v168, v168, v170
    v_mul_f32 v169, v169, v171
    v_cvt_pk_bf16_f32 v140, v168, v169
    v_cvt_pk_bf16_f32 v166, v142, v143
    v_cvt_pk_bf16_f32 v167, v146, v147
    v_lshlrev_b32 v168, 16, v166
    v_and_b32 v169, 0xffff0000, v166
    v_lshlrev_b32 v170, 16, v167
    v_and_b32 v171, 0xffff0000, v167
    v_mul_f32 v168, v168, v170
    v_mul_f32 v169, v169, v171
    v_cvt_pk_bf16_f32 v141, v168, v169
    ds_write_b64 v5, v[140:141] offset:80
    v_cvt_pk_bf16_f32 v166, v148, v149
    v_cvt_pk_bf16_f32 v167, v152, v153
    v_lshlrev_b32 v168, 16, v166
    v_and_b32 v169, 0xffff0000, v166
    v_lshlrev_b32 v170, 16, v167
    v_and_b32 v171, 0xffff0000, v167
    v_mul_f32 v168, v168, v170
    v_mul_f32 v169, v169, v171
    v_cvt_pk_bf16_f32 v148, v168, v169
    v_cvt_pk_bf16_f32 v166, v150, v151
    v_cvt_pk_bf16_f32 v167, v154, v155
    v_lshlrev_b32 v168, 16, v166
    v_and_b32 v169, 0xffff0000, v166
    v_lshlrev_b32 v170, 16, v167
    v_and_b32 v171, 0xffff0000, v167
    v_mul_f32 v168, v168, v170
    v_mul_f32 v169, v169, v171
    v_cvt_pk_bf16_f32 v149, v168, v169
    ds_write_b64 v5, v[148:149] offset:3648
    v_cvt_pk_bf16_f32 v166, v156, v157
    v_cvt_pk_bf16_f32 v167, v160, v161
    v_lshlrev_b32 v168, 16, v166
    v_and_b32 v169, 0xffff0000, v166
    v_lshlrev_b32 v170, 16, v167
    v_and_b32 v171, 0xffff0000, v167
    v_mul_f32 v168, v168, v170
    v_mul_f32 v169, v169, v171
    v_cvt_pk_bf16_f32 v156, v168, v169
    v_cvt_pk_bf16_f32 v166, v158, v159
    v_cvt_pk_bf16_f32 v167, v162, v163
    v_lshlrev_b32 v168, 16, v166
    v_and_b32 v169, 0xffff0000, v166
    v_lshlrev_b32 v170, 16, v167
    v_and_b32 v171, 0xffff0000, v167
    v_mul_f32 v168, v168, v170
    v_mul_f32 v169, v169, v171
    v_cvt_pk_bf16_f32 v157, v168, v169
    ds_write_b64 v5, v[156:157] offset:3664
    s_waitcnt lgkmcnt(0)
    ds_read_b128 v[68:71], v28
    ds_read_b128 v[72:75], v29
    ds_read_b128 v[76:79], v30
    ds_read_b128 v[80:83], v31
    ds_read_b128 v[84:87], v32
    ds_read_b128 v[88:91], v33
    s_waitcnt lgkmcnt(5)
    buffer_store_dwordx4 v[68:71], v36, s[16:19], 0 offen sc1
    s_waitcnt lgkmcnt(4)
    buffer_store_dwordx4 v[72:75], v37, s[16:19], 0 offen sc1
    s_waitcnt lgkmcnt(3)
    buffer_store_dwordx4 v[76:79], v38, s[16:19], 0 offen sc1
    s_waitcnt lgkmcnt(2)
    buffer_store_dwordx4 v[80:83], v39, s[16:19], 0 offen sc1
    s_waitcnt lgkmcnt(1)
    buffer_store_dwordx4 v[84:87], v40, s[16:19], 0 offen sc1
    s_waitcnt lgkmcnt(0)
    buffer_store_dwordx4 v[88:91], v41, s[16:19], 0 offen sc1
    s_add_u32 s44, s4, 0xc000000
    s_addc_u32 s45, s5, 0
    s_and_b32 s45, s45, 0xffff
    s_mov_b32 s46, 0x1000
    s_mov_b32 s47, 0x20000
    s_lshl_b32 s36, s21, 8
    s_lshl_b32 s37, s20, 2
    s_add_u32 s37, s37, s36
    s_waitcnt vmcnt(0)
    s_barrier
    s_cmp_lg_u32 s30, 0
    s_cbranch_scc1 L_ffn2_entry
    v_mov_b32 v4, 1
    v_mov_b32 v5, 0
    s_mov_b64 exec, 1
    buffer_store_dword v4, v5, s[44:47], s37 offen offset:192 sc1
    s_mov_b64 exec, -1
    s_branch L_ffn2_entry
    v_add_u32 v1, v1, v2
    v_add_u32 v1, s22, v1
    s_lshr_b32 s23, s23, 1
    v_lshrrev_b32 v3, 1, v3
    v_add_u32 v3, v3, v4
    v_add_u32 v3, s23, v3
    s_mov_b32 s24, 3072
    v_mul_lo_u32 v1, v1, s24
    v_lshl_add_u32 v1, v3, 1, v1
    s_mov_b32 s25, 0
    v_cvt_pk_bf16_f32 v166, v68, v69
    v_cvt_pk_bf16_f32 v167, v72, v73
    v_lshlrev_b32 v168, 16, v166
    v_and_b32 v169, 0xffff0000, v166
    v_lshlrev_b32 v170, 16, v167
    v_and_b32 v171, 0xffff0000, v167
    v_mul_f32 v168, v168, v170
    v_mul_f32 v169, v169, v171
    v_cvt_pk_bf16_f32 v164, v168, v169
    v_cvt_pk_bf16_f32 v166, v70, v71
    v_cvt_pk_bf16_f32 v167, v74, v75
    v_lshlrev_b32 v168, 16, v166
    v_and_b32 v169, 0xffff0000, v166
    v_lshlrev_b32 v170, 16, v167
    v_and_b32 v171, 0xffff0000, v167
    v_mul_f32 v168, v168, v170
    v_mul_f32 v169, v169, v171
    v_cvt_pk_bf16_f32 v165, v168, v169
    buffer_store_dwordx2 v[164:165], v1, s[16:19], s25 offen offset:0
    s_nop 1
    v_cvt_pk_bf16_f32 v166, v76, v77
    v_cvt_pk_bf16_f32 v167, v80, v81
    v_lshlrev_b32 v168, 16, v166
    v_and_b32 v169, 0xffff0000, v166
    v_lshlrev_b32 v170, 16, v167
    v_and_b32 v171, 0xffff0000, v167
    v_mul_f32 v168, v168, v170
    v_mul_f32 v169, v169, v171
    v_cvt_pk_bf16_f32 v164, v168, v169
    v_cvt_pk_bf16_f32 v166, v78, v79
    v_cvt_pk_bf16_f32 v167, v82, v83
    v_lshlrev_b32 v168, 16, v166
    v_and_b32 v169, 0xffff0000, v166
    v_lshlrev_b32 v170, 16, v167
    v_and_b32 v171, 0xffff0000, v167
    v_mul_f32 v168, v168, v170
    v_mul_f32 v169, v169, v171
    v_cvt_pk_bf16_f32 v165, v168, v169
    buffer_store_dwordx2 v[164:165], v1, s[16:19], s25 offen offset:16
    s_nop 1
    s_mov_b32 s25, 98304
    v_cvt_pk_bf16_f32 v166, v84, v85
    v_cvt_pk_bf16_f32 v167, v88, v89
    v_lshlrev_b32 v168, 16, v166
    v_and_b32 v169, 0xffff0000, v166
    v_lshlrev_b32 v170, 16, v167
    v_and_b32 v171, 0xffff0000, v167
    v_mul_f32 v168, v168, v170
    v_mul_f32 v169, v169, v171
    v_cvt_pk_bf16_f32 v164, v168, v169
    v_cvt_pk_bf16_f32 v166, v86, v87
    v_cvt_pk_bf16_f32 v167, v90, v91
    v_lshlrev_b32 v168, 16, v166
    v_and_b32 v169, 0xffff0000, v166
    v_lshlrev_b32 v170, 16, v167
    v_and_b32 v171, 0xffff0000, v167
    v_mul_f32 v168, v168, v170
    v_mul_f32 v169, v169, v171
    v_cvt_pk_bf16_f32 v165, v168, v169
    buffer_store_dwordx2 v[164:165], v1, s[16:19], s25 offen offset:0
    s_nop 1
    v_cvt_pk_bf16_f32 v166, v92, v93
    v_cvt_pk_bf16_f32 v167, v96, v97
    v_lshlrev_b32 v168, 16, v166
    v_and_b32 v169, 0xffff0000, v166
    v_lshlrev_b32 v170, 16, v167
    v_and_b32 v171, 0xffff0000, v167
    v_mul_f32 v168, v168, v170
    v_mul_f32 v169, v169, v171
    v_cvt_pk_bf16_f32 v164, v168, v169
    v_cvt_pk_bf16_f32 v166, v94, v95
    v_cvt_pk_bf16_f32 v167, v98, v99
    v_lshlrev_b32 v168, 16, v166
    v_and_b32 v169, 0xffff0000, v166
    v_lshlrev_b32 v170, 16, v167
    v_and_b32 v171, 0xffff0000, v167
    v_mul_f32 v168, v168, v170
    v_mul_f32 v169, v169, v171
    v_cvt_pk_bf16_f32 v165, v168, v169
    buffer_store_dwordx2 v[164:165], v1, s[16:19], s25 offen offset:16
    s_nop 1
    s_mov_b32 s25, 0
    v_cvt_pk_bf16_f32 v166, v100, v101
    v_cvt_pk_bf16_f32 v167, v104, v105
    v_lshlrev_b32 v168, 16, v166
    v_and_b32 v169, 0xffff0000, v166
    v_lshlrev_b32 v170, 16, v167
    v_and_b32 v171, 0xffff0000, v167
    v_mul_f32 v168, v168, v170
    v_mul_f32 v169, v169, v171
    v_cvt_pk_bf16_f32 v164, v168, v169
    v_cvt_pk_bf16_f32 v166, v102, v103
    v_cvt_pk_bf16_f32 v167, v106, v107
    v_lshlrev_b32 v168, 16, v166
    v_and_b32 v169, 0xffff0000, v166
    v_lshlrev_b32 v170, 16, v167
    v_and_b32 v171, 0xffff0000, v167
    v_mul_f32 v168, v168, v170
    v_mul_f32 v169, v169, v171
    v_cvt_pk_bf16_f32 v165, v168, v169
    buffer_store_dwordx2 v[164:165], v1, s[16:19], s25 offen offset:32
    s_nop 1
    v_cvt_pk_bf16_f32 v166, v108, v109
    v_cvt_pk_bf16_f32 v167, v112, v113
    v_lshlrev_b32 v168, 16, v166
    v_and_b32 v169, 0xffff0000, v166
    v_lshlrev_b32 v170, 16, v167
    v_and_b32 v171, 0xffff0000, v167
    v_mul_f32 v168, v168, v170
    v_mul_f32 v169, v169, v171
    v_cvt_pk_bf16_f32 v164, v168, v169
    v_cvt_pk_bf16_f32 v166, v110, v111
    v_cvt_pk_bf16_f32 v167, v114, v115
    v_lshlrev_b32 v168, 16, v166
    v_and_b32 v169, 0xffff0000, v166
    v_lshlrev_b32 v170, 16, v167
    v_and_b32 v171, 0xffff0000, v167
    v_mul_f32 v168, v168, v170
    v_mul_f32 v169, v169, v171
    v_cvt_pk_bf16_f32 v165, v168, v169
    buffer_store_dwordx2 v[164:165], v1, s[16:19], s25 offen offset:48
    s_nop 1
    s_mov_b32 s25, 98304
    v_cvt_pk_bf16_f32 v166, v116, v117
    v_cvt_pk_bf16_f32 v167, v120, v121
    v_lshlrev_b32 v168, 16, v166
    v_and_b32 v169, 0xffff0000, v166
    v_lshlrev_b32 v170, 16, v167
    v_and_b32 v171, 0xffff0000, v167
    v_mul_f32 v168, v168, v170
    v_mul_f32 v169, v169, v171
    v_cvt_pk_bf16_f32 v164, v168, v169
    v_cvt_pk_bf16_f32 v166, v118, v119
    v_cvt_pk_bf16_f32 v167, v122, v123
    v_lshlrev_b32 v168, 16, v166
    v_and_b32 v169, 0xffff0000, v166
    v_lshlrev_b32 v170, 16, v167
    v_and_b32 v171, 0xffff0000, v167
    v_mul_f32 v168, v168, v170
    v_mul_f32 v169, v169, v171
    v_cvt_pk_bf16_f32 v165, v168, v169
    buffer_store_dwordx2 v[164:165], v1, s[16:19], s25 offen offset:32
    s_nop 1
    v_cvt_pk_bf16_f32 v166, v124, v125
    v_cvt_pk_bf16_f32 v167, v128, v129
    v_lshlrev_b32 v168, 16, v166
    v_and_b32 v169, 0xffff0000, v166
    v_lshlrev_b32 v170, 16, v167
    v_and_b32 v171, 0xffff0000, v167
    v_mul_f32 v168, v168, v170
    v_mul_f32 v169, v169, v171
    v_cvt_pk_bf16_f32 v164, v168, v169
    v_cvt_pk_bf16_f32 v166, v126, v127
    v_cvt_pk_bf16_f32 v167, v130, v131
    v_lshlrev_b32 v168, 16, v166
    v_and_b32 v169, 0xffff0000, v166
    v_lshlrev_b32 v170, 16, v167
    v_and_b32 v171, 0xffff0000, v167
    v_mul_f32 v168, v168, v170
    v_mul_f32 v169, v169, v171
    v_cvt_pk_bf16_f32 v165, v168, v169
    buffer_store_dwordx2 v[164:165], v1, s[16:19], s25 offen offset:48
    s_nop 1
    s_mov_b32 s25, 0
    v_cvt_pk_bf16_f32 v166, v132, v133
    v_cvt_pk_bf16_f32 v167, v136, v137
    v_lshlrev_b32 v168, 16, v166
    v_and_b32 v169, 0xffff0000, v166
    v_lshlrev_b32 v170, 16, v167
    v_and_b32 v171, 0xffff0000, v167
    v_mul_f32 v168, v168, v170
    v_mul_f32 v169, v169, v171
    v_cvt_pk_bf16_f32 v164, v168, v169
    v_cvt_pk_bf16_f32 v166, v134, v135
    v_cvt_pk_bf16_f32 v167, v138, v139
    v_lshlrev_b32 v168, 16, v166
    v_and_b32 v169, 0xffff0000, v166
    v_lshlrev_b32 v170, 16, v167
    v_and_b32 v171, 0xffff0000, v167
    v_mul_f32 v168, v168, v170
    v_mul_f32 v169, v169, v171
    v_cvt_pk_bf16_f32 v165, v168, v169
    buffer_store_dwordx2 v[164:165], v1, s[16:19], s25 offen offset:64
    s_nop 1
    v_cvt_pk_bf16_f32 v166, v140, v141
    v_cvt_pk_bf16_f32 v167, v144, v145
    v_lshlrev_b32 v168, 16, v166
    v_and_b32 v169, 0xffff0000, v166
    v_lshlrev_b32 v170, 16, v167
    v_and_b32 v171, 0xffff0000, v167
    v_mul_f32 v168, v168, v170
    v_mul_f32 v169, v169, v171
    v_cvt_pk_bf16_f32 v164, v168, v169
    v_cvt_pk_bf16_f32 v166, v142, v143
    v_cvt_pk_bf16_f32 v167, v146, v147
    v_lshlrev_b32 v168, 16, v166
    v_and_b32 v169, 0xffff0000, v166
    v_lshlrev_b32 v170, 16, v167
    v_and_b32 v171, 0xffff0000, v167
    v_mul_f32 v168, v168, v170
    v_mul_f32 v169, v169, v171
    v_cvt_pk_bf16_f32 v165, v168, v169
    buffer_store_dwordx2 v[164:165], v1, s[16:19], s25 offen offset:80
    s_nop 1
    s_mov_b32 s25, 98304
    v_cvt_pk_bf16_f32 v166, v148, v149
    v_cvt_pk_bf16_f32 v167, v152, v153
    v_lshlrev_b32 v168, 16, v166
    v_and_b32 v169, 0xffff0000, v166
    v_lshlrev_b32 v170, 16, v167
    v_and_b32 v171, 0xffff0000, v167
    v_mul_f32 v168, v168, v170
    v_mul_f32 v169, v169, v171
    v_cvt_pk_bf16_f32 v164, v168, v169
    v_cvt_pk_bf16_f32 v166, v150, v151
    v_cvt_pk_bf16_f32 v167, v154, v155
    v_lshlrev_b32 v168, 16, v166
    v_and_b32 v169, 0xffff0000, v166
    v_lshlrev_b32 v170, 16, v167
    v_and_b32 v171, 0xffff0000, v167
    v_mul_f32 v168, v168, v170
    v_mul_f32 v169, v169, v171
    v_cvt_pk_bf16_f32 v165, v168, v169
    buffer_store_dwordx2 v[164:165], v1, s[16:19], s25 offen offset:64
    s_nop 1
    v_cvt_pk_bf16_f32 v166, v156, v157
    v_cvt_pk_bf16_f32 v167, v160, v161
    v_lshlrev_b32 v168, 16, v166
    v_and_b32 v169, 0xffff0000, v166
    v_lshlrev_b32 v170, 16, v167
    v_and_b32 v171, 0xffff0000, v167
    v_mul_f32 v168, v168, v170
    v_mul_f32 v169, v169, v171
    v_cvt_pk_bf16_f32 v164, v168, v169
    v_cvt_pk_bf16_f32 v166, v158, v159
    v_cvt_pk_bf16_f32 v167, v162, v163
    v_lshlrev_b32 v168, 16, v166
    v_and_b32 v169, 0xffff0000, v166
    v_lshlrev_b32 v170, 16, v167
    v_and_b32 v171, 0xffff0000, v167
    v_mul_f32 v168, v168, v170
    v_mul_f32 v169, v169, v171
    v_cvt_pk_bf16_f32 v165, v168, v169
    buffer_store_dwordx2 v[164:165], v1, s[16:19], s25 offen offset:80
    s_nop 1
L_ffn1_kernel_end:
    s_endpgm
.globl ffn2_kernel
.p2align 8
.type ffn2_kernel,@function
ffn2_kernel:
L_ffn2_entry:
    s_cmp_ge_u32 s2, 160
    s_cbranch_scc1 L_ffn2_kernel_end
    s_load_dwordx2 s[4:5], s[0:1], 104
    s_load_dwordx2 s[6:7], s[0:1], 0
    s_load_dwordx2 s[28:29], s[0:1], 88
    s_mov_b32 s38, 0
    s_lshr_b32 s20, s2, 5
    s_and_b32 s21, s2, 31
    s_mul_i32 s22, s21, 64
    s_mul_i32 s23, s20, 128
    s_waitcnt lgkmcnt(0)
    s_add_u32 s8, s4, 0x9a00000
    s_addc_u32 s9, s5, 0
    s_and_b32 s9, s9, 0xffff
    s_mov_b32 s10, 0x600000
    s_mov_b32 s11, 0x20000
    s_add_u32 s12, s4, 0x2600000
    s_addc_u32 s13, s5, 0
    s_and_b32 s13, s13, 0xffff
    s_mov_b32 s14, 0x1e0000
    s_mov_b32 s15, 0x20000
    v_lshrrev_b32 v1, 3, v0
    v_and_b32 v8, 7, v0
    v_and_b32 v9, 7, v1
    v_xor_b32 v8, v8, v9
    v_lshlrev_b32 v8, 4, v8
    s_mov_b32 s24, 3072
    s_mov_b32 s25, 3072
    v_add_u32 v2, s22, v1
    v_mul_lo_u32 v2, v2, s24
    v_add_u32 v2, v2, v8
    v_add_u32 v3, s22, v1
    v_add_u32 v3, 32, v3
    v_mul_lo_u32 v3, v3, s24
    v_add_u32 v3, v3, v8
    v_add_u32 v4, s23, v1
    v_mul_lo_u32 v4, v4, s25
    v_add_u32 v4, v4, v8
    v_add_u32 v5, s23, v1
    v_add_u32 v5, 32, v5
    v_mul_lo_u32 v5, v5, s25
    v_add_u32 v5, v5, v8
    v_add_u32 v6, s23, v1
    v_add_u32 v6, 64, v6
    v_mul_lo_u32 v6, v6, s25
    v_add_u32 v6, v6, v8
    v_add_u32 v7, s23, v1
    v_add_u32 v7, 96, v7
    v_mul_lo_u32 v7, v7, s25
    v_add_u32 v7, v7, v8
    v_mul_u32_u24 v1, 144, v1
    v_add_u32 v8, v8, v1
    v_lshrrev_b32 v1, 6, v0
    v_and_b32 v9, 1, v1
    v_lshrrev_b32 v10, 1, v1
    v_mul_u32_u24 v9, 32, v9
    v_mul_u32_u24 v10, 64, v10
    v_and_b32 v1, 31, v0
    v_add_u32 v9, v9, v1
    v_add_u32 v10, v10, v1
    v_mul_u32_u24 v9, 144, v9
    v_mul_u32_u24 v10, 144, v10
    v_bfe_u32 v1, v0, 5, 1
    v_lshlrev_b32 v1, 4, v1
    v_add_u32 v9, v9, v1
    v_add_u32 v10, v10, v1
    v_add_u32 v10, 9216, v10
    v_add_u32 v11, 27648, v8
    v_add_u32 v12, 27648, v9
    v_add_u32 v13, 27648, v10
    v_lshrrev_b32 v1, 6, v0
    s_nop 0
    v_readfirstlane_b32 s30, v1
    s_lshl_b32 s30, s30, 10
    v_and_b32 v14, 1, v1
    v_lshrrev_b32 v18, 1, v1
    v_mul_u32_u24 v14, 32, v14
    v_mul_u32_u24 v18, 64, v18
    v_and_b32 v1, 31, v0
    v_add_u32 v14, v14, v1
    v_add_u32 v18, v18, v1
    v_lshlrev_b32 v14, 7, v14
    v_lshlrev_b32 v18, 7, v18
    v_bfe_u32 v8, v0, 5, 1
    v_and_b32 v1, 7, v0
    v_xor_b32 v1, v1, v8
    v_lshlrev_b32 v1, 4, v1
    v_add_u32 v14, v14, v1
    v_add_u32 v18, v18, v1
    v_xor_b32 v15, 32, v14
    v_xor_b32 v19, 32, v18
    v_xor_b32 v16, 64, v14
    v_xor_b32 v20, 64, v18
    v_xor_b32 v17, 96, v14
    v_xor_b32 v21, 96, v18
    v_add_u32 v18, 32768, v18
    v_add_u32 v19, 32768, v19
    v_add_u32 v20, 32768, v20
    v_add_u32 v21, 32768, v21
    v_mov_b32 v48, 0
    v_mov_b32 v49, 0
    v_mov_b32 v50, 0
    v_mov_b32 v51, 0
    v_mov_b32 v52, 0
    v_mov_b32 v53, 0
    v_mov_b32 v54, 0
    v_mov_b32 v55, 0
    v_mov_b32 v56, 0
    v_mov_b32 v57, 0
    v_mov_b32 v58, 0
    v_mov_b32 v59, 0
    v_mov_b32 v60, 0
    v_mov_b32 v61, 0
    v_mov_b32 v62, 0
    v_mov_b32 v63, 0
    v_mov_b32 v64, 0
    v_mov_b32 v65, 0
    v_mov_b32 v66, 0
    v_mov_b32 v67, 0
    v_mov_b32 v68, 0
    v_mov_b32 v69, 0
    v_mov_b32 v70, 0
    v_mov_b32 v71, 0
    v_mov_b32 v72, 0
    v_mov_b32 v73, 0
    v_mov_b32 v74, 0
    v_mov_b32 v75, 0
    v_mov_b32 v76, 0
    v_mov_b32 v77, 0
    v_mov_b32 v78, 0
    v_mov_b32 v79, 0
    s_mul_i32 s26, s38, 3072
    s_mov_b32 s31, s26
    s_add_u32 m0, s30, 32768
    s_nop 0
    buffer_load_dwordx4 v4, s[12:15], s31 offen lds
    s_add_u32 m0, s30, 36864
    s_nop 0
    buffer_load_dwordx4 v5, s[12:15], s31 offen lds
    s_add_u32 m0, s30, 40960
    s_nop 0
    buffer_load_dwordx4 v6, s[12:15], s31 offen lds
    s_add_u32 m0, s30, 45056
    s_nop 0
    buffer_load_dwordx4 v7, s[12:15], s31 offen lds
    s_add_u32 s31, s31, 128
    s_add_u32 m0, s30, 49152
    s_nop 0
    buffer_load_dwordx4 v4, s[12:15], s31 offen lds
    s_add_u32 m0, s30, 53248
    s_nop 0
    buffer_load_dwordx4 v5, s[12:15], s31 offen lds
    s_add_u32 m0, s30, 57344
    s_nop 0
    buffer_load_dwordx4 v6, s[12:15], s31 offen lds
    s_add_u32 m0, s30, 61440
    s_nop 0
    buffer_load_dwordx4 v7, s[12:15], s31 offen lds
    s_add_u32 s31, s31, 128
    s_add_u32 m0, s30, 65536
    s_nop 0
    buffer_load_dwordx4 v4, s[12:15], s31 offen lds
    s_add_u32 m0, s30, 69632
    s_nop 0
    buffer_load_dwordx4 v5, s[12:15], s31 offen lds
    s_add_u32 m0, s30, 73728
    s_nop 0
    buffer_load_dwordx4 v6, s[12:15], s31 offen lds
    s_add_u32 m0, s30, 77824
    s_nop 0
    buffer_load_dwordx4 v7, s[12:15], s31 offen lds
    s_add_u32 s31, s31, 128
    s_cmp_lg_u32 s30, 0
    s_cbranch_scc1 L_ffn2_kernel_cw
    s_add_u32 s44, s4, 0xc000000
    s_addc_u32 s45, s5, 0
    s_and_b32 s45, s45, 0xffff
    s_mov_b32 s46, 0x1000
    s_mov_b32 s47, 0x20000
    s_lshr_b32 s36, s21, 1
    s_lshl_b32 s36, s36, 8
    v_min_u32 v80, 15, v0
    v_lshlrev_b32 v80, 2, v80
L_ffn2_kernel_cp:
    buffer_load_dword v81, v80, s[44:47], s36 offen offset:192 sc1
    s_waitcnt vmcnt(0)
    v_cmp_eq_u32 vcc, 0, v81
    s_cbranch_vccz L_ffn2_kernel_cw
    s_sleep 1
    s_branch L_ffn2_kernel_cp
L_ffn2_kernel_cw:
    s_barrier
    s_add_u32 m0, s30, 0
    s_nop 0
    buffer_load_dwordx4 v2, s[8:11], s26 offen lds
    s_add_u32 m0, s30, 4096
    s_nop 0
    buffer_load_dwordx4 v3, s[8:11], s26 offen lds
    s_add_u32 s26, s26, 128
    s_add_u32 m0, s30, 8192
    s_nop 0
    buffer_load_dwordx4 v2, s[8:11], s26 offen sc1 lds
    s_add_u32 m0, s30, 12288
    s_nop 0
    buffer_load_dwordx4 v3, s[8:11], s26 offen sc1 lds
    s_add_u32 s26, s26, 128
    s_add_u32 m0, s30, 16384
    s_nop 0
    buffer_load_dwordx4 v2, s[8:11], s26 offen lds
    s_add_u32 m0, s30, 20480
    s_nop 0
    buffer_load_dwordx4 v3, s[8:11], s26 offen lds
    s_add_u32 s26, s26, 128
    s_mov_b32 s41, 0
    s_waitcnt vmcnt(2)
    s_barrier
    ds_read_b128 v[24:27], v14 offset:0
    ds_read_b128 v[28:31], v18 offset:0
    ds_read_b128 v[32:35], v18 offset:4096
    s_mov_b32 s27, 0
L_ffn2_kernel_loopm:
    ds_read_b128 v[36:39], v15 offset:0
    ds_read_b128 v[40:43], v19 offset:0
    ds_read_b128 v[44:47], v19 offset:4096
    s_waitcnt lgkmcnt(3)
    v_mfma_f32_32x32x16_bf16 v[48:63], v[28:31], v[24:27], v[48:63]
    v_mfma_f32_32x32x16_bf16 v[64:79], v[32:35], v[24:27], v[64:79]
    ds_read_b128 v[24:27], v16 offset:0
    ds_read_b128 v[28:31], v20 offset:0
    ds_read_b128 v[32:35], v20 offset:4096
    s_waitcnt lgkmcnt(3)
    v_mfma_f32_32x32x16_bf16 v[48:63], v[40:43], v[36:39], v[48:63]
    v_mfma_f32_32x32x16_bf16 v[64:79], v[44:47], v[36:39], v[64:79]
    ds_read_b128 v[36:39], v17 offset:0
    ds_read_b128 v[40:43], v21 offset:0
    ds_read_b128 v[44:47], v21 offset:4096
    s_waitcnt lgkmcnt(3)
    v_mfma_f32_32x32x16_bf16 v[48:63], v[28:31], v[24:27], v[48:63]
    v_mfma_f32_32x32x16_bf16 v[64:79], v[32:35], v[24:27], v[64:79]
    s_waitcnt vmcnt(6)
    s_barrier
    ds_read_b128 v[24:27], v14 offset:8192
    ds_read_b128 v[28:31], v18 offset:16384
    ds_read_b128 v[32:35], v18 offset:20480
    s_cmp_eq_u32 s41, 1
    s_cbranch_scc1 L_ffn2_kernel_dx4
    s_add_u32 m0, s30, 24576
    s_nop 0
    buffer_load_dwordx4 v2, s[8:11], s26 offen lds
    s_add_u32 m0, s30, 28672
    s_nop 0
    buffer_load_dwordx4 v3, s[8:11], s26 offen lds
    s_branch L_ffn2_kernel_dy4
L_ffn2_kernel_dx4:
    s_add_u32 m0, s30, 24576
    s_nop 0
    buffer_load_dwordx4 v2, s[8:11], s26 offen sc1 lds
    s_add_u32 m0, s30, 28672
    s_nop 0
    buffer_load_dwordx4 v3, s[8:11], s26 offen sc1 lds
L_ffn2_kernel_dy4:
    s_add_u32 s41, s41, 1
    s_cmp_eq_u32 s41, 3
    s_cselect_b32 s41, 0, s41
    s_add_u32 m0, s30, 81920
    s_nop 0
    buffer_load_dwordx4 v4, s[12:15], s26 offen lds
    s_add_u32 m0, s30, 86016
    s_nop 0
    buffer_load_dwordx4 v5, s[12:15], s26 offen lds
    s_add_u32 m0, s30, 90112
    s_nop 0
    buffer_load_dwordx4 v6, s[12:15], s26 offen lds
    s_add_u32 m0, s30, 94208
    s_nop 0
    buffer_load_dwordx4 v7, s[12:15], s26 offen lds
    s_add_u32 s26, s26, 128
    s_waitcnt lgkmcnt(3)
    v_mfma_f32_32x32x16_bf16 v[48:63], v[40:43], v[36:39], v[48:63]
    v_mfma_f32_32x32x16_bf16 v[64:79], v[44:47], v[36:39], v[64:79]
    ds_read_b128 v[36:39], v15 offset:8192
    ds_read_b128 v[40:43], v19 offset:16384
    ds_read_b128 v[44:47], v19 offset:20480
    s_waitcnt lgkmcnt(3)
    v_mfma_f32_32x32x16_bf16 v[48:63], v[28:31], v[24:27], v[48:63]
    v_mfma_f32_32x32x16_bf16 v[64:79], v[32:35], v[24:27], v[64:79]
    ds_read_b128 v[24:27], v16 offset:8192
    ds_read_b128 v[28:31], v20 offset:16384
    ds_read_b128 v[32:35], v20 offset:20480
    s_waitcnt lgkmcnt(3)
    v_mfma_f32_32x32x16_bf16 v[48:63], v[40:43], v[36:39], v[48:63]
    v_mfma_f32_32x32x16_bf16 v[64:79], v[44:47], v[36:39], v[64:79]
    ds_read_b128 v[36:39], v17 offset:8192
    ds_read_b128 v[40:43], v21 offset:16384
    ds_read_b128 v[44:47], v21 offset:20480
    s_waitcnt lgkmcnt(3)
    v_mfma_f32_32x32x16_bf16 v[48:63], v[28:31], v[24:27], v[48:63]
    v_mfma_f32_32x32x16_bf16 v[64:79], v[32:35], v[24:27], v[64:79]
    s_waitcnt vmcnt(6)
    s_barrier
    ds_read_b128 v[24:27], v14 offset:16384
    ds_read_b128 v[28:31], v18 offset:32768
    ds_read_b128 v[32:35], v18 offset:36864
    s_cmp_eq_u32 s41, 1
    s_cbranch_scc1 L_ffn2_kernel_dx5
    s_add_u32 m0, s30, 0
    s_nop 0
    buffer_load_dwordx4 v2, s[8:11], s26 offen lds
    s_add_u32 m0, s30, 4096
    s_nop 0
    buffer_load_dwordx4 v3, s[8:11], s26 offen lds
    s_branch L_ffn2_kernel_dy5
L_ffn2_kernel_dx5:
    s_add_u32 m0, s30, 0
    s_nop 0
    buffer_load_dwordx4 v2, s[8:11], s26 offen sc1 lds
    s_add_u32 m0, s30, 4096
    s_nop 0
    buffer_load_dwordx4 v3, s[8:11], s26 offen sc1 lds
L_ffn2_kernel_dy5:
    s_add_u32 s41, s41, 1
    s_cmp_eq_u32 s41, 3
    s_cselect_b32 s41, 0, s41
    s_add_u32 m0, s30, 32768
    s_nop 0
    buffer_load_dwordx4 v4, s[12:15], s26 offen lds
    s_add_u32 m0, s30, 36864
    s_nop 0
    buffer_load_dwordx4 v5, s[12:15], s26 offen lds
    s_add_u32 m0, s30, 40960
    s_nop 0
    buffer_load_dwordx4 v6, s[12:15], s26 offen lds
    s_add_u32 m0, s30, 45056
    s_nop 0
    buffer_load_dwordx4 v7, s[12:15], s26 offen lds
    s_add_u32 s26, s26, 128
    s_waitcnt lgkmcnt(3)
    v_mfma_f32_32x32x16_bf16 v[48:63], v[40:43], v[36:39], v[48:63]
    v_mfma_f32_32x32x16_bf16 v[64:79], v[44:47], v[36:39], v[64:79]
    ds_read_b128 v[36:39], v15 offset:16384
    ds_read_b128 v[40:43], v19 offset:32768
    ds_read_b128 v[44:47], v19 offset:36864
    s_waitcnt lgkmcnt(3)
    v_mfma_f32_32x32x16_bf16 v[48:63], v[28:31], v[24:27], v[48:63]
    v_mfma_f32_32x32x16_bf16 v[64:79], v[32:35], v[24:27], v[64:79]
    ds_read_b128 v[24:27], v16 offset:16384
    ds_read_b128 v[28:31], v20 offset:32768
    ds_read_b128 v[32:35], v20 offset:36864
    s_waitcnt lgkmcnt(3)
    v_mfma_f32_32x32x16_bf16 v[48:63], v[40:43], v[36:39], v[48:63]
    v_mfma_f32_32x32x16_bf16 v[64:79], v[44:47], v[36:39], v[64:79]
    ds_read_b128 v[36:39], v17 offset:16384
    ds_read_b128 v[40:43], v21 offset:32768
    ds_read_b128 v[44:47], v21 offset:36864
    s_waitcnt lgkmcnt(3)
    v_mfma_f32_32x32x16_bf16 v[48:63], v[28:31], v[24:27], v[48:63]
    v_mfma_f32_32x32x16_bf16 v[64:79], v[32:35], v[24:27], v[64:79]
    s_waitcnt vmcnt(6)
    s_barrier
    ds_read_b128 v[24:27], v14 offset:24576
    ds_read_b128 v[28:31], v18 offset:49152
    ds_read_b128 v[32:35], v18 offset:53248
    s_cmp_eq_u32 s41, 1
    s_cbranch_scc1 L_ffn2_kernel_dx6
    s_add_u32 m0, s30, 8192
    s_nop 0
    buffer_load_dwordx4 v2, s[8:11], s26 offen lds
    s_add_u32 m0, s30, 12288
    s_nop 0
    buffer_load_dwordx4 v3, s[8:11], s26 offen lds
    s_branch L_ffn2_kernel_dy6
L_ffn2_kernel_dx6:
    s_add_u32 m0, s30, 8192
    s_nop 0
    buffer_load_dwordx4 v2, s[8:11], s26 offen sc1 lds
    s_add_u32 m0, s30, 12288
    s_nop 0
    buffer_load_dwordx4 v3, s[8:11], s26 offen sc1 lds
L_ffn2_kernel_dy6:
    s_add_u32 s41, s41, 1
    s_cmp_eq_u32 s41, 3
    s_cselect_b32 s41, 0, s41
    s_add_u32 m0, s30, 49152
    s_nop 0
    buffer_load_dwordx4 v4, s[12:15], s26 offen lds
    s_add_u32 m0, s30, 53248
    s_nop 0
    buffer_load_dwordx4 v5, s[12:15], s26 offen lds
    s_add_u32 m0, s30, 57344
    s_nop 0
    buffer_load_dwordx4 v6, s[12:15], s26 offen lds
    s_add_u32 m0, s30, 61440
    s_nop 0
    buffer_load_dwordx4 v7, s[12:15], s26 offen lds
    s_add_u32 s26, s26, 128
    s_waitcnt lgkmcnt(3)
    v_mfma_f32_32x32x16_bf16 v[48:63], v[40:43], v[36:39], v[48:63]
    v_mfma_f32_32x32x16_bf16 v[64:79], v[44:47], v[36:39], v[64:79]
    ds_read_b128 v[36:39], v15 offset:24576
    ds_read_b128 v[40:43], v19 offset:49152
    ds_read_b128 v[44:47], v19 offset:53248
    s_waitcnt lgkmcnt(3)
    v_mfma_f32_32x32x16_bf16 v[48:63], v[28:31], v[24:27], v[48:63]
    v_mfma_f32_32x32x16_bf16 v[64:79], v[32:35], v[24:27], v[64:79]
    ds_read_b128 v[24:27], v16 offset:24576
    ds_read_b128 v[28:31], v20 offset:49152
    ds_read_b128 v[32:35], v20 offset:53248
    s_waitcnt lgkmcnt(3)
    v_mfma_f32_32x32x16_bf16 v[48:63], v[40:43], v[36:39], v[48:63]
    v_mfma_f32_32x32x16_bf16 v[64:79], v[44:47], v[36:39], v[64:79]
    ds_read_b128 v[36:39], v17 offset:24576
    ds_read_b128 v[40:43], v21 offset:49152
    ds_read_b128 v[44:47], v21 offset:53248
    s_waitcnt lgkmcnt(3)
    v_mfma_f32_32x32x16_bf16 v[48:63], v[28:31], v[24:27], v[48:63]
    v_mfma_f32_32x32x16_bf16 v[64:79], v[32:35], v[24:27], v[64:79]
    s_waitcnt vmcnt(6)
    s_barrier
    ds_read_b128 v[24:27], v14 offset:0
    ds_read_b128 v[28:31], v18 offset:0
    ds_read_b128 v[32:35], v18 offset:4096
    s_cmp_eq_u32 s41, 1
    s_cbranch_scc1 L_ffn2_kernel_dx7
    s_add_u32 m0, s30, 16384
    s_nop 0
    buffer_load_dwordx4 v2, s[8:11], s26 offen lds
    s_add_u32 m0, s30, 20480
    s_nop 0
    buffer_load_dwordx4 v3, s[8:11], s26 offen lds
    s_branch L_ffn2_kernel_dy7
L_ffn2_kernel_dx7:
    s_add_u32 m0, s30, 16384
    s_nop 0
    buffer_load_dwordx4 v2, s[8:11], s26 offen sc1 lds
    s_add_u32 m0, s30, 20480
    s_nop 0
    buffer_load_dwordx4 v3, s[8:11], s26 offen sc1 lds
L_ffn2_kernel_dy7:
    s_add_u32 s41, s41, 1
    s_cmp_eq_u32 s41, 3
    s_cselect_b32 s41, 0, s41
    s_add_u32 m0, s30, 65536
    s_nop 0
    buffer_load_dwordx4 v4, s[12:15], s26 offen lds
    s_add_u32 m0, s30, 69632
    s_nop 0
    buffer_load_dwordx4 v5, s[12:15], s26 offen lds
    s_add_u32 m0, s30, 73728
    s_nop 0
    buffer_load_dwordx4 v6, s[12:15], s26 offen lds
    s_add_u32 m0, s30, 77824
    s_nop 0
    buffer_load_dwordx4 v7, s[12:15], s26 offen lds
    s_add_u32 s26, s26, 128
    s_waitcnt lgkmcnt(3)
    v_mfma_f32_32x32x16_bf16 v[48:63], v[40:43], v[36:39], v[48:63]
    v_mfma_f32_32x32x16_bf16 v[64:79], v[44:47], v[36:39], v[64:79]
    s_add_u32 s27, s27, 1
    s_cmp_lt_u32 s27, 5
    s_cbranch_scc1 L_ffn2_kernel_loopm
    ds_read_b128 v[36:39], v15 offset:0
    ds_read_b128 v[40:43], v19 offset:0
    ds_read_b128 v[44:47], v19 offset:4096
    s_waitcnt lgkmcnt(3)
    v_mfma_f32_32x32x16_bf16 v[48:63], v[28:31], v[24:27], v[48:63]
    v_mfma_f32_32x32x16_bf16 v[64:79], v[32:35], v[24:27], v[64:79]
    ds_read_b128 v[24:27], v16 offset:0
    ds_read_b128 v[28:31], v20 offset:0
    ds_read_b128 v[32:35], v20 offset:4096
    s_waitcnt lgkmcnt(3)
    v_mfma_f32_32x32x16_bf16 v[48:63], v[40:43], v[36:39], v[48:63]
    v_mfma_f32_32x32x16_bf16 v[64:79], v[44:47], v[36:39], v[64:79]
    ds_read_b128 v[36:39], v17 offset:0
    ds_read_b128 v[40:43], v21 offset:0
    ds_read_b128 v[44:47], v21 offset:4096
    s_waitcnt lgkmcnt(3)
    v_mfma_f32_32x32x16_bf16 v[48:63], v[28:31], v[24:27], v[48:63]
    v_mfma_f32_32x32x16_bf16 v[64:79], v[32:35], v[24:27], v[64:79]
    s_waitcnt vmcnt(6)
    s_barrier
    ds_read_b128 v[24:27], v14 offset:8192
    ds_read_b128 v[28:31], v18 offset:16384
    ds_read_b128 v[32:35], v18 offset:20480
    s_cmp_eq_u32 s41, 1
    s_cbranch_scc1 L_ffn2_kernel_dx8
    s_add_u32 m0, s30, 24576
    s_nop 0
    buffer_load_dwordx4 v2, s[8:11], s26 offen lds
    s_add_u32 m0, s30, 28672
    s_nop 0
    buffer_load_dwordx4 v3, s[8:11], s26 offen lds
    s_branch L_ffn2_kernel_dy8
L_ffn2_kernel_dx8:
    s_add_u32 m0, s30, 24576
    s_nop 0
    buffer_load_dwordx4 v2, s[8:11], s26 offen sc1 lds
    s_add_u32 m0, s30, 28672
    s_nop 0
    buffer_load_dwordx4 v3, s[8:11], s26 offen sc1 lds
L_ffn2_kernel_dy8:
    s_add_u32 s41, s41, 1
    s_cmp_eq_u32 s41, 3
    s_cselect_b32 s41, 0, s41
    s_add_u32 m0, s30, 81920
    s_nop 0
    buffer_load_dwordx4 v4, s[12:15], s26 offen lds
    s_add_u32 m0, s30, 86016
    s_nop 0
    buffer_load_dwordx4 v5, s[12:15], s26 offen lds
    s_add_u32 m0, s30, 90112
    s_nop 0
    buffer_load_dwordx4 v6, s[12:15], s26 offen lds
    s_add_u32 m0, s30, 94208
    s_nop 0
    buffer_load_dwordx4 v7, s[12:15], s26 offen lds
    s_add_u32 s26, s26, 128
    s_waitcnt lgkmcnt(3)
    v_mfma_f32_32x32x16_bf16 v[48:63], v[40:43], v[36:39], v[48:63]
    v_mfma_f32_32x32x16_bf16 v[64:79], v[44:47], v[36:39], v[64:79]
    ds_read_b128 v[36:39], v15 offset:8192
    ds_read_b128 v[40:43], v19 offset:16384
    ds_read_b128 v[44:47], v19 offset:20480
    s_waitcnt lgkmcnt(3)
    v_mfma_f32_32x32x16_bf16 v[48:63], v[28:31], v[24:27], v[48:63]
    v_mfma_f32_32x32x16_bf16 v[64:79], v[32:35], v[24:27], v[64:79]
    ds_read_b128 v[24:27], v16 offset:8192
    ds_read_b128 v[28:31], v20 offset:16384
    ds_read_b128 v[32:35], v20 offset:20480
    s_waitcnt lgkmcnt(3)
    v_mfma_f32_32x32x16_bf16 v[48:63], v[40:43], v[36:39], v[48:63]
    v_mfma_f32_32x32x16_bf16 v[64:79], v[44:47], v[36:39], v[64:79]
    ds_read_b128 v[36:39], v17 offset:8192
    ds_read_b128 v[40:43], v21 offset:16384
    ds_read_b128 v[44:47], v21 offset:20480
    s_waitcnt lgkmcnt(3)
    v_mfma_f32_32x32x16_bf16 v[48:63], v[28:31], v[24:27], v[48:63]
    v_mfma_f32_32x32x16_bf16 v[64:79], v[32:35], v[24:27], v[64:79]
    s_waitcnt vmcnt(6)
    s_barrier
    ds_read_b128 v[24:27], v14 offset:16384
    ds_read_b128 v[28:31], v18 offset:32768
    ds_read_b128 v[32:35], v18 offset:36864
    s_waitcnt lgkmcnt(3)
    v_mfma_f32_32x32x16_bf16 v[48:63], v[40:43], v[36:39], v[48:63]
    v_mfma_f32_32x32x16_bf16 v[64:79], v[44:47], v[36:39], v[64:79]
    ds_read_b128 v[36:39], v15 offset:16384
    ds_read_b128 v[40:43], v19 offset:32768
    ds_read_b128 v[44:47], v19 offset:36864
    s_waitcnt lgkmcnt(3)
    v_mfma_f32_32x32x16_bf16 v[48:63], v[28:31], v[24:27], v[48:63]
    v_mfma_f32_32x32x16_bf16 v[64:79], v[32:35], v[24:27], v[64:79]
    ds_read_b128 v[24:27], v16 offset:16384
    ds_read_b128 v[28:31], v20 offset:32768
    ds_read_b128 v[32:35], v20 offset:36864
    s_waitcnt lgkmcnt(3)
    v_mfma_f32_32x32x16_bf16 v[48:63], v[40:43], v[36:39], v[48:63]
    v_mfma_f32_32x32x16_bf16 v[64:79], v[44:47], v[36:39], v[64:79]
    ds_read_b128 v[36:39], v17 offset:16384
    ds_read_b128 v[40:43], v21 offset:32768
    ds_read_b128 v[44:47], v21 offset:36864
    s_waitcnt lgkmcnt(3)
    v_mfma_f32_32x32x16_bf16 v[48:63], v[28:31], v[24:27], v[48:63]
    v_mfma_f32_32x32x16_bf16 v[64:79], v[32:35], v[24:27], v[64:79]
    s_waitcnt vmcnt(0)
    s_barrier
    ds_read_b128 v[24:27], v14 offset:24576
    ds_read_b128 v[28:31], v18 offset:49152
    ds_read_b128 v[32:35], v18 offset:53248
    s_waitcnt lgkmcnt(3)
    v_mfma_f32_32x32x16_bf16 v[48:63], v[40:43], v[36:39], v[48:63]
    v_mfma_f32_32x32x16_bf16 v[64:79], v[44:47], v[36:39], v[64:79]
    ds_read_b128 v[36:39], v15 offset:24576
    ds_read_b128 v[40:43], v19 offset:49152
    ds_read_b128 v[44:47], v19 offset:53248
    s_waitcnt lgkmcnt(3)
    v_mfma_f32_32x32x16_bf16 v[48:63], v[28:31], v[24:27], v[48:63]
    v_mfma_f32_32x32x16_bf16 v[64:79], v[32:35], v[24:27], v[64:79]
    ds_read_b128 v[24:27], v16 offset:24576
    ds_read_b128 v[28:31], v20 offset:49152
    ds_read_b128 v[32:35], v20 offset:53248
    s_waitcnt lgkmcnt(3)
    v_mfma_f32_32x32x16_bf16 v[48:63], v[40:43], v[36:39], v[48:63]
    v_mfma_f32_32x32x16_bf16 v[64:79], v[44:47], v[36:39], v[64:79]
    ds_read_b128 v[36:39], v17 offset:24576
    ds_read_b128 v[40:43], v21 offset:49152
    ds_read_b128 v[44:47], v21 offset:53248
    s_waitcnt lgkmcnt(3)
    v_mfma_f32_32x32x16_bf16 v[48:63], v[28:31], v[24:27], v[48:63]
    v_mfma_f32_32x32x16_bf16 v[64:79], v[32:35], v[24:27], v[64:79]
    s_waitcnt lgkmcnt(0)
    v_mfma_f32_32x32x16_bf16 v[48:63], v[40:43], v[36:39], v[48:63]
    v_mfma_f32_32x32x16_bf16 v[64:79], v[44:47], v[36:39], v[64:79]
    s_nop 15
    s_nop 3
    s_add_u32 s16, s4, 0x9400000
    s_addc_u32 s17, s5, 0
    s_and_b32 s17, s17, 0xffff
    s_mov_b32 s18, 0x280000
    s_mov_b32 s19, 0x20000
    s_mov_b32 s32, s28
    s_mov_b32 s33, s29
    s_and_b32 s33, s33, 0xffff
    s_mov_b32 s34, 0x280000
    s_mov_b32 s35, 0x20000
    v_lshrrev_b32 v1, 6, v0
    v_and_b32 v2, 1, v1
    v_lshrrev_b32 v3, 1, v1
    v_mul_u32_u24 v2, 32, v2
    v_mul_u32_u24 v3, 64, v3
    v_and_b32 v1, 31, v0
    v_bfe_u32 v4, v0, 5, 1
    v_lshlrev_b32 v4, 2, v4
    v_add_u32 v1, v1, v2
    v_add_u32 v1, s22, v1
    v_add_u32 v3, v3, v4
    v_add_u32 v3, s23, v3
    s_mov_b32 s24, 1280
    v_mul_lo_u32 v1, v1, s24
    v_lshl_add_u32 v1, v3, 1, v1
    s_mov_b32 s25, 0
    buffer_load_dwordx2 v[80:81], v1, s[16:19], s25 offen offset:0
    buffer_load_dwordx2 v[82:83], v1, s[16:19], s25 offen offset:16
    buffer_load_dwordx2 v[84:85], v1, s[16:19], s25 offen offset:32
    buffer_load_dwordx2 v[86:87], v1, s[16:19], s25 offen offset:48
    s_waitcnt vmcnt(0)
    v_cvt_pk_bf16_f32 v88, v48, v49
    v_cvt_pk_bf16_f32 v89, v50, v51
    v_lshlrev_b32 v90, 16, v88
    v_and_b32 v91, 0xffff0000, v88
    v_lshlrev_b32 v92, 16, v80
    v_and_b32 v93, 0xffff0000, v80
    v_add_f32 v90, v90, v92
    v_add_f32 v91, v91, v93
    v_cvt_pk_bf16_f32 v80, v90, v91
    v_lshlrev_b32 v90, 16, v89
    v_and_b32 v91, 0xffff0000, v89
    v_lshlrev_b32 v92, 16, v81
    v_and_b32 v93, 0xffff0000, v81
    v_add_f32 v90, v90, v92
    v_add_f32 v91, v91, v93
    v_cvt_pk_bf16_f32 v81, v90, v91
    buffer_store_dwordx2 v[80:81], v1, s[32:35], s25 offen offset:0
    v_cvt_pk_bf16_f32 v88, v52, v53
    v_cvt_pk_bf16_f32 v89, v54, v55
    v_lshlrev_b32 v90, 16, v88
    v_and_b32 v91, 0xffff0000, v88
    v_lshlrev_b32 v92, 16, v82
    v_and_b32 v93, 0xffff0000, v82
    v_add_f32 v90, v90, v92
    v_add_f32 v91, v91, v93
    v_cvt_pk_bf16_f32 v82, v90, v91
    v_lshlrev_b32 v90, 16, v89
    v_and_b32 v91, 0xffff0000, v89
    v_lshlrev_b32 v92, 16, v83
    v_and_b32 v93, 0xffff0000, v83
    v_add_f32 v90, v90, v92
    v_add_f32 v91, v91, v93
    v_cvt_pk_bf16_f32 v83, v90, v91
    buffer_store_dwordx2 v[82:83], v1, s[32:35], s25 offen offset:16
    v_cvt_pk_bf16_f32 v88, v56, v57
    v_cvt_pk_bf16_f32 v89, v58, v59
    v_lshlrev_b32 v90, 16, v88
    v_and_b32 v91, 0xffff0000, v88
    v_lshlrev_b32 v92, 16, v84
    v_and_b32 v93, 0xffff0000, v84
    v_add_f32 v90, v90, v92
    v_add_f32 v91, v91, v93
    v_cvt_pk_bf16_f32 v84, v90, v91
    v_lshlrev_b32 v90, 16, v89
    v_and_b32 v91, 0xffff0000, v89
    v_lshlrev_b32 v92, 16, v85
    v_and_b32 v93, 0xffff0000, v85
    v_add_f32 v90, v90, v92
    v_add_f32 v91, v91, v93
    v_cvt_pk_bf16_f32 v85, v90, v91
    buffer_store_dwordx2 v[84:85], v1, s[32:35], s25 offen offset:32
    v_cvt_pk_bf16_f32 v88, v60, v61
    v_cvt_pk_bf16_f32 v89, v62, v63
    v_lshlrev_b32 v90, 16, v88
    v_and_b32 v91, 0xffff0000, v88
    v_lshlrev_b32 v92, 16, v86
    v_and_b32 v93, 0xffff0000, v86
    v_add_f32 v90, v90, v92
    v_add_f32 v91, v91, v93
    v_cvt_pk_bf16_f32 v86, v90, v91
    v_lshlrev_b32 v90, 16, v89
    v_and_b32 v91, 0xffff0000, v89
    v_lshlrev_b32 v92, 16, v87
    v_and_b32 v93, 0xffff0000, v87
    v_add_f32 v90, v90, v92
    v_add_f32 v91, v91, v93
    v_cvt_pk_bf16_f32 v87, v90, v91
    buffer_store_dwordx2 v[86:87], v1, s[32:35], s25 offen offset:48
    s_nop 1
    s_mov_b32 s25, 0
    buffer_load_dwordx2 v[80:81], v1, s[16:19], s25 offen offset:64
    buffer_load_dwordx2 v[82:83], v1, s[16:19], s25 offen offset:80
    buffer_load_dwordx2 v[84:85], v1, s[16:19], s25 offen offset:96
    buffer_load_dwordx2 v[86:87], v1, s[16:19], s25 offen offset:112
    s_waitcnt vmcnt(0)
    v_cvt_pk_bf16_f32 v88, v64, v65
    v_cvt_pk_bf16_f32 v89, v66, v67
    v_lshlrev_b32 v90, 16, v88
    v_and_b32 v91, 0xffff0000, v88
    v_lshlrev_b32 v92, 16, v80
    v_and_b32 v93, 0xffff0000, v80
    v_add_f32 v90, v90, v92
    v_add_f32 v91, v91, v93
    v_cvt_pk_bf16_f32 v80, v90, v91
    v_lshlrev_b32 v90, 16, v89
    v_and_b32 v91, 0xffff0000, v89
    v_lshlrev_b32 v92, 16, v81
    v_and_b32 v93, 0xffff0000, v81
    v_add_f32 v90, v90, v92
    v_add_f32 v91, v91, v93
    v_cvt_pk_bf16_f32 v81, v90, v91
    buffer_store_dwordx2 v[80:81], v1, s[32:35], s25 offen offset:64
    v_cvt_pk_bf16_f32 v88, v68, v69
    v_cvt_pk_bf16_f32 v89, v70, v71
    v_lshlrev_b32 v90, 16, v88
    v_and_b32 v91, 0xffff0000, v88
    v_lshlrev_b32 v92, 16, v82
    v_and_b32 v93, 0xffff0000, v82
    v_add_f32 v90, v90, v92
    v_add_f32 v91, v91, v93
    v_cvt_pk_bf16_f32 v82, v90, v91
    v_lshlrev_b32 v90, 16, v89
    v_and_b32 v91, 0xffff0000, v89
    v_lshlrev_b32 v92, 16, v83
    v_and_b32 v93, 0xffff0000, v83
    v_add_f32 v90, v90, v92
    v_add_f32 v91, v91, v93
    v_cvt_pk_bf16_f32 v83, v90, v91
    buffer_store_dwordx2 v[82:83], v1, s[32:35], s25 offen offset:80
    v_cvt_pk_bf16_f32 v88, v72, v73
    v_cvt_pk_bf16_f32 v89, v74, v75
    v_lshlrev_b32 v90, 16, v88
    v_and_b32 v91, 0xffff0000, v88
    v_lshlrev_b32 v92, 16, v84
    v_and_b32 v93, 0xffff0000, v84
    v_add_f32 v90, v90, v92
    v_add_f32 v91, v91, v93
    v_cvt_pk_bf16_f32 v84, v90, v91
    v_lshlrev_b32 v90, 16, v89
    v_and_b32 v91, 0xffff0000, v89
    v_lshlrev_b32 v92, 16, v85
    v_and_b32 v93, 0xffff0000, v85
    v_add_f32 v90, v90, v92
    v_add_f32 v91, v91, v93
    v_cvt_pk_bf16_f32 v85, v90, v91
    buffer_store_dwordx2 v[84:85], v1, s[32:35], s25 offen offset:96
    v_cvt_pk_bf16_f32 v88, v76, v77
    v_cvt_pk_bf16_f32 v89, v78, v79
    v_lshlrev_b32 v90, 16, v88
    v_and_b32 v91, 0xffff0000, v88
    v_lshlrev_b32 v92, 16, v86
    v_and_b32 v93, 0xffff0000, v86
    v_add_f32 v90, v90, v92
    v_add_f32 v91, v91, v93
    v_cvt_pk_bf16_f32 v86, v90, v91
    v_lshlrev_b32 v90, 16, v89
    v_and_b32 v91, 0xffff0000, v89
    v_lshlrev_b32 v92, 16, v87
    v_and_b32 v93, 0xffff0000, v87
    v_add_f32 v90, v90, v92
    v_add_f32 v91, v91, v93
    v_cvt_pk_bf16_f32 v87, v90, v91
    buffer_store_dwordx2 v[86:87], v1, s[32:35], s25 offen offset:112
    s_nop 1
L_ffn2_kernel_end:
    s_endpgm
.section .rodata,"a"
.p2align 6
.amdhsa_kernel prep_kernel
  .amdhsa_next_free_vgpr 48
  .amdhsa_next_free_sgpr 102
  .amdhsa_accum_offset 48
  .amdhsa_group_segment_fixed_size 0
  .amdhsa_kernarg_size 112
  .amdhsa_user_sgpr_count 2
  .amdhsa_user_sgpr_kernarg_segment_ptr 1
  .amdhsa_system_sgpr_workgroup_id_x 1
.end_amdhsa_kernel
.p2align 6
.amdhsa_kernel chain_kernel
  .amdhsa_next_free_vgpr 256
  .amdhsa_next_free_sgpr 102
  .amdhsa_accum_offset 152
  .amdhsa_group_segment_fixed_size 0
  .amdhsa_kernarg_size 112
  .amdhsa_user_sgpr_count 2
  .amdhsa_user_sgpr_kernarg_segment_ptr 1
  .amdhsa_system_sgpr_workgroup_id_x 1
.end_amdhsa_kernel
.p2align 6
.amdhsa_kernel wo_kernel
  .amdhsa_next_free_vgpr 184
  .amdhsa_next_free_sgpr 102
  .amdhsa_accum_offset 184
  .amdhsa_group_segment_fixed_size 0
  .amdhsa_kernarg_size 112
  .amdhsa_user_sgpr_count 2
  .amdhsa_user_sgpr_kernarg_segment_ptr 1
  .amdhsa_system_sgpr_workgroup_id_x 1
.end_amdhsa_kernel
.p2align 6
.amdhsa_kernel ffn1_kernel
  .amdhsa_next_free_vgpr 180
  .amdhsa_next_free_sgpr 102
  .amdhsa_accum_offset 180
  .amdhsa_group_segment_fixed_size 0
  .amdhsa_kernarg_size 112
  .amdhsa_user_sgpr_count 2
  .amdhsa_user_sgpr_kernarg_segment_ptr 1
  .amdhsa_system_sgpr_workgroup_id_x 1
.end_amdhsa_kernel
.p2align 6
.amdhsa_kernel ffn2_kernel
  .amdhsa_next_free_vgpr 96
  .amdhsa_next_free_sgpr 102
  .amdhsa_accum_offset 96
  .amdhsa_group_segment_fixed_size 0
  .amdhsa_kernarg_size 112
  .amdhsa_user_sgpr_count 2
  .amdhsa_user_sgpr_kernarg_segment_ptr 1
  .amdhsa_system_sgpr_workgroup_id_x 1
.end_amdhsa_kernel
```
